```python
import torch

def _softmax(x, axis=-1):
    return torch.softmax(x, dim=axis)
def _gelu(x):
    return torch.nn.functional.gelu(x, approximate="tanh")
def _silu(x):
    return torch.nn.functional.silu(x)
def _sigmoid(x):
    return torch.sigmoid(x)
def _layernorm(x, axis=-1, eps=1e-5):
    m = x.mean(dim=axis, keepdim=True)
    v = x.var(dim=axis, keepdim=True, unbiased=False)
    return (x - m) / torch.sqrt(v + eps)
def _scatter_add(tgt, idx, src, axis=0):
    return tgt.clone().index_add_(axis, idx, src)
def _segment_sum(src, seg, n):
    out = torch.zeros((n,) + src.shape[1:], dtype=src.dtype)
    return out.index_add_(0, seg, src)
def _pad(x, pw):
    flat = tuple(v for pair in reversed(pw) for v in pair)
    return torch.nn.functional.pad(x, flat)

kernel_name = 'interleave_layers__sliding_local_dilated__moe_arch_mod__prompt'

def setup_inputs():

    _w = (lambda a: (lambda t: t.to(torch.bfloat16) if t.is_floating_point() else t)(torch.as_tensor(a)))
    def _A_setup():
        B, S, D = 1, 2048, 512
        return {
            "x": _w((lambda *s: torch.randn(*s, dtype=torch.bfloat16) * 0.05)(B, S, D)),
            "wqkv": _w((lambda *s: torch.randn(*s, dtype=torch.bfloat16) * 0.05)(D, 3 * D)),
            "wo": _w((lambda *s: torch.randn(*s, dtype=torch.bfloat16) * 0.05)(D, D)),
        }
    _A_in = _A_setup()

    def _B_setup():
        B, S, D, F, C = 1, 2048, 512, 1792, 8
        return {
            "x": _w((lambda *s: torch.randn(*s, dtype=torch.bfloat16) * 0.05)(B, S, D)),
            "w_r": _w((lambda *s: torch.randn(*s, dtype=torch.bfloat16) * 0.05)(D)),
            "w_gate": _w((lambda *s: torch.randn(*s, dtype=torch.bfloat16) * 0.05)(D, F)),
            "w_up": _w((lambda *s: torch.randn(*s, dtype=torch.bfloat16) * 0.05)(D, F)),
            "w_down": _w((lambda *s: torch.randn(*s, dtype=torch.bfloat16) * 0.05)(F, D)),
        }
    _B_in = _B_setup()

    return {
        "A_x": _A_in["x"],
        "A_wqkv": _A_in["wqkv"],
        "A_wo": _A_in["wo"],
        "B_x": _B_in["x"],
        "B_w_r": _B_in["w_r"],
        "B_w_gate": _B_in["w_gate"],
        "B_w_up": _B_in["w_up"],
        "B_w_down": _B_in["w_down"],
    }

def reference(A_x, A_wqkv, A_wo, B_x, B_w_r, B_w_gate, B_w_up, B_w_down):
    def _A_ref(x, wqkv, wo):
        B, S, D = x.shape
        H = 32; Dh = D // H
        W, dil = 8, 2
        qkv = (lambda x, *d: x.permute(*d))((x @ wqkv).reshape(B, S, 3, H, Dh), 2, 0, 3, 1, 4)
        q, k, v = qkv[0], qkv[1], qkv[2]
        scale = Dh ** -0.5
        pos = torch.arange(S)
        off = torch.arange(W) * dil
        idx = pos[:, None] - off[None, :]
        mask = idx >= 0
        idx_c = torch.where(mask, idx, 0).reshape(-1)
        kg = k[:, :, idx_c, :].reshape(B, H, S, W, Dh)
        vg = v[:, :, idx_c, :].reshape(B, H, S, W, Dh)
        logits = torch.einsum("bhsd,bhswd->bhsw", q, kg) * scale
        logits = torch.where(mask[None, None, :, :], logits, -1e9)
        attn = _softmax(logits, axis=-1)
        o = torch.einsum("bhsw,bhswd->bhsd", attn, vg)
        return (lambda x, *d: x.permute(*d))(o, 0, 2, 1, 3).reshape(B, S, D) @ wo

    def _B_ref(x, w_r, w_gate, w_up, w_down):
        B, S, D = x.shape
        C = 8
        r = x @ w_r
        idx = torch.argsort(-r, axis=-1)[:, :C]
        idx_e = (lambda x, n, axis: torch.repeat_interleave(x, n, dim=axis))(idx.reshape(B, C, 1), D, axis=2)
        x_sel = (lambda x, i, axis: torch.take_along_dim(x, i, dim=axis))(x, idx_e, axis=1)
        g = _silu(x_sel @ w_gate)
        u = x_sel @ w_up
        y = (g * u) @ w_down
        r_sel = _sigmoid((lambda x, i, axis: torch.take_along_dim(x, i, dim=axis))(r, idx, axis=1))
        y = y * r_sel.reshape(B, C, 1)
        b_off = (torch.arange(B) * S).reshape(B, 1)
        flat_idx = (idx + b_off).reshape(B * C)
        zero = (x * 0.0).reshape(B * S, D)
        upd = _scatter_add(zero, flat_idx, y.reshape(B * C, D), axis=0)
        return x + upd.reshape(B, S, D)

    x = A_x
    x = x + _A_ref(_layernorm(x, axis=-1), A_wqkv, A_wo)
    x = x + _B_ref(_layernorm(x, axis=-1), B_w_r, B_w_gate, B_w_up, B_w_down)
    x = x + _A_ref(_layernorm(x, axis=-1), A_wqkv, A_wo)
    x = x + _B_ref(_layernorm(x, axis=-1), B_w_r, B_w_gate, B_w_up, B_w_down)
    return x
```

```asm
; @launch kernel=k1l1_kernel grid=(256,1,1) block=(512,1,1) lds=139264
; @launch kernel=k2l1_kernel grid=(256,1,1) block=(512,1,1) lds=131072
; @launch kernel=k4l1_kernel grid=(184,1,1) block=(512,1,1) lds=115904
; @launch kernel=k5l1_kernel grid=(32,1,1) block=(256,1,1) lds=4096
; @launch kernel=k1l2_kernel grid=(256,1,1) block=(512,1,1) lds=139264
; @launch kernel=k2l2_kernel grid=(256,1,1) block=(512,1,1) lds=131072
; @launch kernel=k4l2_kernel grid=(184,1,1) block=(512,1,1) lds=115904
; @launch kernel=k5l2_kernel grid=(32,1,1) block=(256,1,1) lds=4096
.amdgcn_target "amdgcn-amd-amdhsa--gfx950"
.text
.globl k1l1_kernel
.p2align 8
.type k1l1_kernel,@function
k1l1_kernel:
    s_cmp_ge_u32 s2, 256
    s_cbranch_scc1 L_k1l1_done
    s_load_dwordx2 s[4:5], s[0:1], 0
    s_load_dwordx2 s[6:7], s[0:1], 8
    s_load_dwordx2 s[8:9], s[0:1], 80
    s_and_b32 s28, s2, 7
    s_lshr_b32 s29, s2, 3
    s_lshr_b32 s30, s28, 1
    s_lshl_b32 s30, s30, 3
    s_lshr_b32 s31, s29, 2
    s_add_u32 s30, s30, s31
    s_and_b32 s28, s28, 1
    s_lshl_b32 s28, s28, 2
    s_and_b32 s29, s29, 3
    s_add_u32 s29, s28, s29
    s_lshl_b32 s31, s30, 6
    v_and_b32 v1, 63, v0
    v_lshrrev_b32 v2, 6, v0
    s_nop 0
    v_readfirstlane_b32 s30, v2
    v_lshrrev_b32 v10, 3, v1
    v_and_b32 v11, 7, v1
    v_lshrrev_b32 v12, 4, v1
    s_cmp_lt_u32 s30, 4
    s_cbranch_scc1 L_k1l1_comp
    s_sub_u32 s30, s30, 4
    s_lshl_b32 s34, s30, 4
    s_add_u32 s34, s34, s31
    v_add_u32 v13, s34, v10
    v_lshlrev_b32 v13, 10, v13
    v_xor_b32 v14, v11, v12
    v_lshl_add_u32 v2, v14, 4, v13
    v_xor_b32 v14, 4, v14
    v_lshl_add_u32 v3, v14, 4, v13
    v_add_u32 v3, 8192, v3
    s_lshl_b32 s34, s30, 2
    s_add_u32 s34, s34, s31
    s_sub_u32 s34, s34, 16
    v_add_u32 v13, s34, v10
    v_lshlrev_b32 v13, 10, v13
    s_lshl_b32 s34, s30, 1
    v_add_u32 v14, s34, v12
    v_and_b32 v14, 7, v14
    v_xor_b32 v14, v11, v14
    v_lshl_add_u32 v4, v14, 4, v13
    v_bfe_u32 v13, v10, 1, 1
    s_and_b32 s34, s30, 1
    s_lshl_b32 s34, s34, 1
    v_or_b32 v13, s34, v13
    v_lshrrev_b32 v14, 1, v11
    v_xor_b32 v13, v13, v14
    v_mul_u32_u24 v5, 3072, v10
    v_lshl_add_u32 v5, v13, 5, v5
    v_and_b32 v14, 1, v11
    v_lshl_add_u32 v5, v14, 4, v5
    s_lshl_b32 s34, s29, 7
    v_add_u32 v5, s34, v5
    s_mul_i32 s32, s30, 24576
    s_lshl_b32 s33, s30, 10
    s_lshl_b32 s35, s30, 11
    s_add_u32 s35, s35, 2048
    s_lshl_b32 s36, s30, 9
    s_waitcnt lgkmcnt(0)
    s_mov_b32 s12, s4
    s_and_b32 s13, s5, 0xffff
    s_mov_b32 s14, 2097152
    s_mov_b32 s15, 0x00020000
    s_mov_b32 s16, s6
    s_and_b32 s17, s7, 0xffff
    s_mov_b32 s18, 1572864
    s_mov_b32 s19, 0x00020000
    s_mov_b64 s[56:57], 0xffffffff
    s_mov_b32 s37, 0
    s_add_u32 m0, s35, 0
    s_nop 0
    buffer_load_dwordx4 v2, s[12:15], s37 offen lds
    s_add_u32 m0, s35, 1024
    s_nop 0
    buffer_load_dwordx4 v3, s[12:15], s37 offen lds
    s_add_u32 m0, s36, 0
    s_mov_b64 exec, s[56:57]
    buffer_load_dwordx4 v4, s[12:15], s37 offen lds
    s_mov_b64 exec, -1
    s_add_u32 s34, s32, 0
    s_add_u32 m0, s33, 10240
    s_nop 0
    buffer_load_dwordx4 v5, s[16:19], s34 offen lds
    s_add_u32 s34, s32, 98304
    s_add_u32 m0, s33, 14336
    s_nop 0
    buffer_load_dwordx4 v5, s[16:19], s34 offen lds
    s_add_u32 s34, s32, 1024
    s_add_u32 m0, s33, 18432
    s_nop 0
    buffer_load_dwordx4 v5, s[16:19], s34 offen lds
    s_add_u32 s34, s32, 99328
    s_add_u32 m0, s33, 22528
    s_nop 0
    buffer_load_dwordx4 v5, s[16:19], s34 offen lds
    s_add_u32 s34, s32, 2048
    s_add_u32 m0, s33, 26624
    s_nop 0
    buffer_load_dwordx4 v5, s[16:19], s34 offen lds
    s_add_u32 s34, s32, 100352
    s_add_u32 m0, s33, 30720
    s_nop 0
    buffer_load_dwordx4 v5, s[16:19], s34 offen lds
    s_mov_b32 s37, 128
    s_add_u32 m0, s35, 34816
    s_nop 0
    buffer_load_dwordx4 v2, s[12:15], s37 offen lds
    s_add_u32 m0, s35, 35840
    s_nop 0
    buffer_load_dwordx4 v3, s[12:15], s37 offen lds
    s_add_u32 m0, s36, 34816
    s_mov_b64 exec, s[56:57]
    buffer_load_dwordx4 v4, s[12:15], s37 offen lds
    s_mov_b64 exec, -1
    s_add_u32 s34, s32, 196608
    s_add_u32 m0, s33, 45056
    s_nop 0
    buffer_load_dwordx4 v5, s[16:19], s34 offen lds
    s_add_u32 s34, s32, 294912
    s_add_u32 m0, s33, 49152
    s_nop 0
    buffer_load_dwordx4 v5, s[16:19], s34 offen lds
    s_add_u32 s34, s32, 197632
    s_add_u32 m0, s33, 53248
    s_nop 0
    buffer_load_dwordx4 v5, s[16:19], s34 offen lds
    s_add_u32 s34, s32, 295936
    s_add_u32 m0, s33, 57344
    s_nop 0
    buffer_load_dwordx4 v5, s[16:19], s34 offen lds
    s_add_u32 s34, s32, 198656
    s_add_u32 m0, s33, 61440
    s_nop 0
    buffer_load_dwordx4 v5, s[16:19], s34 offen lds
    s_add_u32 s34, s32, 296960
    s_add_u32 m0, s33, 65536
    s_nop 0
    buffer_load_dwordx4 v5, s[16:19], s34 offen lds
    s_add_u32 s24, s8, 8388608
    s_addc_u32 s25, s9, 0
    s_and_b32 s25, s25, 0xffff
    s_mov_b32 s26, 65536
    s_mov_b32 s27, 0x00020000
    v_lshlrev_b32 v6, 5, v1
    v_add_u32 v6, s35, v6
    v_and_b32 v7, 31, v1
    v_lshlrev_b32 v7, 4, v7
    v_add_u32 v7, s36, v7
    v_mov_b32 v120, 0
    v_mov_b32 v121, 0
    v_mov_b32 v122, 0
    v_mov_b32 v123, 0
    v_mov_b32 v124, 0
    v_mov_b32 v125, 0
    v_mov_b32 v126, 0
    v_mov_b32 v127, 0
    s_mov_b32 s52, 0xffff0000
    s_mov_b32 s53, 0x3b000000
    s_mov_b32 s54, 0x3727c5ac
    s_waitcnt vmcnt(9)
    s_barrier
    ds_read_b128 v[100:103], v6 offset:0
    ds_read_b128 v[104:107], v6 offset:16
    ds_read_b128 v[108:111], v7 offset:0
    s_mov_b32 s37, 256
    s_add_u32 m0, s35, 69632
    s_nop 0
    buffer_load_dwordx4 v2, s[12:15], s37 offen lds
    s_add_u32 m0, s35, 70656
    s_nop 0
    buffer_load_dwordx4 v3, s[12:15], s37 offen lds
    s_add_u32 m0, s36, 69632
    s_mov_b64 exec, s[56:57]
    buffer_load_dwordx4 v4, s[12:15], s37 offen lds
    s_mov_b64 exec, -1
    s_add_u32 s34, s32, 393216
    s_add_u32 m0, s33, 79872
    s_nop 0
    buffer_load_dwordx4 v5, s[16:19], s34 offen lds
    s_add_u32 s34, s32, 491520
    s_add_u32 m0, s33, 83968
    s_nop 0
    buffer_load_dwordx4 v5, s[16:19], s34 offen lds
    s_add_u32 s34, s32, 394240
    s_add_u32 m0, s33, 88064
    s_nop 0
    buffer_load_dwordx4 v5, s[16:19], s34 offen lds
    s_add_u32 s34, s32, 492544
    s_add_u32 m0, s33, 92160
    s_nop 0
    buffer_load_dwordx4 v5, s[16:19], s34 offen lds
    s_add_u32 s34, s32, 395264
    s_add_u32 m0, s33, 96256
    s_nop 0
    buffer_load_dwordx4 v5, s[16:19], s34 offen lds
    s_add_u32 s34, s32, 493568
    s_add_u32 m0, s33, 100352
    s_nop 0
    buffer_load_dwordx4 v5, s[16:19], s34 offen lds
    s_waitcnt lgkmcnt(0)
    v_lshlrev_b32 v112, 16, v100
    v_and_b32 v113, s52, v100
    v_add_f32 v120, v120, v112
    v_add_f32 v121, v121, v113
    v_fma_f32 v122, v112, v112, v122
    v_fma_f32 v123, v113, v113, v123
    v_lshlrev_b32 v112, 16, v101
    v_and_b32 v113, s52, v101
    v_add_f32 v120, v120, v112
    v_add_f32 v121, v121, v113
    v_fma_f32 v122, v112, v112, v122
    v_fma_f32 v123, v113, v113, v123
    v_lshlrev_b32 v112, 16, v102
    v_and_b32 v113, s52, v102
    v_add_f32 v120, v120, v112
    v_add_f32 v121, v121, v113
    v_fma_f32 v122, v112, v112, v122
    v_fma_f32 v123, v113, v113, v123
    v_lshlrev_b32 v112, 16, v103
    v_and_b32 v113, s52, v103
    v_add_f32 v120, v120, v112
    v_add_f32 v121, v121, v113
    v_fma_f32 v122, v112, v112, v122
    v_fma_f32 v123, v113, v113, v123
    v_lshlrev_b32 v112, 16, v104
    v_and_b32 v113, s52, v104
    v_add_f32 v120, v120, v112
    v_add_f32 v121, v121, v113
    v_fma_f32 v122, v112, v112, v122
    v_fma_f32 v123, v113, v113, v123
    v_lshlrev_b32 v112, 16, v105
    v_and_b32 v113, s52, v105
    v_add_f32 v120, v120, v112
    v_add_f32 v121, v121, v113
    v_fma_f32 v122, v112, v112, v122
    v_fma_f32 v123, v113, v113, v123
    v_lshlrev_b32 v112, 16, v106
    v_and_b32 v113, s52, v106
    v_add_f32 v120, v120, v112
    v_add_f32 v121, v121, v113
    v_fma_f32 v122, v112, v112, v122
    v_fma_f32 v123, v113, v113, v123
    v_lshlrev_b32 v112, 16, v107
    v_and_b32 v113, s52, v107
    v_add_f32 v120, v120, v112
    v_add_f32 v121, v121, v113
    v_fma_f32 v122, v112, v112, v122
    v_fma_f32 v123, v113, v113, v123
    v_lshlrev_b32 v112, 16, v108
    v_and_b32 v113, s52, v108
    v_add_f32 v124, v124, v112
    v_add_f32 v125, v125, v113
    v_fma_f32 v126, v112, v112, v126
    v_fma_f32 v127, v113, v113, v127
    v_lshlrev_b32 v112, 16, v109
    v_and_b32 v113, s52, v109
    v_add_f32 v124, v124, v112
    v_add_f32 v125, v125, v113
    v_fma_f32 v126, v112, v112, v126
    v_fma_f32 v127, v113, v113, v127
    v_lshlrev_b32 v112, 16, v110
    v_and_b32 v113, s52, v110
    v_add_f32 v124, v124, v112
    v_add_f32 v125, v125, v113
    v_fma_f32 v126, v112, v112, v126
    v_fma_f32 v127, v113, v113, v127
    v_lshlrev_b32 v112, 16, v111
    v_and_b32 v113, s52, v111
    v_add_f32 v124, v124, v112
    v_add_f32 v125, v125, v113
    v_fma_f32 v126, v112, v112, v126
    v_fma_f32 v127, v113, v113, v127
    s_waitcnt vmcnt(9)
    s_barrier
    ds_read_b128 v[100:103], v6 offset:34816
    ds_read_b128 v[104:107], v6 offset:34832
    ds_read_b128 v[108:111], v7 offset:34816
    s_mov_b32 s37, 384
    s_add_u32 m0, s35, 104448
    s_nop 0
    buffer_load_dwordx4 v2, s[12:15], s37 offen lds
    s_add_u32 m0, s35, 105472
    s_nop 0
    buffer_load_dwordx4 v3, s[12:15], s37 offen lds
    s_add_u32 m0, s36, 104448
    s_mov_b64 exec, s[56:57]
    buffer_load_dwordx4 v4, s[12:15], s37 offen lds
    s_mov_b64 exec, -1
    s_add_u32 s34, s32, 589824
    s_add_u32 m0, s33, 114688
    s_nop 0
    buffer_load_dwordx4 v5, s[16:19], s34 offen lds
    s_add_u32 s34, s32, 688128
    s_add_u32 m0, s33, 118784
    s_nop 0
    buffer_load_dwordx4 v5, s[16:19], s34 offen lds
    s_add_u32 s34, s32, 590848
    s_add_u32 m0, s33, 122880
    s_nop 0
    buffer_load_dwordx4 v5, s[16:19], s34 offen lds
    s_add_u32 s34, s32, 689152
    s_add_u32 m0, s33, 126976
    s_nop 0
    buffer_load_dwordx4 v5, s[16:19], s34 offen lds
    s_add_u32 s34, s32, 591872
    s_add_u32 m0, s33, 131072
    s_nop 0
    buffer_load_dwordx4 v5, s[16:19], s34 offen lds
    s_add_u32 s34, s32, 690176
    s_add_u32 m0, s33, 135168
    s_nop 0
    buffer_load_dwordx4 v5, s[16:19], s34 offen lds
    s_waitcnt lgkmcnt(0)
    v_lshlrev_b32 v112, 16, v100
    v_and_b32 v113, s52, v100
    v_add_f32 v120, v120, v112
    v_add_f32 v121, v121, v113
    v_fma_f32 v122, v112, v112, v122
    v_fma_f32 v123, v113, v113, v123
    v_lshlrev_b32 v112, 16, v101
    v_and_b32 v113, s52, v101
    v_add_f32 v120, v120, v112
    v_add_f32 v121, v121, v113
    v_fma_f32 v122, v112, v112, v122
    v_fma_f32 v123, v113, v113, v123
    v_lshlrev_b32 v112, 16, v102
    v_and_b32 v113, s52, v102
    v_add_f32 v120, v120, v112
    v_add_f32 v121, v121, v113
    v_fma_f32 v122, v112, v112, v122
    v_fma_f32 v123, v113, v113, v123
    v_lshlrev_b32 v112, 16, v103
    v_and_b32 v113, s52, v103
    v_add_f32 v120, v120, v112
    v_add_f32 v121, v121, v113
    v_fma_f32 v122, v112, v112, v122
    v_fma_f32 v123, v113, v113, v123
    v_lshlrev_b32 v112, 16, v104
    v_and_b32 v113, s52, v104
    v_add_f32 v120, v120, v112
    v_add_f32 v121, v121, v113
    v_fma_f32 v122, v112, v112, v122
    v_fma_f32 v123, v113, v113, v123
    v_lshlrev_b32 v112, 16, v105
    v_and_b32 v113, s52, v105
    v_add_f32 v120, v120, v112
    v_add_f32 v121, v121, v113
    v_fma_f32 v122, v112, v112, v122
    v_fma_f32 v123, v113, v113, v123
    v_lshlrev_b32 v112, 16, v106
    v_and_b32 v113, s52, v106
    v_add_f32 v120, v120, v112
    v_add_f32 v121, v121, v113
    v_fma_f32 v122, v112, v112, v122
    v_fma_f32 v123, v113, v113, v123
    v_lshlrev_b32 v112, 16, v107
    v_and_b32 v113, s52, v107
    v_add_f32 v120, v120, v112
    v_add_f32 v121, v121, v113
    v_fma_f32 v122, v112, v112, v122
    v_fma_f32 v123, v113, v113, v123
    v_lshlrev_b32 v112, 16, v108
    v_and_b32 v113, s52, v108
    v_add_f32 v124, v124, v112
    v_add_f32 v125, v125, v113
    v_fma_f32 v126, v112, v112, v126
    v_fma_f32 v127, v113, v113, v127
    v_lshlrev_b32 v112, 16, v109
    v_and_b32 v113, s52, v109
    v_add_f32 v124, v124, v112
    v_add_f32 v125, v125, v113
    v_fma_f32 v126, v112, v112, v126
    v_fma_f32 v127, v113, v113, v127
    v_lshlrev_b32 v112, 16, v110
    v_and_b32 v113, s52, v110
    v_add_f32 v124, v124, v112
    v_add_f32 v125, v125, v113
    v_fma_f32 v126, v112, v112, v126
    v_fma_f32 v127, v113, v113, v127
    v_lshlrev_b32 v112, 16, v111
    v_and_b32 v113, s52, v111
    v_add_f32 v124, v124, v112
    v_add_f32 v125, v125, v113
    v_fma_f32 v126, v112, v112, v126
    v_fma_f32 v127, v113, v113, v127
    s_waitcnt vmcnt(9)
    s_barrier
    v_add_u32 v6, 69632, v6
    v_add_u32 v7, 69632, v7
    ds_read_b128 v[100:103], v6 offset:0
    ds_read_b128 v[104:107], v6 offset:16
    ds_read_b128 v[108:111], v7 offset:0
    s_mov_b32 s37, 512
    s_add_u32 m0, s35, 0
    s_nop 0
    buffer_load_dwordx4 v2, s[12:15], s37 offen lds
    s_add_u32 m0, s35, 1024
    s_nop 0
    buffer_load_dwordx4 v3, s[12:15], s37 offen lds
    s_add_u32 m0, s36, 0
    s_mov_b64 exec, s[56:57]
    buffer_load_dwordx4 v4, s[12:15], s37 offen lds
    s_mov_b64 exec, -1
    s_add_u32 s34, s32, 786432
    s_add_u32 m0, s33, 10240
    s_nop 0
    buffer_load_dwordx4 v5, s[16:19], s34 offen lds
    s_add_u32 s34, s32, 884736
    s_add_u32 m0, s33, 14336
    s_nop 0
    buffer_load_dwordx4 v5, s[16:19], s34 offen lds
    s_add_u32 s34, s32, 787456
    s_add_u32 m0, s33, 18432
    s_nop 0
    buffer_load_dwordx4 v5, s[16:19], s34 offen lds
    s_add_u32 s34, s32, 885760
    s_add_u32 m0, s33, 22528
    s_nop 0
    buffer_load_dwordx4 v5, s[16:19], s34 offen lds
    s_add_u32 s34, s32, 788480
    s_add_u32 m0, s33, 26624
    s_nop 0
    buffer_load_dwordx4 v5, s[16:19], s34 offen lds
    s_add_u32 s34, s32, 886784
    s_add_u32 m0, s33, 30720
    s_nop 0
    buffer_load_dwordx4 v5, s[16:19], s34 offen lds
    s_waitcnt lgkmcnt(0)
    v_lshlrev_b32 v112, 16, v100
    v_and_b32 v113, s52, v100
    v_add_f32 v120, v120, v112
    v_add_f32 v121, v121, v113
    v_fma_f32 v122, v112, v112, v122
    v_fma_f32 v123, v113, v113, v123
    v_lshlrev_b32 v112, 16, v101
    v_and_b32 v113, s52, v101
    v_add_f32 v120, v120, v112
    v_add_f32 v121, v121, v113
    v_fma_f32 v122, v112, v112, v122
    v_fma_f32 v123, v113, v113, v123
    v_lshlrev_b32 v112, 16, v102
    v_and_b32 v113, s52, v102
    v_add_f32 v120, v120, v112
    v_add_f32 v121, v121, v113
    v_fma_f32 v122, v112, v112, v122
    v_fma_f32 v123, v113, v113, v123
    v_lshlrev_b32 v112, 16, v103
    v_and_b32 v113, s52, v103
    v_add_f32 v120, v120, v112
    v_add_f32 v121, v121, v113
    v_fma_f32 v122, v112, v112, v122
    v_fma_f32 v123, v113, v113, v123
    v_lshlrev_b32 v112, 16, v104
    v_and_b32 v113, s52, v104
    v_add_f32 v120, v120, v112
    v_add_f32 v121, v121, v113
    v_fma_f32 v122, v112, v112, v122
    v_fma_f32 v123, v113, v113, v123
    v_lshlrev_b32 v112, 16, v105
    v_and_b32 v113, s52, v105
    v_add_f32 v120, v120, v112
    v_add_f32 v121, v121, v113
    v_fma_f32 v122, v112, v112, v122
    v_fma_f32 v123, v113, v113, v123
    v_lshlrev_b32 v112, 16, v106
    v_and_b32 v113, s52, v106
    v_add_f32 v120, v120, v112
    v_add_f32 v121, v121, v113
    v_fma_f32 v122, v112, v112, v122
    v_fma_f32 v123, v113, v113, v123
    v_lshlrev_b32 v112, 16, v107
    v_and_b32 v113, s52, v107
    v_add_f32 v120, v120, v112
    v_add_f32 v121, v121, v113
    v_fma_f32 v122, v112, v112, v122
    v_fma_f32 v123, v113, v113, v123
    v_lshlrev_b32 v112, 16, v108
    v_and_b32 v113, s52, v108
    v_add_f32 v124, v124, v112
    v_add_f32 v125, v125, v113
    v_fma_f32 v126, v112, v112, v126
    v_fma_f32 v127, v113, v113, v127
    v_lshlrev_b32 v112, 16, v109
    v_and_b32 v113, s52, v109
    v_add_f32 v124, v124, v112
    v_add_f32 v125, v125, v113
    v_fma_f32 v126, v112, v112, v126
    v_fma_f32 v127, v113, v113, v127
    v_lshlrev_b32 v112, 16, v110
    v_and_b32 v113, s52, v110
    v_add_f32 v124, v124, v112
    v_add_f32 v125, v125, v113
    v_fma_f32 v126, v112, v112, v126
    v_fma_f32 v127, v113, v113, v127
    v_lshlrev_b32 v112, 16, v111
    v_and_b32 v113, s52, v111
    v_add_f32 v124, v124, v112
    v_add_f32 v125, v125, v113
    v_fma_f32 v126, v112, v112, v126
    v_fma_f32 v127, v113, v113, v127
    s_waitcnt vmcnt(9)
    s_barrier
    ds_read_b128 v[100:103], v6 offset:34816
    ds_read_b128 v[104:107], v6 offset:34832
    ds_read_b128 v[108:111], v7 offset:34816
    s_mov_b32 s37, 640
    s_add_u32 m0, s35, 34816
    s_nop 0
    buffer_load_dwordx4 v2, s[12:15], s37 offen lds
    s_add_u32 m0, s35, 35840
    s_nop 0
    buffer_load_dwordx4 v3, s[12:15], s37 offen lds
    s_add_u32 m0, s36, 34816
    s_mov_b64 exec, s[56:57]
    buffer_load_dwordx4 v4, s[12:15], s37 offen lds
    s_mov_b64 exec, -1
    s_add_u32 s34, s32, 983040
    s_add_u32 m0, s33, 45056
    s_nop 0
    buffer_load_dwordx4 v5, s[16:19], s34 offen lds
    s_add_u32 s34, s32, 1081344
    s_add_u32 m0, s33, 49152
    s_nop 0
    buffer_load_dwordx4 v5, s[16:19], s34 offen lds
    s_add_u32 s34, s32, 984064
    s_add_u32 m0, s33, 53248
    s_nop 0
    buffer_load_dwordx4 v5, s[16:19], s34 offen lds
    s_add_u32 s34, s32, 1082368
    s_add_u32 m0, s33, 57344
    s_nop 0
    buffer_load_dwordx4 v5, s[16:19], s34 offen lds
    s_add_u32 s34, s32, 985088
    s_add_u32 m0, s33, 61440
    s_nop 0
    buffer_load_dwordx4 v5, s[16:19], s34 offen lds
    s_add_u32 s34, s32, 1083392
    s_add_u32 m0, s33, 65536
    s_nop 0
    buffer_load_dwordx4 v5, s[16:19], s34 offen lds
    s_waitcnt lgkmcnt(0)
    v_lshlrev_b32 v112, 16, v100
    v_and_b32 v113, s52, v100
    v_add_f32 v120, v120, v112
    v_add_f32 v121, v121, v113
    v_fma_f32 v122, v112, v112, v122
    v_fma_f32 v123, v113, v113, v123
    v_lshlrev_b32 v112, 16, v101
    v_and_b32 v113, s52, v101
    v_add_f32 v120, v120, v112
    v_add_f32 v121, v121, v113
    v_fma_f32 v122, v112, v112, v122
    v_fma_f32 v123, v113, v113, v123
    v_lshlrev_b32 v112, 16, v102
    v_and_b32 v113, s52, v102
    v_add_f32 v120, v120, v112
    v_add_f32 v121, v121, v113
    v_fma_f32 v122, v112, v112, v122
    v_fma_f32 v123, v113, v113, v123
    v_lshlrev_b32 v112, 16, v103
    v_and_b32 v113, s52, v103
    v_add_f32 v120, v120, v112
    v_add_f32 v121, v121, v113
    v_fma_f32 v122, v112, v112, v122
    v_fma_f32 v123, v113, v113, v123
    v_lshlrev_b32 v112, 16, v104
    v_and_b32 v113, s52, v104
    v_add_f32 v120, v120, v112
    v_add_f32 v121, v121, v113
    v_fma_f32 v122, v112, v112, v122
    v_fma_f32 v123, v113, v113, v123
    v_lshlrev_b32 v112, 16, v105
    v_and_b32 v113, s52, v105
    v_add_f32 v120, v120, v112
    v_add_f32 v121, v121, v113
    v_fma_f32 v122, v112, v112, v122
    v_fma_f32 v123, v113, v113, v123
    v_lshlrev_b32 v112, 16, v106
    v_and_b32 v113, s52, v106
    v_add_f32 v120, v120, v112
    v_add_f32 v121, v121, v113
    v_fma_f32 v122, v112, v112, v122
    v_fma_f32 v123, v113, v113, v123
    v_lshlrev_b32 v112, 16, v107
    v_and_b32 v113, s52, v107
    v_add_f32 v120, v120, v112
    v_add_f32 v121, v121, v113
    v_fma_f32 v122, v112, v112, v122
    v_fma_f32 v123, v113, v113, v123
    v_lshlrev_b32 v112, 16, v108
    v_and_b32 v113, s52, v108
    v_add_f32 v124, v124, v112
    v_add_f32 v125, v125, v113
    v_fma_f32 v126, v112, v112, v126
    v_fma_f32 v127, v113, v113, v127
    v_lshlrev_b32 v112, 16, v109
    v_and_b32 v113, s52, v109
    v_add_f32 v124, v124, v112
    v_add_f32 v125, v125, v113
    v_fma_f32 v126, v112, v112, v126
    v_fma_f32 v127, v113, v113, v127
    v_lshlrev_b32 v112, 16, v110
    v_and_b32 v113, s52, v110
    v_add_f32 v124, v124, v112
    v_add_f32 v125, v125, v113
    v_fma_f32 v126, v112, v112, v126
    v_fma_f32 v127, v113, v113, v127
    v_lshlrev_b32 v112, 16, v111
    v_and_b32 v113, s52, v111
    v_add_f32 v124, v124, v112
    v_add_f32 v125, v125, v113
    v_fma_f32 v126, v112, v112, v126
    v_fma_f32 v127, v113, v113, v127
    s_waitcnt vmcnt(9)
    s_barrier
    v_subrev_u32 v6, 69632, v6
    v_subrev_u32 v7, 69632, v7
    ds_read_b128 v[100:103], v6 offset:0
    ds_read_b128 v[104:107], v6 offset:16
    ds_read_b128 v[108:111], v7 offset:0
    s_mov_b32 s37, 768
    s_add_u32 m0, s35, 69632
    s_nop 0
    buffer_load_dwordx4 v2, s[12:15], s37 offen lds
    s_add_u32 m0, s35, 70656
    s_nop 0
    buffer_load_dwordx4 v3, s[12:15], s37 offen lds
    s_add_u32 m0, s36, 69632
    s_mov_b64 exec, s[56:57]
    buffer_load_dwordx4 v4, s[12:15], s37 offen lds
    s_mov_b64 exec, -1
    s_add_u32 s34, s32, 1179648
    s_add_u32 m0, s33, 79872
    s_nop 0
    buffer_load_dwordx4 v5, s[16:19], s34 offen lds
    s_add_u32 s34, s32, 1277952
    s_add_u32 m0, s33, 83968
    s_nop 0
    buffer_load_dwordx4 v5, s[16:19], s34 offen lds
    s_add_u32 s34, s32, 1180672
    s_add_u32 m0, s33, 88064
    s_nop 0
    buffer_load_dwordx4 v5, s[16:19], s34 offen lds
    s_add_u32 s34, s32, 1278976
    s_add_u32 m0, s33, 92160
    s_nop 0
    buffer_load_dwordx4 v5, s[16:19], s34 offen lds
    s_add_u32 s34, s32, 1181696
    s_add_u32 m0, s33, 96256
    s_nop 0
    buffer_load_dwordx4 v5, s[16:19], s34 offen lds
    s_add_u32 s34, s32, 1280000
    s_add_u32 m0, s33, 100352
    s_nop 0
    buffer_load_dwordx4 v5, s[16:19], s34 offen lds
    s_waitcnt lgkmcnt(0)
    v_lshlrev_b32 v112, 16, v100
    v_and_b32 v113, s52, v100
    v_add_f32 v120, v120, v112
    v_add_f32 v121, v121, v113
    v_fma_f32 v122, v112, v112, v122
    v_fma_f32 v123, v113, v113, v123
    v_lshlrev_b32 v112, 16, v101
    v_and_b32 v113, s52, v101
    v_add_f32 v120, v120, v112
    v_add_f32 v121, v121, v113
    v_fma_f32 v122, v112, v112, v122
    v_fma_f32 v123, v113, v113, v123
    v_lshlrev_b32 v112, 16, v102
    v_and_b32 v113, s52, v102
    v_add_f32 v120, v120, v112
    v_add_f32 v121, v121, v113
    v_fma_f32 v122, v112, v112, v122
    v_fma_f32 v123, v113, v113, v123
    v_lshlrev_b32 v112, 16, v103
    v_and_b32 v113, s52, v103
    v_add_f32 v120, v120, v112
    v_add_f32 v121, v121, v113
    v_fma_f32 v122, v112, v112, v122
    v_fma_f32 v123, v113, v113, v123
    v_lshlrev_b32 v112, 16, v104
    v_and_b32 v113, s52, v104
    v_add_f32 v120, v120, v112
    v_add_f32 v121, v121, v113
    v_fma_f32 v122, v112, v112, v122
    v_fma_f32 v123, v113, v113, v123
    v_lshlrev_b32 v112, 16, v105
    v_and_b32 v113, s52, v105
    v_add_f32 v120, v120, v112
    v_add_f32 v121, v121, v113
    v_fma_f32 v122, v112, v112, v122
    v_fma_f32 v123, v113, v113, v123
    v_lshlrev_b32 v112, 16, v106
    v_and_b32 v113, s52, v106
    v_add_f32 v120, v120, v112
    v_add_f32 v121, v121, v113
    v_fma_f32 v122, v112, v112, v122
    v_fma_f32 v123, v113, v113, v123
    v_lshlrev_b32 v112, 16, v107
    v_and_b32 v113, s52, v107
    v_add_f32 v120, v120, v112
    v_add_f32 v121, v121, v113
    v_fma_f32 v122, v112, v112, v122
    v_fma_f32 v123, v113, v113, v123
    v_lshlrev_b32 v112, 16, v108
    v_and_b32 v113, s52, v108
    v_add_f32 v124, v124, v112
    v_add_f32 v125, v125, v113
    v_fma_f32 v126, v112, v112, v126
    v_fma_f32 v127, v113, v113, v127
    v_lshlrev_b32 v112, 16, v109
    v_and_b32 v113, s52, v109
    v_add_f32 v124, v124, v112
    v_add_f32 v125, v125, v113
    v_fma_f32 v126, v112, v112, v126
    v_fma_f32 v127, v113, v113, v127
    v_lshlrev_b32 v112, 16, v110
    v_and_b32 v113, s52, v110
    v_add_f32 v124, v124, v112
    v_add_f32 v125, v125, v113
    v_fma_f32 v126, v112, v112, v126
    v_fma_f32 v127, v113, v113, v127
    v_lshlrev_b32 v112, 16, v111
    v_and_b32 v113, s52, v111
    v_add_f32 v124, v124, v112
    v_add_f32 v125, v125, v113
    v_fma_f32 v126, v112, v112, v126
    v_fma_f32 v127, v113, v113, v127
    s_waitcnt vmcnt(9)
    s_barrier
    ds_read_b128 v[100:103], v6 offset:34816
    ds_read_b128 v[104:107], v6 offset:34832
    ds_read_b128 v[108:111], v7 offset:34816
    s_mov_b32 s37, 896
    s_add_u32 m0, s35, 104448
    s_nop 0
    buffer_load_dwordx4 v2, s[12:15], s37 offen lds
    s_add_u32 m0, s35, 105472
    s_nop 0
    buffer_load_dwordx4 v3, s[12:15], s37 offen lds
    s_add_u32 m0, s36, 104448
    s_mov_b64 exec, s[56:57]
    buffer_load_dwordx4 v4, s[12:15], s37 offen lds
    s_mov_b64 exec, -1
    s_add_u32 s34, s32, 1376256
    s_add_u32 m0, s33, 114688
    s_nop 0
    buffer_load_dwordx4 v5, s[16:19], s34 offen lds
    s_add_u32 s34, s32, 1474560
    s_add_u32 m0, s33, 118784
    s_nop 0
    buffer_load_dwordx4 v5, s[16:19], s34 offen lds
    s_add_u32 s34, s32, 1377280
    s_add_u32 m0, s33, 122880
    s_nop 0
    buffer_load_dwordx4 v5, s[16:19], s34 offen lds
    s_add_u32 s34, s32, 1475584
    s_add_u32 m0, s33, 126976
    s_nop 0
    buffer_load_dwordx4 v5, s[16:19], s34 offen lds
    s_add_u32 s34, s32, 1378304
    s_add_u32 m0, s33, 131072
    s_nop 0
    buffer_load_dwordx4 v5, s[16:19], s34 offen lds
    s_add_u32 s34, s32, 1476608
    s_add_u32 m0, s33, 135168
    s_nop 0
    buffer_load_dwordx4 v5, s[16:19], s34 offen lds
    s_waitcnt lgkmcnt(0)
    v_lshlrev_b32 v112, 16, v100
    v_and_b32 v113, s52, v100
    v_add_f32 v120, v120, v112
    v_add_f32 v121, v121, v113
    v_fma_f32 v122, v112, v112, v122
    v_fma_f32 v123, v113, v113, v123
    v_lshlrev_b32 v112, 16, v101
    v_and_b32 v113, s52, v101
    v_add_f32 v120, v120, v112
    v_add_f32 v121, v121, v113
    v_fma_f32 v122, v112, v112, v122
    v_fma_f32 v123, v113, v113, v123
    v_lshlrev_b32 v112, 16, v102
    v_and_b32 v113, s52, v102
    v_add_f32 v120, v120, v112
    v_add_f32 v121, v121, v113
    v_fma_f32 v122, v112, v112, v122
    v_fma_f32 v123, v113, v113, v123
    v_lshlrev_b32 v112, 16, v103
    v_and_b32 v113, s52, v103
    v_add_f32 v120, v120, v112
    v_add_f32 v121, v121, v113
    v_fma_f32 v122, v112, v112, v122
    v_fma_f32 v123, v113, v113, v123
    v_lshlrev_b32 v112, 16, v104
    v_and_b32 v113, s52, v104
    v_add_f32 v120, v120, v112
    v_add_f32 v121, v121, v113
    v_fma_f32 v122, v112, v112, v122
    v_fma_f32 v123, v113, v113, v123
    v_lshlrev_b32 v112, 16, v105
    v_and_b32 v113, s52, v105
    v_add_f32 v120, v120, v112
    v_add_f32 v121, v121, v113
    v_fma_f32 v122, v112, v112, v122
    v_fma_f32 v123, v113, v113, v123
    v_lshlrev_b32 v112, 16, v106
    v_and_b32 v113, s52, v106
    v_add_f32 v120, v120, v112
    v_add_f32 v121, v121, v113
    v_fma_f32 v122, v112, v112, v122
    v_fma_f32 v123, v113, v113, v123
    v_lshlrev_b32 v112, 16, v107
    v_and_b32 v113, s52, v107
    v_add_f32 v120, v120, v112
    v_add_f32 v121, v121, v113
    v_fma_f32 v122, v112, v112, v122
    v_fma_f32 v123, v113, v113, v123
    v_lshlrev_b32 v112, 16, v108
    v_and_b32 v113, s52, v108
    v_add_f32 v124, v124, v112
    v_add_f32 v125, v125, v113
    v_fma_f32 v126, v112, v112, v126
    v_fma_f32 v127, v113, v113, v127
    v_lshlrev_b32 v112, 16, v109
    v_and_b32 v113, s52, v109
    v_add_f32 v124, v124, v112
    v_add_f32 v125, v125, v113
    v_fma_f32 v126, v112, v112, v126
    v_fma_f32 v127, v113, v113, v127
    v_lshlrev_b32 v112, 16, v110
    v_and_b32 v113, s52, v110
    v_add_f32 v124, v124, v112
    v_add_f32 v125, v125, v113
    v_fma_f32 v126, v112, v112, v126
    v_fma_f32 v127, v113, v113, v127
    v_lshlrev_b32 v112, 16, v111
    v_and_b32 v113, s52, v111
    v_add_f32 v124, v124, v112
    v_add_f32 v125, v125, v113
    v_fma_f32 v126, v112, v112, v126
    v_fma_f32 v127, v113, v113, v127
    s_waitcnt vmcnt(9)
    s_barrier
    v_add_u32 v6, 69632, v6
    v_add_u32 v7, 69632, v7
    ds_read_b128 v[100:103], v6 offset:0
    ds_read_b128 v[104:107], v6 offset:16
    ds_read_b128 v[108:111], v7 offset:0
    s_waitcnt lgkmcnt(0)
    v_lshlrev_b32 v112, 16, v100
    v_and_b32 v113, s52, v100
    v_add_f32 v120, v120, v112
    v_add_f32 v121, v121, v113
    v_fma_f32 v122, v112, v112, v122
    v_fma_f32 v123, v113, v113, v123
    v_lshlrev_b32 v112, 16, v101
    v_and_b32 v113, s52, v101
    v_add_f32 v120, v120, v112
    v_add_f32 v121, v121, v113
    v_fma_f32 v122, v112, v112, v122
    v_fma_f32 v123, v113, v113, v123
    v_lshlrev_b32 v112, 16, v102
    v_and_b32 v113, s52, v102
    v_add_f32 v120, v120, v112
    v_add_f32 v121, v121, v113
    v_fma_f32 v122, v112, v112, v122
    v_fma_f32 v123, v113, v113, v123
    v_lshlrev_b32 v112, 16, v103
    v_and_b32 v113, s52, v103
    v_add_f32 v120, v120, v112
    v_add_f32 v121, v121, v113
    v_fma_f32 v122, v112, v112, v122
    v_fma_f32 v123, v113, v113, v123
    v_lshlrev_b32 v112, 16, v104
    v_and_b32 v113, s52, v104
    v_add_f32 v120, v120, v112
    v_add_f32 v121, v121, v113
    v_fma_f32 v122, v112, v112, v122
    v_fma_f32 v123, v113, v113, v123
    v_lshlrev_b32 v112, 16, v105
    v_and_b32 v113, s52, v105
    v_add_f32 v120, v120, v112
    v_add_f32 v121, v121, v113
    v_fma_f32 v122, v112, v112, v122
    v_fma_f32 v123, v113, v113, v123
    v_lshlrev_b32 v112, 16, v106
    v_and_b32 v113, s52, v106
    v_add_f32 v120, v120, v112
    v_add_f32 v121, v121, v113
    v_fma_f32 v122, v112, v112, v122
    v_fma_f32 v123, v113, v113, v123
    v_lshlrev_b32 v112, 16, v107
    v_and_b32 v113, s52, v107
    v_add_f32 v120, v120, v112
    v_add_f32 v121, v121, v113
    v_fma_f32 v122, v112, v112, v122
    v_fma_f32 v123, v113, v113, v123
    v_lshlrev_b32 v112, 16, v108
    v_and_b32 v113, s52, v108
    v_add_f32 v124, v124, v112
    v_add_f32 v125, v125, v113
    v_fma_f32 v126, v112, v112, v126
    v_fma_f32 v127, v113, v113, v127
    v_lshlrev_b32 v112, 16, v109
    v_and_b32 v113, s52, v109
    v_add_f32 v124, v124, v112
    v_add_f32 v125, v125, v113
    v_fma_f32 v126, v112, v112, v126
    v_fma_f32 v127, v113, v113, v127
    v_lshlrev_b32 v112, 16, v110
    v_and_b32 v113, s52, v110
    v_add_f32 v124, v124, v112
    v_add_f32 v125, v125, v113
    v_fma_f32 v126, v112, v112, v126
    v_fma_f32 v127, v113, v113, v127
    v_lshlrev_b32 v112, 16, v111
    v_and_b32 v113, s52, v111
    v_add_f32 v124, v124, v112
    v_add_f32 v125, v125, v113
    v_fma_f32 v126, v112, v112, v126
    v_fma_f32 v127, v113, v113, v127
    s_waitcnt vmcnt(0)
    s_barrier
    ds_read_b128 v[100:103], v6 offset:34816
    ds_read_b128 v[104:107], v6 offset:34832
    ds_read_b128 v[108:111], v7 offset:34816
    s_waitcnt lgkmcnt(0)
    v_lshlrev_b32 v112, 16, v100
    v_and_b32 v113, s52, v100
    v_add_f32 v120, v120, v112
    v_add_f32 v121, v121, v113
    v_fma_f32 v122, v112, v112, v122
    v_fma_f32 v123, v113, v113, v123
    v_lshlrev_b32 v112, 16, v101
    v_and_b32 v113, s52, v101
    v_add_f32 v120, v120, v112
    v_add_f32 v121, v121, v113
    v_fma_f32 v122, v112, v112, v122
    v_fma_f32 v123, v113, v113, v123
    v_lshlrev_b32 v112, 16, v102
    v_and_b32 v113, s52, v102
    v_add_f32 v120, v120, v112
    v_add_f32 v121, v121, v113
    v_fma_f32 v122, v112, v112, v122
    v_fma_f32 v123, v113, v113, v123
    v_lshlrev_b32 v112, 16, v103
    v_and_b32 v113, s52, v103
    v_add_f32 v120, v120, v112
    v_add_f32 v121, v121, v113
    v_fma_f32 v122, v112, v112, v122
    v_fma_f32 v123, v113, v113, v123
    v_lshlrev_b32 v112, 16, v104
    v_and_b32 v113, s52, v104
    v_add_f32 v120, v120, v112
    v_add_f32 v121, v121, v113
    v_fma_f32 v122, v112, v112, v122
    v_fma_f32 v123, v113, v113, v123
    v_lshlrev_b32 v112, 16, v105
    v_and_b32 v113, s52, v105
    v_add_f32 v120, v120, v112
    v_add_f32 v121, v121, v113
    v_fma_f32 v122, v112, v112, v122
    v_fma_f32 v123, v113, v113, v123
    v_lshlrev_b32 v112, 16, v106
    v_and_b32 v113, s52, v106
    v_add_f32 v120, v120, v112
    v_add_f32 v121, v121, v113
    v_fma_f32 v122, v112, v112, v122
    v_fma_f32 v123, v113, v113, v123
    v_lshlrev_b32 v112, 16, v107
    v_and_b32 v113, s52, v107
    v_add_f32 v120, v120, v112
    v_add_f32 v121, v121, v113
    v_fma_f32 v122, v112, v112, v122
    v_fma_f32 v123, v113, v113, v123
    v_lshlrev_b32 v112, 16, v108
    v_and_b32 v113, s52, v108
    v_add_f32 v124, v124, v112
    v_add_f32 v125, v125, v113
    v_fma_f32 v126, v112, v112, v126
    v_fma_f32 v127, v113, v113, v127
    v_lshlrev_b32 v112, 16, v109
    v_and_b32 v113, s52, v109
    v_add_f32 v124, v124, v112
    v_add_f32 v125, v125, v113
    v_fma_f32 v126, v112, v112, v126
    v_fma_f32 v127, v113, v113, v127
    v_lshlrev_b32 v112, 16, v110
    v_and_b32 v113, s52, v110
    v_add_f32 v124, v124, v112
    v_add_f32 v125, v125, v113
    v_fma_f32 v126, v112, v112, v126
    v_fma_f32 v127, v113, v113, v127
    v_lshlrev_b32 v112, 16, v111
    v_and_b32 v113, s52, v111
    v_add_f32 v124, v124, v112
    v_add_f32 v125, v125, v113
    v_fma_f32 v126, v112, v112, v126
    v_fma_f32 v127, v113, v113, v127
    v_add_f32 v120, v120, v121
    v_add_f32 v121, v122, v123
    v_add_f32 v122, v124, v125
    v_add_f32 v123, v126, v127
    v_add_f32_dpp v120, v120, v120 quad_perm:[1,0,3,2] row_mask:0xf bank_mask:0xf
    v_add_f32_dpp v121, v121, v121 quad_perm:[1,0,3,2] row_mask:0xf bank_mask:0xf
    v_add_f32_dpp v122, v122, v122 quad_perm:[1,0,3,2] row_mask:0xf bank_mask:0xf
    v_add_f32_dpp v123, v123, v123 quad_perm:[1,0,3,2] row_mask:0xf bank_mask:0xf
    v_add_f32_dpp v120, v120, v120 quad_perm:[2,3,0,1] row_mask:0xf bank_mask:0xf
    v_add_f32_dpp v121, v121, v121 quad_perm:[2,3,0,1] row_mask:0xf bank_mask:0xf
    v_add_f32_dpp v122, v122, v122 quad_perm:[2,3,0,1] row_mask:0xf bank_mask:0xf
    v_add_f32_dpp v123, v123, v123 quad_perm:[2,3,0,1] row_mask:0xf bank_mask:0xf
    s_nop 0
    v_add_f32_dpp v122, v122, v122 row_half_mirror row_mask:0xf bank_mask:0xf
    v_add_f32_dpp v123, v123, v123 row_half_mirror row_mask:0xf bank_mask:0xf
    v_mul_f32 v112, s53, v120
    v_mul_f32 v113, s53, v121
    v_fma_f32 v113, -v112, v112, v113
    v_max_f32 v113, 0, v113
    v_cvt_pk_bf16_f32 v112, v112, v113
    v_lshlrev_b32 v124, 16, v112
    v_and_b32 v113, s52, v112
    v_add_f32 v113, s54, v113
    v_cvt_pk_bf16_f32 v113, v113, v113
    v_lshlrev_b32 v113, 16, v113
    v_sqrt_f32 v113, v113
    s_nop 0
    v_cvt_pk_bf16_f32 v113, v113, v113
    v_lshlrev_b32 v113, 16, v113
    v_rcp_f32 v125, v113
    v_mul_f32 v114, s53, v122
    v_mul_f32 v115, s53, v123
    v_fma_f32 v115, -v114, v114, v115
    v_max_f32 v115, 0, v115
    v_cvt_pk_bf16_f32 v114, v114, v115
    v_lshlrev_b32 v126, 16, v114
    v_and_b32 v115, s52, v114
    v_add_f32 v115, s54, v115
    v_cvt_pk_bf16_f32 v115, v115, v115
    v_lshlrev_b32 v115, 16, v115
    v_sqrt_f32 v115, v115
    s_nop 0
    v_cvt_pk_bf16_f32 v115, v115, v115
    v_lshlrev_b32 v115, 16, v115
    v_rcp_f32 v127, v115
    v_lshrrev_b32 v112, 2, v1
    v_lshlrev_b32 v112, 3, v112
    s_lshl_b32 s34, s30, 7
    v_add_u32 v112, s34, v112
    ds_write_b64 v112, v[124:125] offset:0
    v_bfe_u32 v112, v1, 3, 2
    v_lshlrev_b32 v112, 3, v112
    s_lshl_b32 s34, s30, 5
    v_add_u32 v112, s34, v112
    ds_write_b64 v112, v[126:127] offset:512
    s_cmp_lg_u32 s30, 0
    s_cbranch_scc1 L_k1l1_nz
    v_mov_b32 v100, 0
    v_mov_b32 v101, 0
    v_mov_b32 v102, 0
    v_mov_b32 v103, 0
    s_lshl_b32 s34, s2, 8
    v_lshlrev_b32 v104, 4, v1
    v_add_u32 v104, s34, v104
    v_cmp_gt_u32 vcc, 16, v1
    s_nop 0
    s_and_saveexec_b64 s[58:59], vcc
    buffer_store_dwordx4 v[100:103], v104, s[24:27], 0 offen
    s_mov_b64 exec, s[58:59]
L_k1l1_nz:
    s_mov_b32 s20, s8
    s_and_b32 s21, s9, 0xffff
    s_mov_b32 s22, 2097152
    s_mov_b32 s23, 0x00020000
    s_waitcnt lgkmcnt(0)
    s_barrier
    s_load_dwordx2 s[60:61], s[0:1], 16
    s_load_dwordx4 s[64:67], s[0:1], 40
    s_load_dwordx2 s[62:63], s[0:1], 56
    s_and_b32 s84, s2, 7
    s_lshr_b32 s85, s2, 3
    v_lshrrev_b32 v20, 5, v1
    v_mul_u32_u24 v20, 3584, v20
    v_and_b32 v21, 31, v1
    v_lshl_add_u32 v20, v21, 4, v20
    v_lshlrev_b32 v21, 4, v1
    s_mul_i32 s34, s84, 448
    s_lshl_b32 s37, s85, 4
    s_lshl_b32 s38, s30, 2
    s_add_u32 s37, s37, s38
    s_mul_i32 s37, s37, 3584
    s_add_u32 s34, s34, s37
    s_waitcnt lgkmcnt(0)
    s_mov_b32 s68, s64
    s_and_b32 s69, s65, 0xffff
    s_mov_b32 s70, 1835008
    s_mov_b32 s71, 0x00020000
    s_mov_b32 s72, s66
    s_and_b32 s73, s67, 0xffff
    s_mov_b32 s74, 1835008
    s_mov_b32 s75, 0x00020000
    s_mov_b32 s76, s62
    s_and_b32 s77, s63, 0xffff
    s_mov_b32 s78, 1835008
    s_mov_b32 s79, 0x00020000
    s_mov_b32 s80, s60
    s_and_b32 s81, s61, 0xffff
    s_mov_b32 s82, 524288
    s_mov_b32 s83, 0x00020000
    s_lshl_b32 s37, s85, 4
    s_add_u32 s37, s37, s38
    s_lshl_b32 s37, s37, 10
    buffer_load_dwordx4 v[154:157], v21, s[80:83], s37 offen offset:0
    buffer_load_dwordx4 v[158:161], v21, s[80:83], s37 offen offset:1024
    buffer_load_dwordx4 v[162:165], v21, s[80:83], s37 offen offset:2048
    buffer_load_dwordx4 v[166:169], v21, s[80:83], s37 offen offset:3072
    s_add_u32 s37, s34, 0
    buffer_load_dwordx4 v[130:133], v20, s[68:71], s37 offen
    buffer_load_dwordx4 v[134:137], v20, s[72:75], s37 offen
    s_add_u32 s37, s34, 7168
    buffer_load_dwordx4 v[138:141], v20, s[68:71], s37 offen
    buffer_load_dwordx4 v[142:145], v20, s[72:75], s37 offen
    s_mul_i32 s34, s84, 224
    s_mul_i32 s37, s85, 7
    s_add_u32 s34, s34, s37
    s_add_u32 s34, s34, s30
    s_lshl_b32 s34, s34, 10
    buffer_load_dwordx4 v[146:149], v21, s[76:79], s34 offen
    s_add_u32 s34, s34, 4096
    buffer_load_dwordx4 v[150:153], v21, s[76:79], s34 offen
    s_add_u32 s30, s30, 4
    s_branch L_k1l1_attn
L_k1l1_comp:
    s_lshl_b32 s35, s30, 11
    s_add_u32 s35, s35, 2048
    s_waitcnt lgkmcnt(0)
    s_mov_b32 s20, s8
    s_and_b32 s21, s9, 0xffff
    s_mov_b32 s22, 2097152
    s_mov_b32 s23, 0x00020000
    v_and_b32 v10, 15, v1
    v_lshrrev_b32 v13, 1, v10
    v_xor_b32 v13, v13, v12
    v_lshlrev_b32 v6, 7, v10
    v_lshl_add_u32 v6, v13, 4, v6
    v_xor_b32 v7, 64, v6
    v_add_u32 v8, s35, v6
    v_add_u32 v9, s35, v7
    v_bfe_u32 v13, v1, 2, 2
    v_lshl_add_u32 v14, v12, 3, v13
    v_lshlrev_b32 v164, 7, v14
    v_lshrrev_b32 v13, 1, v13
    v_and_b32 v14, 1, v12
    v_lshl_or_b32 v13, v14, 1, v13
    v_xor_b32 v13, s30, v13
    v_lshl_add_u32 v164, v13, 5, v164
    v_and_b32 v14, 3, v1
    v_lshl_add_u32 v164, v14, 3, v164
    v_add_u32 v164, 10240, v164
    v_add_u32 v165, 69632, v6
    v_add_u32 v166, 69632, v7
    v_add_u32 v167, 69632, v8
    v_add_u32 v168, 69632, v9
    v_add_u32 v169, 69632, v164
    v_mov_b32 v16, 0
    v_mov_b32 v17, 0
    v_mov_b32 v18, 0
    v_mov_b32 v19, 0
    v_mov_b32 v20, 0
    v_mov_b32 v21, 0
    v_mov_b32 v22, 0
    v_mov_b32 v23, 0
    v_mov_b32 v24, 0
    v_mov_b32 v25, 0
    v_mov_b32 v26, 0
    v_mov_b32 v27, 0
    v_mov_b32 v28, 0
    v_mov_b32 v29, 0
    v_mov_b32 v30, 0
    v_mov_b32 v31, 0
    v_mov_b32 v32, 0
    v_mov_b32 v33, 0
    v_mov_b32 v34, 0
    v_mov_b32 v35, 0
    v_mov_b32 v36, 0
    v_mov_b32 v37, 0
    v_mov_b32 v38, 0
    v_mov_b32 v39, 0
    v_mov_b32 v40, 0
    v_mov_b32 v41, 0
    v_mov_b32 v42, 0
    v_mov_b32 v43, 0
    v_mov_b32 v44, 0
    v_mov_b32 v45, 0
    v_mov_b32 v46, 0
    v_mov_b32 v47, 0
    v_mov_b32 v48, 0
    v_mov_b32 v49, 0
    v_mov_b32 v50, 0
    v_mov_b32 v51, 0
    v_mov_b32 v52, 0
    v_mov_b32 v53, 0
    v_mov_b32 v54, 0
    v_mov_b32 v55, 0
    v_mov_b32 v56, 0
    v_mov_b32 v57, 0
    v_mov_b32 v58, 0
    v_mov_b32 v59, 0
    v_mov_b32 v60, 0
    v_mov_b32 v61, 0
    v_mov_b32 v62, 0
    v_mov_b32 v63, 0
    v_mov_b32 v64, 0
    v_mov_b32 v65, 0
    v_mov_b32 v66, 0
    v_mov_b32 v67, 0
    v_mov_b32 v68, 0
    v_mov_b32 v69, 0
    v_mov_b32 v70, 0
    v_mov_b32 v71, 0
    v_mov_b32 v72, 0
    v_mov_b32 v73, 0
    v_mov_b32 v74, 0
    v_mov_b32 v75, 0
    v_mov_b32 v76, 0
    v_mov_b32 v77, 0
    v_mov_b32 v78, 0
    v_mov_b32 v79, 0
    v_mov_b32 v80, 0
    v_mov_b32 v81, 0
    v_mov_b32 v82, 0
    v_mov_b32 v83, 0
    v_mov_b32 v84, 0
    v_mov_b32 v85, 0
    v_mov_b32 v86, 0
    v_mov_b32 v87, 0
    v_mov_b32 v160, 0x3f803f80
    v_mov_b32 v161, 0x3f803f80
    v_mov_b32 v162, 0x3f803f80
    v_mov_b32 v163, 0x3f803f80
    v_mov_b32 v170, 0
    v_mov_b32 v171, 0
    v_mov_b32 v172, 0
    v_mov_b32 v173, 0
    s_barrier
    ds_read_b64_tr_b16 v[136:137], v164 offset:0
    ds_read_b64_tr_b16 v[138:139], v164 offset:512
    ds_read_b64_tr_b16 v[140:141], v164 offset:8192
    ds_read_b64_tr_b16 v[142:143], v164 offset:8704
    ds_read_b64_tr_b16 v[144:145], v164 offset:16384
    ds_read_b64_tr_b16 v[146:147], v164 offset:16896
    ds_read_b128 v[88:91], v6 offset:2048
    ds_read_b128 v[92:95], v6 offset:4096
    ds_read_b128 v[96:99], v6 offset:6144
    ds_read_b128 v[100:103], v6 offset:8192
    ds_read_b128 v[104:107], v6 offset:0
    s_waitcnt lgkmcnt(0)
    ds_read_b64_tr_b16 v[148:149], v164 offset:4096
    ds_read_b64_tr_b16 v[150:151], v164 offset:4608
    ds_read_b64_tr_b16 v[152:153], v164 offset:12288
    ds_read_b64_tr_b16 v[154:155], v164 offset:12800
    ds_read_b64_tr_b16 v[156:157], v164 offset:20480
    ds_read_b64_tr_b16 v[158:159], v164 offset:20992
    ds_read_b128 v[112:115], v7 offset:2048
    ds_read_b128 v[116:119], v7 offset:4096
    ds_read_b128 v[120:123], v7 offset:6144
    ds_read_b128 v[124:127], v7 offset:8192
    ds_read_b128 v[128:131], v7 offset:0
    v_mfma_f32_16x16x32_bf16 v[16:19], v[136:139], v[88:91], v[16:19]
    v_mfma_f32_16x16x32_bf16 v[20:23], v[136:139], v[92:95], v[20:23]
    v_mfma_f32_16x16x32_bf16 v[24:27], v[136:139], v[96:99], v[24:27]
    v_mfma_f32_16x16x32_bf16 v[28:31], v[136:139], v[100:103], v[28:31]
    v_mfma_f32_16x16x32_bf16 v[76:79], v[136:139], v[160:163], v[76:79]
    v_mfma_f32_16x16x32_bf16 v[36:39], v[140:143], v[88:91], v[36:39]
    v_mfma_f32_16x16x32_bf16 v[40:43], v[140:143], v[92:95], v[40:43]
    v_mfma_f32_16x16x32_bf16 v[44:47], v[140:143], v[96:99], v[44:47]
    v_mfma_f32_16x16x32_bf16 v[48:51], v[140:143], v[100:103], v[48:51]
    v_mfma_f32_16x16x32_bf16 v[52:55], v[140:143], v[104:107], v[52:55]
    v_mfma_f32_16x16x32_bf16 v[80:83], v[140:143], v[160:163], v[80:83]
    v_mfma_f32_16x16x32_bf16 v[56:59], v[144:147], v[88:91], v[56:59]
    v_mfma_f32_16x16x32_bf16 v[60:63], v[144:147], v[92:95], v[60:63]
    v_mfma_f32_16x16x32_bf16 v[64:67], v[144:147], v[96:99], v[64:67]
    v_mfma_f32_16x16x32_bf16 v[68:71], v[144:147], v[100:103], v[68:71]
    v_mfma_f32_16x16x32_bf16 v[72:75], v[144:147], v[104:107], v[72:75]
    v_mfma_f32_16x16x32_bf16 v[84:87], v[144:147], v[160:163], v[84:87]
    s_waitcnt lgkmcnt(0)
    s_barrier
    ds_read_b64_tr_b16 v[136:137], v164 offset:34816
    ds_read_b64_tr_b16 v[138:139], v164 offset:35328
    ds_read_b64_tr_b16 v[140:141], v164 offset:43008
    ds_read_b64_tr_b16 v[142:143], v164 offset:43520
    ds_read_b64_tr_b16 v[144:145], v164 offset:51200
    ds_read_b64_tr_b16 v[146:147], v164 offset:51712
    ds_read_b128 v[88:91], v6 offset:36864
    ds_read_b128 v[92:95], v6 offset:38912
    ds_read_b128 v[96:99], v6 offset:40960
    ds_read_b128 v[100:103], v6 offset:43008
    ds_read_b128 v[104:107], v6 offset:34816
    v_mfma_f32_16x16x32_bf16 v[16:19], v[148:151], v[112:115], v[16:19]
    v_mfma_f32_16x16x32_bf16 v[20:23], v[148:151], v[116:119], v[20:23]
    v_mfma_f32_16x16x32_bf16 v[24:27], v[148:151], v[120:123], v[24:27]
    v_mfma_f32_16x16x32_bf16 v[28:31], v[148:151], v[124:127], v[28:31]
    v_mfma_f32_16x16x32_bf16 v[76:79], v[148:151], v[160:163], v[76:79]
    v_mfma_f32_16x16x32_bf16 v[36:39], v[152:155], v[112:115], v[36:39]
    v_mfma_f32_16x16x32_bf16 v[40:43], v[152:155], v[116:119], v[40:43]
    v_mfma_f32_16x16x32_bf16 v[44:47], v[152:155], v[120:123], v[44:47]
    v_mfma_f32_16x16x32_bf16 v[48:51], v[152:155], v[124:127], v[48:51]
    v_mfma_f32_16x16x32_bf16 v[52:55], v[152:155], v[128:131], v[52:55]
    v_mfma_f32_16x16x32_bf16 v[80:83], v[152:155], v[160:163], v[80:83]
    v_mfma_f32_16x16x32_bf16 v[56:59], v[156:159], v[112:115], v[56:59]
    v_mfma_f32_16x16x32_bf16 v[60:63], v[156:159], v[116:119], v[60:63]
    v_mfma_f32_16x16x32_bf16 v[64:67], v[156:159], v[120:123], v[64:67]
    v_mfma_f32_16x16x32_bf16 v[68:71], v[156:159], v[124:127], v[68:71]
    v_mfma_f32_16x16x32_bf16 v[72:75], v[156:159], v[128:131], v[72:75]
    v_mfma_f32_16x16x32_bf16 v[84:87], v[156:159], v[160:163], v[84:87]
    s_waitcnt lgkmcnt(0)
    ds_read_b64_tr_b16 v[148:149], v164 offset:38912
    ds_read_b64_tr_b16 v[150:151], v164 offset:39424
    ds_read_b64_tr_b16 v[152:153], v164 offset:47104
    ds_read_b64_tr_b16 v[154:155], v164 offset:47616
    ds_read_b64_tr_b16 v[156:157], v164 offset:55296
    ds_read_b64_tr_b16 v[158:159], v164 offset:55808
    ds_read_b128 v[112:115], v7 offset:36864
    ds_read_b128 v[116:119], v7 offset:38912
    ds_read_b128 v[120:123], v7 offset:40960
    ds_read_b128 v[124:127], v7 offset:43008
    ds_read_b128 v[128:131], v7 offset:34816
    v_mfma_f32_16x16x32_bf16 v[16:19], v[136:139], v[88:91], v[16:19]
    v_mfma_f32_16x16x32_bf16 v[20:23], v[136:139], v[92:95], v[20:23]
    v_mfma_f32_16x16x32_bf16 v[24:27], v[136:139], v[96:99], v[24:27]
    v_mfma_f32_16x16x32_bf16 v[28:31], v[136:139], v[100:103], v[28:31]
    v_mfma_f32_16x16x32_bf16 v[76:79], v[136:139], v[160:163], v[76:79]
    v_mfma_f32_16x16x32_bf16 v[36:39], v[140:143], v[88:91], v[36:39]
    v_mfma_f32_16x16x32_bf16 v[40:43], v[140:143], v[92:95], v[40:43]
    v_mfma_f32_16x16x32_bf16 v[44:47], v[140:143], v[96:99], v[44:47]
    v_mfma_f32_16x16x32_bf16 v[48:51], v[140:143], v[100:103], v[48:51]
    v_mfma_f32_16x16x32_bf16 v[52:55], v[140:143], v[104:107], v[52:55]
    v_mfma_f32_16x16x32_bf16 v[80:83], v[140:143], v[160:163], v[80:83]
    v_mfma_f32_16x16x32_bf16 v[56:59], v[144:147], v[88:91], v[56:59]
    v_mfma_f32_16x16x32_bf16 v[60:63], v[144:147], v[92:95], v[60:63]
    v_mfma_f32_16x16x32_bf16 v[64:67], v[144:147], v[96:99], v[64:67]
    v_mfma_f32_16x16x32_bf16 v[68:71], v[144:147], v[100:103], v[68:71]
    v_mfma_f32_16x16x32_bf16 v[72:75], v[144:147], v[104:107], v[72:75]
    v_mfma_f32_16x16x32_bf16 v[84:87], v[144:147], v[160:163], v[84:87]
    s_waitcnt lgkmcnt(0)
    s_barrier
    ds_read_b64_tr_b16 v[136:137], v169 offset:0
    ds_read_b64_tr_b16 v[138:139], v169 offset:512
    ds_read_b64_tr_b16 v[140:141], v169 offset:8192
    ds_read_b64_tr_b16 v[142:143], v169 offset:8704
    ds_read_b64_tr_b16 v[144:145], v169 offset:16384
    ds_read_b64_tr_b16 v[146:147], v169 offset:16896
    ds_read_b128 v[88:91], v165 offset:2048
    ds_read_b128 v[92:95], v165 offset:4096
    ds_read_b128 v[96:99], v165 offset:6144
    ds_read_b128 v[100:103], v165 offset:8192
    ds_read_b128 v[104:107], v165 offset:0
    v_mfma_f32_16x16x32_bf16 v[16:19], v[148:151], v[112:115], v[16:19]
    v_mfma_f32_16x16x32_bf16 v[20:23], v[148:151], v[116:119], v[20:23]
    v_mfma_f32_16x16x32_bf16 v[24:27], v[148:151], v[120:123], v[24:27]
    v_mfma_f32_16x16x32_bf16 v[28:31], v[148:151], v[124:127], v[28:31]
    v_mfma_f32_16x16x32_bf16 v[76:79], v[148:151], v[160:163], v[76:79]
    v_mfma_f32_16x16x32_bf16 v[36:39], v[152:155], v[112:115], v[36:39]
    v_mfma_f32_16x16x32_bf16 v[40:43], v[152:155], v[116:119], v[40:43]
    v_mfma_f32_16x16x32_bf16 v[44:47], v[152:155], v[120:123], v[44:47]
    v_mfma_f32_16x16x32_bf16 v[48:51], v[152:155], v[124:127], v[48:51]
    v_mfma_f32_16x16x32_bf16 v[52:55], v[152:155], v[128:131], v[52:55]
    v_mfma_f32_16x16x32_bf16 v[80:83], v[152:155], v[160:163], v[80:83]
    v_mfma_f32_16x16x32_bf16 v[56:59], v[156:159], v[112:115], v[56:59]
    v_mfma_f32_16x16x32_bf16 v[60:63], v[156:159], v[116:119], v[60:63]
    v_mfma_f32_16x16x32_bf16 v[64:67], v[156:159], v[120:123], v[64:67]
    v_mfma_f32_16x16x32_bf16 v[68:71], v[156:159], v[124:127], v[68:71]
    v_mfma_f32_16x16x32_bf16 v[72:75], v[156:159], v[128:131], v[72:75]
    v_mfma_f32_16x16x32_bf16 v[84:87], v[156:159], v[160:163], v[84:87]
    s_waitcnt lgkmcnt(0)
    ds_read_b64_tr_b16 v[148:149], v169 offset:4096
    ds_read_b64_tr_b16 v[150:151], v169 offset:4608
    ds_read_b64_tr_b16 v[152:153], v169 offset:12288
    ds_read_b64_tr_b16 v[154:155], v169 offset:12800
    ds_read_b64_tr_b16 v[156:157], v169 offset:20480
    ds_read_b64_tr_b16 v[158:159], v169 offset:20992
    ds_read_b128 v[112:115], v166 offset:2048
    ds_read_b128 v[116:119], v166 offset:4096
    ds_read_b128 v[120:123], v166 offset:6144
    ds_read_b128 v[124:127], v166 offset:8192
    ds_read_b128 v[128:131], v166 offset:0
    v_mfma_f32_16x16x32_bf16 v[16:19], v[136:139], v[88:91], v[16:19]
    v_mfma_f32_16x16x32_bf16 v[20:23], v[136:139], v[92:95], v[20:23]
    v_mfma_f32_16x16x32_bf16 v[24:27], v[136:139], v[96:99], v[24:27]
    v_mfma_f32_16x16x32_bf16 v[28:31], v[136:139], v[100:103], v[28:31]
    v_mfma_f32_16x16x32_bf16 v[76:79], v[136:139], v[160:163], v[76:79]
    v_mfma_f32_16x16x32_bf16 v[36:39], v[140:143], v[88:91], v[36:39]
    v_mfma_f32_16x16x32_bf16 v[40:43], v[140:143], v[92:95], v[40:43]
    v_mfma_f32_16x16x32_bf16 v[44:47], v[140:143], v[96:99], v[44:47]
    v_mfma_f32_16x16x32_bf16 v[48:51], v[140:143], v[100:103], v[48:51]
    v_mfma_f32_16x16x32_bf16 v[52:55], v[140:143], v[104:107], v[52:55]
    v_mfma_f32_16x16x32_bf16 v[80:83], v[140:143], v[160:163], v[80:83]
    v_mfma_f32_16x16x32_bf16 v[56:59], v[144:147], v[88:91], v[56:59]
    v_mfma_f32_16x16x32_bf16 v[60:63], v[144:147], v[92:95], v[60:63]
    v_mfma_f32_16x16x32_bf16 v[64:67], v[144:147], v[96:99], v[64:67]
    v_mfma_f32_16x16x32_bf16 v[68:71], v[144:147], v[100:103], v[68:71]
    v_mfma_f32_16x16x32_bf16 v[72:75], v[144:147], v[104:107], v[72:75]
    v_mfma_f32_16x16x32_bf16 v[84:87], v[144:147], v[160:163], v[84:87]
    s_waitcnt lgkmcnt(0)
    s_barrier
    ds_read_b64_tr_b16 v[136:137], v169 offset:34816
    ds_read_b64_tr_b16 v[138:139], v169 offset:35328
    ds_read_b64_tr_b16 v[140:141], v169 offset:43008
    ds_read_b64_tr_b16 v[142:143], v169 offset:43520
    ds_read_b64_tr_b16 v[144:145], v169 offset:51200
    ds_read_b64_tr_b16 v[146:147], v169 offset:51712
    ds_read_b128 v[88:91], v165 offset:36864
    ds_read_b128 v[92:95], v165 offset:38912
    ds_read_b128 v[96:99], v165 offset:40960
    ds_read_b128 v[100:103], v165 offset:43008
    ds_read_b128 v[104:107], v165 offset:34816
    v_mfma_f32_16x16x32_bf16 v[16:19], v[148:151], v[112:115], v[16:19]
    v_mfma_f32_16x16x32_bf16 v[20:23], v[148:151], v[116:119], v[20:23]
    v_mfma_f32_16x16x32_bf16 v[24:27], v[148:151], v[120:123], v[24:27]
    v_mfma_f32_16x16x32_bf16 v[28:31], v[148:151], v[124:127], v[28:31]
    v_mfma_f32_16x16x32_bf16 v[76:79], v[148:151], v[160:163], v[76:79]
    v_mfma_f32_16x16x32_bf16 v[36:39], v[152:155], v[112:115], v[36:39]
    v_mfma_f32_16x16x32_bf16 v[40:43], v[152:155], v[116:119], v[40:43]
    v_mfma_f32_16x16x32_bf16 v[44:47], v[152:155], v[120:123], v[44:47]
    v_mfma_f32_16x16x32_bf16 v[48:51], v[152:155], v[124:127], v[48:51]
    v_mfma_f32_16x16x32_bf16 v[52:55], v[152:155], v[128:131], v[52:55]
    v_mfma_f32_16x16x32_bf16 v[80:83], v[152:155], v[160:163], v[80:83]
    v_mfma_f32_16x16x32_bf16 v[56:59], v[156:159], v[112:115], v[56:59]
    v_mfma_f32_16x16x32_bf16 v[60:63], v[156:159], v[116:119], v[60:63]
    v_mfma_f32_16x16x32_bf16 v[64:67], v[156:159], v[120:123], v[64:67]
    v_mfma_f32_16x16x32_bf16 v[68:71], v[156:159], v[124:127], v[68:71]
    v_mfma_f32_16x16x32_bf16 v[72:75], v[156:159], v[128:131], v[72:75]
    v_mfma_f32_16x16x32_bf16 v[84:87], v[156:159], v[160:163], v[84:87]
    s_waitcnt lgkmcnt(0)
    ds_read_b64_tr_b16 v[148:149], v169 offset:38912
    ds_read_b64_tr_b16 v[150:151], v169 offset:39424
    ds_read_b64_tr_b16 v[152:153], v169 offset:47104
    ds_read_b64_tr_b16 v[154:155], v169 offset:47616
    ds_read_b64_tr_b16 v[156:157], v169 offset:55296
    ds_read_b64_tr_b16 v[158:159], v169 offset:55808
    ds_read_b128 v[112:115], v166 offset:36864
    ds_read_b128 v[116:119], v166 offset:38912
    ds_read_b128 v[120:123], v166 offset:40960
    ds_read_b128 v[124:127], v166 offset:43008
    ds_read_b128 v[128:131], v166 offset:34816
    v_mfma_f32_16x16x32_bf16 v[16:19], v[136:139], v[88:91], v[16:19]
    v_mfma_f32_16x16x32_bf16 v[20:23], v[136:139], v[92:95], v[20:23]
    v_mfma_f32_16x16x32_bf16 v[24:27], v[136:139], v[96:99], v[24:27]
    v_mfma_f32_16x16x32_bf16 v[28:31], v[136:139], v[100:103], v[28:31]
    v_mfma_f32_16x16x32_bf16 v[76:79], v[136:139], v[160:163], v[76:79]
    v_mfma_f32_16x16x32_bf16 v[36:39], v[140:143], v[88:91], v[36:39]
    v_mfma_f32_16x16x32_bf16 v[40:43], v[140:143], v[92:95], v[40:43]
    v_mfma_f32_16x16x32_bf16 v[44:47], v[140:143], v[96:99], v[44:47]
    v_mfma_f32_16x16x32_bf16 v[48:51], v[140:143], v[100:103], v[48:51]
    v_mfma_f32_16x16x32_bf16 v[52:55], v[140:143], v[104:107], v[52:55]
    v_mfma_f32_16x16x32_bf16 v[80:83], v[140:143], v[160:163], v[80:83]
    v_mfma_f32_16x16x32_bf16 v[56:59], v[144:147], v[88:91], v[56:59]
    v_mfma_f32_16x16x32_bf16 v[60:63], v[144:147], v[92:95], v[60:63]
    v_mfma_f32_16x16x32_bf16 v[64:67], v[144:147], v[96:99], v[64:67]
    v_mfma_f32_16x16x32_bf16 v[68:71], v[144:147], v[100:103], v[68:71]
    v_mfma_f32_16x16x32_bf16 v[72:75], v[144:147], v[104:107], v[72:75]
    v_mfma_f32_16x16x32_bf16 v[84:87], v[144:147], v[160:163], v[84:87]
    s_waitcnt lgkmcnt(0)
    s_barrier
    ds_read_b64_tr_b16 v[136:137], v164 offset:0
    ds_read_b64_tr_b16 v[138:139], v164 offset:512
    ds_read_b64_tr_b16 v[140:141], v164 offset:8192
    ds_read_b64_tr_b16 v[142:143], v164 offset:8704
    ds_read_b64_tr_b16 v[144:145], v164 offset:16384
    ds_read_b64_tr_b16 v[146:147], v164 offset:16896
    ds_read_b128 v[88:91], v6 offset:2048
    ds_read_b128 v[92:95], v6 offset:4096
    ds_read_b128 v[96:99], v6 offset:6144
    ds_read_b128 v[100:103], v6 offset:8192
    ds_read_b128 v[104:107], v6 offset:0
    v_mfma_f32_16x16x32_bf16 v[16:19], v[148:151], v[112:115], v[16:19]
    v_mfma_f32_16x16x32_bf16 v[20:23], v[148:151], v[116:119], v[20:23]
    v_mfma_f32_16x16x32_bf16 v[24:27], v[148:151], v[120:123], v[24:27]
    v_mfma_f32_16x16x32_bf16 v[28:31], v[148:151], v[124:127], v[28:31]
    v_mfma_f32_16x16x32_bf16 v[76:79], v[148:151], v[160:163], v[76:79]
    v_mfma_f32_16x16x32_bf16 v[36:39], v[152:155], v[112:115], v[36:39]
    v_mfma_f32_16x16x32_bf16 v[40:43], v[152:155], v[116:119], v[40:43]
    v_mfma_f32_16x16x32_bf16 v[44:47], v[152:155], v[120:123], v[44:47]
    v_mfma_f32_16x16x32_bf16 v[48:51], v[152:155], v[124:127], v[48:51]
    v_mfma_f32_16x16x32_bf16 v[52:55], v[152:155], v[128:131], v[52:55]
    v_mfma_f32_16x16x32_bf16 v[80:83], v[152:155], v[160:163], v[80:83]
    v_mfma_f32_16x16x32_bf16 v[56:59], v[156:159], v[112:115], v[56:59]
    v_mfma_f32_16x16x32_bf16 v[60:63], v[156:159], v[116:119], v[60:63]
    v_mfma_f32_16x16x32_bf16 v[64:67], v[156:159], v[120:123], v[64:67]
    v_mfma_f32_16x16x32_bf16 v[68:71], v[156:159], v[124:127], v[68:71]
    v_mfma_f32_16x16x32_bf16 v[72:75], v[156:159], v[128:131], v[72:75]
    v_mfma_f32_16x16x32_bf16 v[84:87], v[156:159], v[160:163], v[84:87]
    s_waitcnt lgkmcnt(0)
    ds_read_b64_tr_b16 v[148:149], v164 offset:4096
    ds_read_b64_tr_b16 v[150:151], v164 offset:4608
    ds_read_b64_tr_b16 v[152:153], v164 offset:12288
    ds_read_b64_tr_b16 v[154:155], v164 offset:12800
    ds_read_b64_tr_b16 v[156:157], v164 offset:20480
    ds_read_b64_tr_b16 v[158:159], v164 offset:20992
    ds_read_b128 v[112:115], v7 offset:2048
    ds_read_b128 v[116:119], v7 offset:4096
    ds_read_b128 v[120:123], v7 offset:6144
    ds_read_b128 v[124:127], v7 offset:8192
    ds_read_b128 v[128:131], v7 offset:0
    v_mfma_f32_16x16x32_bf16 v[16:19], v[136:139], v[88:91], v[16:19]
    v_mfma_f32_16x16x32_bf16 v[20:23], v[136:139], v[92:95], v[20:23]
    v_mfma_f32_16x16x32_bf16 v[24:27], v[136:139], v[96:99], v[24:27]
    v_mfma_f32_16x16x32_bf16 v[28:31], v[136:139], v[100:103], v[28:31]
    v_mfma_f32_16x16x32_bf16 v[76:79], v[136:139], v[160:163], v[76:79]
    v_mfma_f32_16x16x32_bf16 v[36:39], v[140:143], v[88:91], v[36:39]
    v_mfma_f32_16x16x32_bf16 v[40:43], v[140:143], v[92:95], v[40:43]
    v_mfma_f32_16x16x32_bf16 v[44:47], v[140:143], v[96:99], v[44:47]
    v_mfma_f32_16x16x32_bf16 v[48:51], v[140:143], v[100:103], v[48:51]
    v_mfma_f32_16x16x32_bf16 v[52:55], v[140:143], v[104:107], v[52:55]
    v_mfma_f32_16x16x32_bf16 v[80:83], v[140:143], v[160:163], v[80:83]
    v_mfma_f32_16x16x32_bf16 v[56:59], v[144:147], v[88:91], v[56:59]
    v_mfma_f32_16x16x32_bf16 v[60:63], v[144:147], v[92:95], v[60:63]
    v_mfma_f32_16x16x32_bf16 v[64:67], v[144:147], v[96:99], v[64:67]
    v_mfma_f32_16x16x32_bf16 v[68:71], v[144:147], v[100:103], v[68:71]
    v_mfma_f32_16x16x32_bf16 v[72:75], v[144:147], v[104:107], v[72:75]
    v_mfma_f32_16x16x32_bf16 v[84:87], v[144:147], v[160:163], v[84:87]
    s_waitcnt lgkmcnt(0)
    s_barrier
    ds_read_b64_tr_b16 v[136:137], v164 offset:34816
    ds_read_b64_tr_b16 v[138:139], v164 offset:35328
    ds_read_b64_tr_b16 v[140:141], v164 offset:43008
    ds_read_b64_tr_b16 v[142:143], v164 offset:43520
    ds_read_b64_tr_b16 v[144:145], v164 offset:51200
    ds_read_b64_tr_b16 v[146:147], v164 offset:51712
    ds_read_b128 v[88:91], v6 offset:36864
    ds_read_b128 v[92:95], v6 offset:38912
    ds_read_b128 v[96:99], v6 offset:40960
    ds_read_b128 v[100:103], v6 offset:43008
    ds_read_b128 v[104:107], v6 offset:34816
    v_mfma_f32_16x16x32_bf16 v[16:19], v[148:151], v[112:115], v[16:19]
    v_mfma_f32_16x16x32_bf16 v[20:23], v[148:151], v[116:119], v[20:23]
    v_mfma_f32_16x16x32_bf16 v[24:27], v[148:151], v[120:123], v[24:27]
    v_mfma_f32_16x16x32_bf16 v[28:31], v[148:151], v[124:127], v[28:31]
    v_mfma_f32_16x16x32_bf16 v[76:79], v[148:151], v[160:163], v[76:79]
    v_mfma_f32_16x16x32_bf16 v[36:39], v[152:155], v[112:115], v[36:39]
    v_mfma_f32_16x16x32_bf16 v[40:43], v[152:155], v[116:119], v[40:43]
    v_mfma_f32_16x16x32_bf16 v[44:47], v[152:155], v[120:123], v[44:47]
    v_mfma_f32_16x16x32_bf16 v[48:51], v[152:155], v[124:127], v[48:51]
    v_mfma_f32_16x16x32_bf16 v[52:55], v[152:155], v[128:131], v[52:55]
    v_mfma_f32_16x16x32_bf16 v[80:83], v[152:155], v[160:163], v[80:83]
    v_mfma_f32_16x16x32_bf16 v[56:59], v[156:159], v[112:115], v[56:59]
    v_mfma_f32_16x16x32_bf16 v[60:63], v[156:159], v[116:119], v[60:63]
    v_mfma_f32_16x16x32_bf16 v[64:67], v[156:159], v[120:123], v[64:67]
    v_mfma_f32_16x16x32_bf16 v[68:71], v[156:159], v[124:127], v[68:71]
    v_mfma_f32_16x16x32_bf16 v[72:75], v[156:159], v[128:131], v[72:75]
    v_mfma_f32_16x16x32_bf16 v[84:87], v[156:159], v[160:163], v[84:87]
    s_waitcnt lgkmcnt(0)
    ds_read_b64_tr_b16 v[148:149], v164 offset:38912
    ds_read_b64_tr_b16 v[150:151], v164 offset:39424
    ds_read_b64_tr_b16 v[152:153], v164 offset:47104
    ds_read_b64_tr_b16 v[154:155], v164 offset:47616
    ds_read_b64_tr_b16 v[156:157], v164 offset:55296
    ds_read_b64_tr_b16 v[158:159], v164 offset:55808
    ds_read_b128 v[112:115], v7 offset:36864
    ds_read_b128 v[116:119], v7 offset:38912
    ds_read_b128 v[120:123], v7 offset:40960
    ds_read_b128 v[124:127], v7 offset:43008
    ds_read_b128 v[128:131], v7 offset:34816
    v_mfma_f32_16x16x32_bf16 v[16:19], v[136:139], v[88:91], v[16:19]
    v_mfma_f32_16x16x32_bf16 v[20:23], v[136:139], v[92:95], v[20:23]
    v_mfma_f32_16x16x32_bf16 v[24:27], v[136:139], v[96:99], v[24:27]
    v_mfma_f32_16x16x32_bf16 v[28:31], v[136:139], v[100:103], v[28:31]
    v_mfma_f32_16x16x32_bf16 v[76:79], v[136:139], v[160:163], v[76:79]
    v_mfma_f32_16x16x32_bf16 v[36:39], v[140:143], v[88:91], v[36:39]
    v_mfma_f32_16x16x32_bf16 v[40:43], v[140:143], v[92:95], v[40:43]
    v_mfma_f32_16x16x32_bf16 v[44:47], v[140:143], v[96:99], v[44:47]
    v_mfma_f32_16x16x32_bf16 v[48:51], v[140:143], v[100:103], v[48:51]
    v_mfma_f32_16x16x32_bf16 v[52:55], v[140:143], v[104:107], v[52:55]
    v_mfma_f32_16x16x32_bf16 v[80:83], v[140:143], v[160:163], v[80:83]
    v_mfma_f32_16x16x32_bf16 v[56:59], v[144:147], v[88:91], v[56:59]
    v_mfma_f32_16x16x32_bf16 v[60:63], v[144:147], v[92:95], v[60:63]
    v_mfma_f32_16x16x32_bf16 v[64:67], v[144:147], v[96:99], v[64:67]
    v_mfma_f32_16x16x32_bf16 v[68:71], v[144:147], v[100:103], v[68:71]
    v_mfma_f32_16x16x32_bf16 v[72:75], v[144:147], v[104:107], v[72:75]
    v_mfma_f32_16x16x32_bf16 v[84:87], v[144:147], v[160:163], v[84:87]
    s_waitcnt lgkmcnt(0)
    s_barrier
    ds_read_b64_tr_b16 v[136:137], v169 offset:0
    ds_read_b64_tr_b16 v[138:139], v169 offset:512
    ds_read_b64_tr_b16 v[140:141], v169 offset:8192
    ds_read_b64_tr_b16 v[142:143], v169 offset:8704
    ds_read_b64_tr_b16 v[144:145], v169 offset:16384
    ds_read_b64_tr_b16 v[146:147], v169 offset:16896
    ds_read_b128 v[88:91], v165 offset:2048
    ds_read_b128 v[92:95], v165 offset:4096
    ds_read_b128 v[96:99], v165 offset:6144
    ds_read_b128 v[100:103], v165 offset:8192
    ds_read_b128 v[104:107], v165 offset:0
    v_mfma_f32_16x16x32_bf16 v[16:19], v[148:151], v[112:115], v[16:19]
    v_mfma_f32_16x16x32_bf16 v[20:23], v[148:151], v[116:119], v[20:23]
    v_mfma_f32_16x16x32_bf16 v[24:27], v[148:151], v[120:123], v[24:27]
    v_mfma_f32_16x16x32_bf16 v[28:31], v[148:151], v[124:127], v[28:31]
    v_mfma_f32_16x16x32_bf16 v[76:79], v[148:151], v[160:163], v[76:79]
    v_mfma_f32_16x16x32_bf16 v[36:39], v[152:155], v[112:115], v[36:39]
    v_mfma_f32_16x16x32_bf16 v[40:43], v[152:155], v[116:119], v[40:43]
    v_mfma_f32_16x16x32_bf16 v[44:47], v[152:155], v[120:123], v[44:47]
    v_mfma_f32_16x16x32_bf16 v[48:51], v[152:155], v[124:127], v[48:51]
    v_mfma_f32_16x16x32_bf16 v[52:55], v[152:155], v[128:131], v[52:55]
    v_mfma_f32_16x16x32_bf16 v[80:83], v[152:155], v[160:163], v[80:83]
    v_mfma_f32_16x16x32_bf16 v[56:59], v[156:159], v[112:115], v[56:59]
    v_mfma_f32_16x16x32_bf16 v[60:63], v[156:159], v[116:119], v[60:63]
    v_mfma_f32_16x16x32_bf16 v[64:67], v[156:159], v[120:123], v[64:67]
    v_mfma_f32_16x16x32_bf16 v[68:71], v[156:159], v[124:127], v[68:71]
    v_mfma_f32_16x16x32_bf16 v[72:75], v[156:159], v[128:131], v[72:75]
    v_mfma_f32_16x16x32_bf16 v[84:87], v[156:159], v[160:163], v[84:87]
    s_waitcnt lgkmcnt(0)
    ds_read_b64_tr_b16 v[148:149], v169 offset:4096
    ds_read_b64_tr_b16 v[150:151], v169 offset:4608
    ds_read_b64_tr_b16 v[152:153], v169 offset:12288
    ds_read_b64_tr_b16 v[154:155], v169 offset:12800
    ds_read_b64_tr_b16 v[156:157], v169 offset:20480
    ds_read_b64_tr_b16 v[158:159], v169 offset:20992
    ds_read_b128 v[112:115], v166 offset:2048
    ds_read_b128 v[116:119], v166 offset:4096
    ds_read_b128 v[120:123], v166 offset:6144
    ds_read_b128 v[124:127], v166 offset:8192
    ds_read_b128 v[128:131], v166 offset:0
    v_mfma_f32_16x16x32_bf16 v[16:19], v[136:139], v[88:91], v[16:19]
    v_mfma_f32_16x16x32_bf16 v[20:23], v[136:139], v[92:95], v[20:23]
    v_mfma_f32_16x16x32_bf16 v[24:27], v[136:139], v[96:99], v[24:27]
    v_mfma_f32_16x16x32_bf16 v[28:31], v[136:139], v[100:103], v[28:31]
    v_mfma_f32_16x16x32_bf16 v[76:79], v[136:139], v[160:163], v[76:79]
    v_mfma_f32_16x16x32_bf16 v[36:39], v[140:143], v[88:91], v[36:39]
    v_mfma_f32_16x16x32_bf16 v[40:43], v[140:143], v[92:95], v[40:43]
    v_mfma_f32_16x16x32_bf16 v[44:47], v[140:143], v[96:99], v[44:47]
    v_mfma_f32_16x16x32_bf16 v[48:51], v[140:143], v[100:103], v[48:51]
    v_mfma_f32_16x16x32_bf16 v[52:55], v[140:143], v[104:107], v[52:55]
    v_mfma_f32_16x16x32_bf16 v[80:83], v[140:143], v[160:163], v[80:83]
    v_mfma_f32_16x16x32_bf16 v[56:59], v[144:147], v[88:91], v[56:59]
    v_mfma_f32_16x16x32_bf16 v[60:63], v[144:147], v[92:95], v[60:63]
    v_mfma_f32_16x16x32_bf16 v[64:67], v[144:147], v[96:99], v[64:67]
    v_mfma_f32_16x16x32_bf16 v[68:71], v[144:147], v[100:103], v[68:71]
    v_mfma_f32_16x16x32_bf16 v[72:75], v[144:147], v[104:107], v[72:75]
    v_mfma_f32_16x16x32_bf16 v[84:87], v[144:147], v[160:163], v[84:87]
    s_waitcnt lgkmcnt(0)
    s_barrier
    ds_read_b64_tr_b16 v[136:137], v169 offset:34816
    ds_read_b64_tr_b16 v[138:139], v169 offset:35328
    ds_read_b64_tr_b16 v[140:141], v169 offset:43008
    ds_read_b64_tr_b16 v[142:143], v169 offset:43520
    ds_read_b64_tr_b16 v[144:145], v169 offset:51200
    ds_read_b64_tr_b16 v[146:147], v169 offset:51712
    ds_read_b128 v[88:91], v165 offset:36864
    ds_read_b128 v[92:95], v165 offset:38912
    ds_read_b128 v[96:99], v165 offset:40960
    ds_read_b128 v[100:103], v165 offset:43008
    ds_read_b128 v[104:107], v165 offset:34816
    v_mfma_f32_16x16x32_bf16 v[16:19], v[148:151], v[112:115], v[16:19]
    v_mfma_f32_16x16x32_bf16 v[20:23], v[148:151], v[116:119], v[20:23]
    v_mfma_f32_16x16x32_bf16 v[24:27], v[148:151], v[120:123], v[24:27]
    v_mfma_f32_16x16x32_bf16 v[28:31], v[148:151], v[124:127], v[28:31]
    v_mfma_f32_16x16x32_bf16 v[76:79], v[148:151], v[160:163], v[76:79]
    v_mfma_f32_16x16x32_bf16 v[36:39], v[152:155], v[112:115], v[36:39]
    v_mfma_f32_16x16x32_bf16 v[40:43], v[152:155], v[116:119], v[40:43]
    v_mfma_f32_16x16x32_bf16 v[44:47], v[152:155], v[120:123], v[44:47]
    v_mfma_f32_16x16x32_bf16 v[48:51], v[152:155], v[124:127], v[48:51]
    v_mfma_f32_16x16x32_bf16 v[52:55], v[152:155], v[128:131], v[52:55]
    v_mfma_f32_16x16x32_bf16 v[80:83], v[152:155], v[160:163], v[80:83]
    v_mfma_f32_16x16x32_bf16 v[56:59], v[156:159], v[112:115], v[56:59]
    v_mfma_f32_16x16x32_bf16 v[60:63], v[156:159], v[116:119], v[60:63]
    v_mfma_f32_16x16x32_bf16 v[64:67], v[156:159], v[120:123], v[64:67]
    v_mfma_f32_16x16x32_bf16 v[68:71], v[156:159], v[124:127], v[68:71]
    v_mfma_f32_16x16x32_bf16 v[72:75], v[156:159], v[128:131], v[72:75]
    v_mfma_f32_16x16x32_bf16 v[84:87], v[156:159], v[160:163], v[84:87]
    s_waitcnt lgkmcnt(0)
    ds_read_b64_tr_b16 v[148:149], v169 offset:38912
    ds_read_b64_tr_b16 v[150:151], v169 offset:39424
    ds_read_b64_tr_b16 v[152:153], v169 offset:47104
    ds_read_b64_tr_b16 v[154:155], v169 offset:47616
    ds_read_b64_tr_b16 v[156:157], v169 offset:55296
    ds_read_b64_tr_b16 v[158:159], v169 offset:55808
    ds_read_b128 v[112:115], v166 offset:36864
    ds_read_b128 v[116:119], v166 offset:38912
    ds_read_b128 v[120:123], v166 offset:40960
    ds_read_b128 v[124:127], v166 offset:43008
    ds_read_b128 v[128:131], v166 offset:34816
    v_mfma_f32_16x16x32_bf16 v[16:19], v[136:139], v[88:91], v[16:19]
    v_mfma_f32_16x16x32_bf16 v[20:23], v[136:139], v[92:95], v[20:23]
    v_mfma_f32_16x16x32_bf16 v[24:27], v[136:139], v[96:99], v[24:27]
    v_mfma_f32_16x16x32_bf16 v[28:31], v[136:139], v[100:103], v[28:31]
    v_mfma_f32_16x16x32_bf16 v[76:79], v[136:139], v[160:163], v[76:79]
    v_mfma_f32_16x16x32_bf16 v[36:39], v[140:143], v[88:91], v[36:39]
    v_mfma_f32_16x16x32_bf16 v[40:43], v[140:143], v[92:95], v[40:43]
    v_mfma_f32_16x16x32_bf16 v[44:47], v[140:143], v[96:99], v[44:47]
    v_mfma_f32_16x16x32_bf16 v[48:51], v[140:143], v[100:103], v[48:51]
    v_mfma_f32_16x16x32_bf16 v[52:55], v[140:143], v[104:107], v[52:55]
    v_mfma_f32_16x16x32_bf16 v[80:83], v[140:143], v[160:163], v[80:83]
    v_mfma_f32_16x16x32_bf16 v[56:59], v[144:147], v[88:91], v[56:59]
    v_mfma_f32_16x16x32_bf16 v[60:63], v[144:147], v[92:95], v[60:63]
    v_mfma_f32_16x16x32_bf16 v[64:67], v[144:147], v[96:99], v[64:67]
    v_mfma_f32_16x16x32_bf16 v[68:71], v[144:147], v[100:103], v[68:71]
    v_mfma_f32_16x16x32_bf16 v[72:75], v[144:147], v[104:107], v[72:75]
    v_mfma_f32_16x16x32_bf16 v[84:87], v[144:147], v[160:163], v[84:87]
    s_waitcnt lgkmcnt(0)
    v_mfma_f32_16x16x32_bf16 v[16:19], v[148:151], v[112:115], v[16:19]
    v_mfma_f32_16x16x32_bf16 v[20:23], v[148:151], v[116:119], v[20:23]
    v_mfma_f32_16x16x32_bf16 v[24:27], v[148:151], v[120:123], v[24:27]
    v_mfma_f32_16x16x32_bf16 v[28:31], v[148:151], v[124:127], v[28:31]
    v_mfma_f32_16x16x32_bf16 v[76:79], v[148:151], v[160:163], v[76:79]
    v_mfma_f32_16x16x32_bf16 v[36:39], v[152:155], v[112:115], v[36:39]
    v_mfma_f32_16x16x32_bf16 v[40:43], v[152:155], v[116:119], v[40:43]
    v_mfma_f32_16x16x32_bf16 v[44:47], v[152:155], v[120:123], v[44:47]
    v_mfma_f32_16x16x32_bf16 v[48:51], v[152:155], v[124:127], v[48:51]
    v_mfma_f32_16x16x32_bf16 v[52:55], v[152:155], v[128:131], v[52:55]
    v_mfma_f32_16x16x32_bf16 v[80:83], v[152:155], v[160:163], v[80:83]
    v_mfma_f32_16x16x32_bf16 v[56:59], v[156:159], v[112:115], v[56:59]
    v_mfma_f32_16x16x32_bf16 v[60:63], v[156:159], v[116:119], v[60:63]
    v_mfma_f32_16x16x32_bf16 v[64:67], v[156:159], v[120:123], v[64:67]
    v_mfma_f32_16x16x32_bf16 v[68:71], v[156:159], v[124:127], v[68:71]
    v_mfma_f32_16x16x32_bf16 v[72:75], v[156:159], v[128:131], v[72:75]
    v_mfma_f32_16x16x32_bf16 v[84:87], v[156:159], v[160:163], v[84:87]
    s_mov_b32 s52, 0xffff0000
    s_mov_b32 s53, 0x3b000000
    s_mov_b32 s54, 0x3727c5ac
    v_lshlrev_b32 v13, 3, v10
    s_barrier
    ds_read_b64 v[90:91], v13 offset:0
    ds_read_b64 v[92:93], v13 offset:128
    ds_read_b64 v[94:95], v13 offset:256
    ds_read_b64 v[96:97], v13 offset:384
    ds_read_b64 v[98:99], v13 offset:512
    v_mul_u32_u24 v14, 112, v10
    v_lshl_add_u32 v14, v12, 3, v14
    s_mul_i32 s34, s30, 8960
    v_add_u32 v14, s34, v14
    s_waitcnt lgkmcnt(0)
    v_pk_fma_f32 v[16:17], v[90:91], v[76:77], v[16:17] op_sel_hi:[0,1,1] neg_lo:[1,0,0] neg_hi:[1,0,0]
    v_pk_fma_f32 v[18:19], v[90:91], v[78:79], v[18:19] op_sel_hi:[0,1,1] neg_lo:[1,0,0] neg_hi:[1,0,0]
    v_pk_mul_f32 v[16:17], v[16:17], v[90:91] op_sel:[0,1] op_sel_hi:[1,1]
    v_pk_mul_f32 v[18:19], v[18:19], v[90:91] op_sel:[0,1] op_sel_hi:[1,1]
    v_cvt_pk_bf16_f32 v16, v16, v17
    v_cvt_pk_bf16_f32 v17, v18, v19
    ds_write_b64 v14, v[16:17] offset:2816
    v_pk_fma_f32 v[20:21], v[92:93], v[76:77], v[20:21] op_sel_hi:[0,1,1] neg_lo:[1,0,0] neg_hi:[1,0,0]
    v_pk_fma_f32 v[22:23], v[92:93], v[78:79], v[22:23] op_sel_hi:[0,1,1] neg_lo:[1,0,0] neg_hi:[1,0,0]
    v_pk_mul_f32 v[20:21], v[20:21], v[92:93] op_sel:[0,1] op_sel_hi:[1,1]
    v_pk_mul_f32 v[22:23], v[22:23], v[92:93] op_sel:[0,1] op_sel_hi:[1,1]
    v_cvt_pk_bf16_f32 v20, v20, v21
    v_cvt_pk_bf16_f32 v21, v22, v23
    ds_write_b64 v14, v[20:21] offset:4608
    v_pk_fma_f32 v[24:25], v[94:95], v[76:77], v[24:25] op_sel_hi:[0,1,1] neg_lo:[1,0,0] neg_hi:[1,0,0]
    v_pk_fma_f32 v[26:27], v[94:95], v[78:79], v[26:27] op_sel_hi:[0,1,1] neg_lo:[1,0,0] neg_hi:[1,0,0]
    v_pk_mul_f32 v[24:25], v[24:25], v[94:95] op_sel:[0,1] op_sel_hi:[1,1]
    v_pk_mul_f32 v[26:27], v[26:27], v[94:95] op_sel:[0,1] op_sel_hi:[1,1]
    v_cvt_pk_bf16_f32 v24, v24, v25
    v_cvt_pk_bf16_f32 v25, v26, v27
    ds_write_b64 v14, v[24:25] offset:6400
    v_pk_fma_f32 v[28:29], v[96:97], v[76:77], v[28:29] op_sel_hi:[0,1,1] neg_lo:[1,0,0] neg_hi:[1,0,0]
    v_pk_fma_f32 v[30:31], v[96:97], v[78:79], v[30:31] op_sel_hi:[0,1,1] neg_lo:[1,0,0] neg_hi:[1,0,0]
    v_pk_mul_f32 v[28:29], v[28:29], v[96:97] op_sel:[0,1] op_sel_hi:[1,1]
    v_pk_mul_f32 v[30:31], v[30:31], v[96:97] op_sel:[0,1] op_sel_hi:[1,1]
    v_cvt_pk_bf16_f32 v28, v28, v29
    v_cvt_pk_bf16_f32 v29, v30, v31
    ds_write_b64 v14, v[28:29] offset:8192
    v_pk_fma_f32 v[36:37], v[90:91], v[80:81], v[36:37] op_sel_hi:[0,1,1] neg_lo:[1,0,0] neg_hi:[1,0,0]
    v_pk_fma_f32 v[38:39], v[90:91], v[82:83], v[38:39] op_sel_hi:[0,1,1] neg_lo:[1,0,0] neg_hi:[1,0,0]
    v_pk_mul_f32 v[36:37], v[36:37], v[90:91] op_sel:[0,1] op_sel_hi:[1,1]
    v_pk_mul_f32 v[38:39], v[38:39], v[90:91] op_sel:[0,1] op_sel_hi:[1,1]
    v_cvt_pk_bf16_f32 v36, v36, v37
    v_cvt_pk_bf16_f32 v37, v38, v39
    ds_write_b64 v14, v[36:37] offset:2848
    v_pk_fma_f32 v[40:41], v[92:93], v[80:81], v[40:41] op_sel_hi:[0,1,1] neg_lo:[1,0,0] neg_hi:[1,0,0]
    v_pk_fma_f32 v[42:43], v[92:93], v[82:83], v[42:43] op_sel_hi:[0,1,1] neg_lo:[1,0,0] neg_hi:[1,0,0]
    v_pk_mul_f32 v[40:41], v[40:41], v[92:93] op_sel:[0,1] op_sel_hi:[1,1]
    v_pk_mul_f32 v[42:43], v[42:43], v[92:93] op_sel:[0,1] op_sel_hi:[1,1]
    v_cvt_pk_bf16_f32 v40, v40, v41
    v_cvt_pk_bf16_f32 v41, v42, v43
    ds_write_b64 v14, v[40:41] offset:4640
    v_pk_fma_f32 v[44:45], v[94:95], v[80:81], v[44:45] op_sel_hi:[0,1,1] neg_lo:[1,0,0] neg_hi:[1,0,0]
    v_pk_fma_f32 v[46:47], v[94:95], v[82:83], v[46:47] op_sel_hi:[0,1,1] neg_lo:[1,0,0] neg_hi:[1,0,0]
    v_pk_mul_f32 v[44:45], v[44:45], v[94:95] op_sel:[0,1] op_sel_hi:[1,1]
    v_pk_mul_f32 v[46:47], v[46:47], v[94:95] op_sel:[0,1] op_sel_hi:[1,1]
    v_cvt_pk_bf16_f32 v44, v44, v45
    v_cvt_pk_bf16_f32 v45, v46, v47
    ds_write_b64 v14, v[44:45] offset:6432
    v_pk_fma_f32 v[48:49], v[96:97], v[80:81], v[48:49] op_sel_hi:[0,1,1] neg_lo:[1,0,0] neg_hi:[1,0,0]
    v_pk_fma_f32 v[50:51], v[96:97], v[82:83], v[50:51] op_sel_hi:[0,1,1] neg_lo:[1,0,0] neg_hi:[1,0,0]
    v_pk_mul_f32 v[48:49], v[48:49], v[96:97] op_sel:[0,1] op_sel_hi:[1,1]
    v_pk_mul_f32 v[50:51], v[50:51], v[96:97] op_sel:[0,1] op_sel_hi:[1,1]
    v_cvt_pk_bf16_f32 v48, v48, v49
    v_cvt_pk_bf16_f32 v49, v50, v51
    ds_write_b64 v14, v[48:49] offset:8224
    v_pk_fma_f32 v[52:53], v[98:99], v[80:81], v[52:53] op_sel_hi:[0,1,1] neg_lo:[1,0,0] neg_hi:[1,0,0]
    v_pk_fma_f32 v[54:55], v[98:99], v[82:83], v[54:55] op_sel_hi:[0,1,1] neg_lo:[1,0,0] neg_hi:[1,0,0]
    v_pk_mul_f32 v[52:53], v[52:53], v[98:99] op_sel:[0,1] op_sel_hi:[1,1]
    v_pk_mul_f32 v[54:55], v[54:55], v[98:99] op_sel:[0,1] op_sel_hi:[1,1]
    v_cvt_pk_bf16_f32 v52, v52, v53
    v_cvt_pk_bf16_f32 v53, v54, v55
    ds_write_b64 v14, v[52:53] offset:1056
    v_pk_fma_f32 v[56:57], v[90:91], v[84:85], v[56:57] op_sel_hi:[0,1,1] neg_lo:[1,0,0] neg_hi:[1,0,0]
    v_pk_fma_f32 v[58:59], v[90:91], v[86:87], v[58:59] op_sel_hi:[0,1,1] neg_lo:[1,0,0] neg_hi:[1,0,0]
    v_pk_mul_f32 v[56:57], v[56:57], v[90:91] op_sel:[0,1] op_sel_hi:[1,1]
    v_pk_mul_f32 v[58:59], v[58:59], v[90:91] op_sel:[0,1] op_sel_hi:[1,1]
    v_cvt_pk_bf16_f32 v56, v56, v57
    v_cvt_pk_bf16_f32 v57, v58, v59
    ds_write_b64 v14, v[56:57] offset:2880
    v_pk_fma_f32 v[60:61], v[92:93], v[84:85], v[60:61] op_sel_hi:[0,1,1] neg_lo:[1,0,0] neg_hi:[1,0,0]
    v_pk_fma_f32 v[62:63], v[92:93], v[86:87], v[62:63] op_sel_hi:[0,1,1] neg_lo:[1,0,0] neg_hi:[1,0,0]
    v_pk_mul_f32 v[60:61], v[60:61], v[92:93] op_sel:[0,1] op_sel_hi:[1,1]
    v_pk_mul_f32 v[62:63], v[62:63], v[92:93] op_sel:[0,1] op_sel_hi:[1,1]
    v_cvt_pk_bf16_f32 v60, v60, v61
    v_cvt_pk_bf16_f32 v61, v62, v63
    ds_write_b64 v14, v[60:61] offset:4672
    v_pk_fma_f32 v[64:65], v[94:95], v[84:85], v[64:65] op_sel_hi:[0,1,1] neg_lo:[1,0,0] neg_hi:[1,0,0]
    v_pk_fma_f32 v[66:67], v[94:95], v[86:87], v[66:67] op_sel_hi:[0,1,1] neg_lo:[1,0,0] neg_hi:[1,0,0]
    v_pk_mul_f32 v[64:65], v[64:65], v[94:95] op_sel:[0,1] op_sel_hi:[1,1]
    v_pk_mul_f32 v[66:67], v[66:67], v[94:95] op_sel:[0,1] op_sel_hi:[1,1]
    v_cvt_pk_bf16_f32 v64, v64, v65
    v_cvt_pk_bf16_f32 v65, v66, v67
    ds_write_b64 v14, v[64:65] offset:6464
    v_pk_fma_f32 v[68:69], v[96:97], v[84:85], v[68:69] op_sel_hi:[0,1,1] neg_lo:[1,0,0] neg_hi:[1,0,0]
    v_pk_fma_f32 v[70:71], v[96:97], v[86:87], v[70:71] op_sel_hi:[0,1,1] neg_lo:[1,0,0] neg_hi:[1,0,0]
    v_pk_mul_f32 v[68:69], v[68:69], v[96:97] op_sel:[0,1] op_sel_hi:[1,1]
    v_pk_mul_f32 v[70:71], v[70:71], v[96:97] op_sel:[0,1] op_sel_hi:[1,1]
    v_cvt_pk_bf16_f32 v68, v68, v69
    v_cvt_pk_bf16_f32 v69, v70, v71
    ds_write_b64 v14, v[68:69] offset:8256
    v_pk_fma_f32 v[72:73], v[98:99], v[84:85], v[72:73] op_sel_hi:[0,1,1] neg_lo:[1,0,0] neg_hi:[1,0,0]
    v_pk_fma_f32 v[74:75], v[98:99], v[86:87], v[74:75] op_sel_hi:[0,1,1] neg_lo:[1,0,0] neg_hi:[1,0,0]
    v_pk_mul_f32 v[72:73], v[72:73], v[98:99] op_sel:[0,1] op_sel_hi:[1,1]
    v_pk_mul_f32 v[74:75], v[74:75], v[98:99] op_sel:[0,1] op_sel_hi:[1,1]
    v_cvt_pk_bf16_f32 v72, v72, v73
    v_cvt_pk_bf16_f32 v73, v74, v75
    ds_write_b64 v14, v[72:73] offset:1088
L_k1l1_attn:
    s_waitcnt lgkmcnt(0)
    s_barrier
    s_lshr_b32 s34, s30, 2
    s_lshl_b32 s34, s34, 5
    v_and_b32 v2, 31, v1
    v_add_u32 v2, s34, v2
    v_lshrrev_b32 v8, 5, v1
    v_add_u32 v3, s31, v2
    v_lshlrev_b32 v9, 3, v8
    v_sub_u32 v7, v3, v9
    v_sub_u32 v4, v2, v9
    v_add_u32 v4, 10, v4
    v_mul_u32_u24 v4, 112, v4
    s_and_b32 s36, s30, 3
    s_mul_i32 s34, s36, 8960
    v_add_u32 v4, s34, v4
    v_add_u32 v6, 16, v2
    v_mul_u32_u24 v6, 112, v6
    v_add_u32 v6, s34, v6
    ds_read_b128 v[16:19], v6 offset:1024
    ds_read_b128 v[20:23], v6 offset:1040
    ds_read_b128 v[24:27], v4 offset:1728
    ds_read_b128 v[28:31], v4 offset:1744
    ds_read_b128 v[32:35], v4 offset:1504
    ds_read_b128 v[36:39], v4 offset:1520
    ds_read_b128 v[40:43], v4 offset:1280
    ds_read_b128 v[44:47], v4 offset:1296
    ds_read_b128 v[48:51], v4 offset:1056
    ds_read_b128 v[52:55], v4 offset:1072
    ds_read_b128 v[56:59], v4 offset:1760
    ds_read_b128 v[60:63], v4 offset:1776
    ds_read_b128 v[64:67], v4 offset:1536
    ds_read_b128 v[68:71], v4 offset:1552
    s_waitcnt lgkmcnt(4)
    ds_read_b128 v[72:75], v4 offset:1312
    ds_read_b128 v[76:79], v4 offset:1328
    ds_read_b128 v[80:83], v4 offset:1088
    ds_read_b128 v[84:87], v4 offset:1104
    v_dot2_f32_bf16 v88, v16, v24, 0
    v_dot2_f32_bf16 v89, v16, v32, 0
    v_dot2_f32_bf16 v90, v16, v40, 0
    v_dot2_f32_bf16 v91, v16, v48, 0
    v_dot2_f32_bf16 v88, v17, v25, v88
    v_dot2_f32_bf16 v89, v17, v33, v89
    v_dot2_f32_bf16 v90, v17, v41, v90
    v_dot2_f32_bf16 v91, v17, v49, v91
    v_dot2_f32_bf16 v88, v18, v26, v88
    v_dot2_f32_bf16 v89, v18, v34, v89
    v_dot2_f32_bf16 v90, v18, v42, v90
    v_dot2_f32_bf16 v91, v18, v50, v91
    v_dot2_f32_bf16 v88, v19, v27, v88
    v_dot2_f32_bf16 v89, v19, v35, v89
    v_dot2_f32_bf16 v90, v19, v43, v90
    v_dot2_f32_bf16 v91, v19, v51, v91
    v_dot2_f32_bf16 v88, v20, v28, v88
    v_dot2_f32_bf16 v89, v20, v36, v89
    v_dot2_f32_bf16 v90, v20, v44, v90
    v_dot2_f32_bf16 v91, v20, v52, v91
    v_dot2_f32_bf16 v88, v21, v29, v88
    v_dot2_f32_bf16 v89, v21, v37, v89
    v_dot2_f32_bf16 v90, v21, v45, v90
    v_dot2_f32_bf16 v91, v21, v53, v91
    v_dot2_f32_bf16 v88, v22, v30, v88
    v_dot2_f32_bf16 v89, v22, v38, v89
    v_dot2_f32_bf16 v90, v22, v46, v90
    v_dot2_f32_bf16 v91, v22, v54, v91
    v_dot2_f32_bf16 v88, v23, v31, v88
    v_dot2_f32_bf16 v89, v23, v39, v89
    v_dot2_f32_bf16 v90, v23, v47, v90
    v_dot2_f32_bf16 v91, v23, v55, v91
    s_nop 0
    v_cvt_pk_bf16_f32 v92, v88, v89
    s_nop 0
    v_cvt_pk_bf16_f32 v93, v90, v91
    v_lshlrev_b32 v88, 16, v92
    v_and_b32 v89, s52, v92
    v_lshlrev_b32 v90, 16, v93
    v_and_b32 v91, s52, v93
    v_mov_b32 v94, 0xcf6e6b28
    v_cmp_le_i32 vcc, 0, v7
    s_nop 1
    v_cndmask_b32 v88, v94, v88, vcc
    v_cmp_le_i32 vcc, 2, v7
    s_nop 1
    v_cndmask_b32 v89, v94, v89, vcc
    v_cmp_le_i32 vcc, 4, v7
    s_nop 1
    v_cndmask_b32 v90, v94, v90, vcc
    v_cmp_le_i32 vcc, 6, v7
    s_nop 1
    v_cndmask_b32 v91, v94, v91, vcc
    v_max3_f32 v95, v88, v89, v90
    v_max_f32 v95, v95, v91
    v_mov_b32 v96, v95
    s_nop 1
    v_permlane32_swap_b32 v95, v96
    v_max_f32 v95, v95, v96
    s_mov_b32 s34, 0x3eb8aa3b
    v_sub_f32 v88, v88, v95
    v_sub_f32 v89, v89, v95
    v_sub_f32 v90, v90, v95
    v_sub_f32 v91, v91, v95
    v_mul_f32 v88, s34, v88
    v_mul_f32 v89, s34, v89
    v_mul_f32 v90, s34, v90
    v_mul_f32 v91, s34, v91
    v_exp_f32 v88, v88
    v_exp_f32 v89, v89
    v_exp_f32 v90, v90
    v_exp_f32 v91, v91
    v_add_f32 v95, v88, v89
    v_add_f32 v96, v90, v91
    v_add_f32 v95, v95, v96
    v_mov_b32 v96, v95
    s_nop 1
    v_permlane32_swap_b32 v95, v96
    v_add_f32 v95, v95, v96
    v_rcp_f32 v95, v95
    s_nop 0
    v_mul_f32 v88, v88, v95
    v_mul_f32 v89, v89, v95
    v_mul_f32 v90, v90, v95
    v_mul_f32 v91, v91, v95
    v_cvt_pk_bf16_f32 v92, v88, v89
    v_cvt_pk_bf16_f32 v93, v90, v91
    s_mov_b32 s38, 0x05040100
    s_mov_b32 s37, 0x07060302
    s_waitcnt lgkmcnt(0)
    v_perm_b32 v40, v64, v56, s38
    v_perm_b32 v41, v64, v56, s37
    v_perm_b32 v42, v65, v57, s38
    v_perm_b32 v43, v65, v57, s37
    v_perm_b32 v44, v66, v58, s38
    v_perm_b32 v45, v66, v58, s37
    v_perm_b32 v46, v67, v59, s38
    v_perm_b32 v47, v67, v59, s37
    v_perm_b32 v48, v68, v60, s38
    v_perm_b32 v49, v68, v60, s37
    v_perm_b32 v50, v69, v61, s38
    v_perm_b32 v51, v69, v61, s37
    v_perm_b32 v52, v70, v62, s38
    v_perm_b32 v53, v70, v62, s37
    v_perm_b32 v54, v71, v63, s38
    v_perm_b32 v55, v71, v63, s37
    v_dot2_f32_bf16 v24, v40, v92, 0
    v_dot2_f32_bf16 v25, v41, v92, 0
    v_dot2_f32_bf16 v26, v42, v92, 0
    v_dot2_f32_bf16 v27, v43, v92, 0
    v_dot2_f32_bf16 v28, v44, v92, 0
    v_dot2_f32_bf16 v29, v45, v92, 0
    v_dot2_f32_bf16 v30, v46, v92, 0
    v_dot2_f32_bf16 v31, v47, v92, 0
    v_dot2_f32_bf16 v32, v48, v92, 0
    v_dot2_f32_bf16 v33, v49, v92, 0
    v_dot2_f32_bf16 v34, v50, v92, 0
    v_dot2_f32_bf16 v35, v51, v92, 0
    v_dot2_f32_bf16 v36, v52, v92, 0
    v_dot2_f32_bf16 v37, v53, v92, 0
    v_dot2_f32_bf16 v38, v54, v92, 0
    v_dot2_f32_bf16 v39, v55, v92, 0
    v_perm_b32 v40, v80, v72, s38
    v_perm_b32 v41, v80, v72, s37
    v_perm_b32 v42, v81, v73, s38
    v_perm_b32 v43, v81, v73, s37
    v_perm_b32 v44, v82, v74, s38
    v_perm_b32 v45, v82, v74, s37
    v_perm_b32 v46, v83, v75, s38
    v_perm_b32 v47, v83, v75, s37
    v_perm_b32 v48, v84, v76, s38
    v_perm_b32 v49, v84, v76, s37
    v_perm_b32 v50, v85, v77, s38
    v_perm_b32 v51, v85, v77, s37
    v_perm_b32 v52, v86, v78, s38
    v_perm_b32 v53, v86, v78, s37
    v_perm_b32 v54, v87, v79, s38
    v_perm_b32 v55, v87, v79, s37
    v_dot2_f32_bf16 v24, v40, v93, v24
    v_dot2_f32_bf16 v25, v41, v93, v25
    v_dot2_f32_bf16 v26, v42, v93, v26
    v_dot2_f32_bf16 v27, v43, v93, v27
    v_dot2_f32_bf16 v28, v44, v93, v28
    v_dot2_f32_bf16 v29, v45, v93, v29
    v_dot2_f32_bf16 v30, v46, v93, v30
    v_dot2_f32_bf16 v31, v47, v93, v31
    v_dot2_f32_bf16 v32, v48, v93, v32
    v_dot2_f32_bf16 v33, v49, v93, v33
    v_dot2_f32_bf16 v34, v50, v93, v34
    v_dot2_f32_bf16 v35, v51, v93, v35
    v_dot2_f32_bf16 v36, v52, v93, v36
    v_dot2_f32_bf16 v37, v53, v93, v37
    v_dot2_f32_bf16 v38, v54, v93, v38
    v_dot2_f32_bf16 v39, v55, v93, v39
    v_permlane32_swap_b32 v24, v32
    v_permlane32_swap_b32 v25, v33
    v_permlane32_swap_b32 v26, v34
    v_permlane32_swap_b32 v27, v35
    v_permlane32_swap_b32 v28, v36
    v_permlane32_swap_b32 v29, v37
    v_permlane32_swap_b32 v30, v38
    v_permlane32_swap_b32 v31, v39
    v_add_f32 v24, v24, v32
    v_add_f32 v25, v25, v33
    v_add_f32 v26, v26, v34
    v_add_f32 v27, v27, v35
    v_add_f32 v28, v28, v36
    v_add_f32 v29, v29, v37
    v_add_f32 v30, v30, v38
    v_add_f32 v31, v31, v39
    v_cvt_pk_bf16_f32 v56, v24, v25
    v_cvt_pk_bf16_f32 v57, v26, v27
    v_cvt_pk_bf16_f32 v58, v28, v29
    v_cvt_pk_bf16_f32 v59, v30, v31
    v_lshlrev_b32 v5, 10, v3
    v_lshl_add_u32 v5, v8, 4, v5
    s_lshl_b32 s34, s29, 7
    s_lshl_b32 s36, s36, 5
    s_add_u32 s34, s34, s36
    v_add_u32 v5, s34, v5
    buffer_store_dwordx4 v[56:59], v5, s[20:23], 0 offen
L_k1l1_done:
    s_endpgm
.globl k2l1_kernel
.p2align 8
.type k2l1_kernel,@function
k2l1_kernel:
    s_cmp_ge_u32 s2, 256
    s_cbranch_scc1 L_k2l1_done
    s_load_dwordx2 s[4:5], s[0:1], 0
    s_load_dwordx2 s[6:7], s[0:1], 16
    s_load_dwordx2 s[8:9], s[0:1], 80
    s_load_dwordx2 s[10:11], s[0:1], 32
    s_and_b32 s36, s2, 7
    s_lshr_b32 s37, s2, 3
    s_lshl_b32 s36, s36, 2
    s_lshr_b32 s38, s37, 3
    s_add_u32 s36, s36, s38
    s_and_b32 s37, s37, 7
    s_lshl_b32 s36, s36, 6
    s_lshl_b32 s41, s37, 7
    v_and_b32 v1, 63, v0
    v_lshrrev_b32 v2, 6, v0
    s_nop 0
    v_readfirstlane_b32 s39, v2
    v_lshrrev_b32 v10, 3, v1
    v_and_b32 v11, 7, v1
    v_lshrrev_b32 v61, 4, v1
    s_lshl_b32 s40, s39, 4
    s_add_u32 s40, s40, s36
    s_cmp_lt_u32 s39, 4
    s_cbranch_scc1 L_k2l1_comp
    s_sub_u32 s39, s39, 4
    s_sub_u32 s40, s40, 64
    v_add_u32 v4, s40, v10
    v_lshlrev_b32 v4, 10, v4
    v_xor_b32 v5, v11, v61
    v_lshl_add_u32 v2, v5, 4, v4
    v_xor_b32 v5, 4, v5
    v_lshl_add_u32 v3, v5, 4, v4
    v_add_u32 v3, 8192, v3
    v_bfe_u32 v4, v10, 1, 1
    s_and_b32 s42, s39, 1
    s_lshl_b32 s42, s42, 1
    v_or_b32 v4, s42, v4
    v_lshrrev_b32 v5, 1, v11
    v_xor_b32 v4, v4, v5
    v_lshlrev_b32 v6, 10, v10
    v_lshl_add_u32 v6, v4, 5, v6
    v_and_b32 v5, 1, v11
    v_lshl_add_u32 v6, v5, 4, v6
    v_add_u32 v6, s41, v6
    s_lshl_b32 s43, s39, 13
    s_lshl_b32 s44, s39, 10
    s_lshl_b32 s45, s39, 11
    s_waitcnt lgkmcnt(0)
    s_mov_b32 s12, s8
    s_and_b32 s13, s9, 0xffff
    s_mov_b32 s14, 2097152
    s_mov_b32 s15, 0x00020000
    s_mov_b32 s16, s6
    s_and_b32 s17, s7, 0xffff
    s_mov_b32 s18, 524288
    s_mov_b32 s19, 0x00020000
    s_mov_b32 s46, 0
    s_add_u32 m0, s45, 0
    s_nop 0
    buffer_load_dwordx4 v2, s[12:15], s46 offen lds
    s_add_u32 m0, s45, 1024
    s_nop 0
    buffer_load_dwordx4 v3, s[12:15], s46 offen lds
    s_add_u32 s47, s43, 0
    s_add_u32 m0, s44, 8192
    s_nop 0
    buffer_load_dwordx4 v6, s[16:19], s47 offen lds
    s_add_u32 s47, s43, 32768
    s_add_u32 m0, s44, 12288
    s_nop 0
    buffer_load_dwordx4 v6, s[16:19], s47 offen lds
    s_mov_b32 s46, 128
    s_add_u32 m0, s45, 16384
    s_nop 0
    buffer_load_dwordx4 v2, s[12:15], s46 offen lds
    s_add_u32 m0, s45, 17408
    s_nop 0
    buffer_load_dwordx4 v3, s[12:15], s46 offen lds
    s_add_u32 s47, s43, 65536
    s_add_u32 m0, s44, 24576
    s_nop 0
    buffer_load_dwordx4 v6, s[16:19], s47 offen lds
    s_add_u32 s47, s43, 98304
    s_add_u32 m0, s44, 28672
    s_nop 0
    buffer_load_dwordx4 v6, s[16:19], s47 offen lds
    s_mov_b32 s46, 256
    s_add_u32 m0, s45, 32768
    s_nop 0
    buffer_load_dwordx4 v2, s[12:15], s46 offen lds
    s_add_u32 m0, s45, 33792
    s_nop 0
    buffer_load_dwordx4 v3, s[12:15], s46 offen lds
    s_add_u32 s47, s43, 131072
    s_add_u32 m0, s44, 40960
    s_nop 0
    buffer_load_dwordx4 v6, s[16:19], s47 offen lds
    s_add_u32 s47, s43, 163840
    s_add_u32 m0, s44, 45056
    s_nop 0
    buffer_load_dwordx4 v6, s[16:19], s47 offen lds
    s_waitcnt vmcnt(8)
    s_barrier
    s_mov_b32 s46, 384
    s_add_u32 m0, s45, 49152
    s_nop 0
    buffer_load_dwordx4 v2, s[12:15], s46 offen lds
    s_add_u32 m0, s45, 50176
    s_nop 0
    buffer_load_dwordx4 v3, s[12:15], s46 offen lds
    s_add_u32 s47, s43, 196608
    s_add_u32 m0, s44, 57344
    s_nop 0
    buffer_load_dwordx4 v6, s[16:19], s47 offen lds
    s_add_u32 s47, s43, 229376
    s_add_u32 m0, s44, 61440
    s_nop 0
    buffer_load_dwordx4 v6, s[16:19], s47 offen lds
    s_waitcnt vmcnt(8)
    s_barrier
    s_mov_b32 s46, 512
    s_add_u32 m0, s45, 65536
    s_nop 0
    buffer_load_dwordx4 v2, s[12:15], s46 offen lds
    s_add_u32 m0, s45, 66560
    s_nop 0
    buffer_load_dwordx4 v3, s[12:15], s46 offen lds
    s_add_u32 s47, s43, 262144
    s_add_u32 m0, s44, 73728
    s_nop 0
    buffer_load_dwordx4 v6, s[16:19], s47 offen lds
    s_add_u32 s47, s43, 294912
    s_add_u32 m0, s44, 77824
    s_nop 0
    buffer_load_dwordx4 v6, s[16:19], s47 offen lds
    s_waitcnt vmcnt(8)
    s_barrier
    s_mov_b32 s46, 640
    s_add_u32 m0, s45, 81920
    s_nop 0
    buffer_load_dwordx4 v2, s[12:15], s46 offen lds
    s_add_u32 m0, s45, 82944
    s_nop 0
    buffer_load_dwordx4 v3, s[12:15], s46 offen lds
    s_add_u32 s47, s43, 327680
    s_add_u32 m0, s44, 90112
    s_nop 0
    buffer_load_dwordx4 v6, s[16:19], s47 offen lds
    s_add_u32 s47, s43, 360448
    s_add_u32 m0, s44, 94208
    s_nop 0
    buffer_load_dwordx4 v6, s[16:19], s47 offen lds
    s_waitcnt vmcnt(8)
    s_barrier
    s_mov_b32 s46, 768
    s_add_u32 m0, s45, 98304
    s_nop 0
    buffer_load_dwordx4 v2, s[12:15], s46 offen lds
    s_add_u32 m0, s45, 99328
    s_nop 0
    buffer_load_dwordx4 v3, s[12:15], s46 offen lds
    s_add_u32 s47, s43, 393216
    s_add_u32 m0, s44, 106496
    s_nop 0
    buffer_load_dwordx4 v6, s[16:19], s47 offen lds
    s_add_u32 s47, s43, 425984
    s_add_u32 m0, s44, 110592
    s_nop 0
    buffer_load_dwordx4 v6, s[16:19], s47 offen lds
    s_waitcnt vmcnt(8)
    s_barrier
    s_mov_b32 s46, 896
    s_add_u32 m0, s45, 114688
    s_nop 0
    buffer_load_dwordx4 v2, s[12:15], s46 offen lds
    s_add_u32 m0, s45, 115712
    s_nop 0
    buffer_load_dwordx4 v3, s[12:15], s46 offen lds
    s_add_u32 s47, s43, 458752
    s_add_u32 m0, s44, 122880
    s_nop 0
    buffer_load_dwordx4 v6, s[16:19], s47 offen lds
    s_add_u32 s47, s43, 491520
    s_add_u32 m0, s44, 126976
    s_nop 0
    buffer_load_dwordx4 v6, s[16:19], s47 offen lds
    s_waitcnt vmcnt(8)
    s_barrier
    s_waitcnt vmcnt(4)
    s_barrier
    s_waitcnt vmcnt(0)
    s_barrier
    s_endpgm
L_k2l1_comp:
    s_lshl_b32 s45, s39, 11
    s_waitcnt lgkmcnt(0)
    s_mov_b32 s20, s4
    s_and_b32 s21, s5, 0xffff
    s_mov_b32 s22, 2097152
    s_mov_b32 s23, 0x00020000
    s_add_u32 s24, s8, 2097152
    s_addc_u32 s25, s9, 0
    s_and_b32 s25, s25, 0xffff
    s_mov_b32 s26, 2097152
    s_mov_b32 s27, 0x00020000
    s_add_u32 s28, s8, 8388608
    s_addc_u32 s29, s9, 0
    s_and_b32 s29, s29, 0xffff
    s_mov_b32 s30, 32768
    s_mov_b32 s31, 0x00020000
    s_mov_b32 s32, s10
    s_and_b32 s33, s11, 0xffff
    s_mov_b32 s34, 1024
    s_mov_b32 s35, 0x00020000
    v_and_b32 v60, 15, v1
    v_add_u32 v62, s40, v60
    v_lshlrev_b32 v9, 10, v62
    v_lshl_add_u32 v9, v61, 3, v9
    v_add_u32 v9, s41, v9
    v_lshlrev_b32 v10, 3, v61
    v_add_u32 v10, s41, v10
    buffer_load_dwordx2 v[44:45], v9, s[20:23], 0 offen offset:0
    buffer_load_dwordx2 v[46:47], v9, s[20:23], 0 offen offset:32
    buffer_load_dwordx2 v[48:49], v9, s[20:23], 0 offen offset:64
    buffer_load_dwordx2 v[50:51], v9, s[20:23], 0 offen offset:96
    buffer_load_dwordx2 v[52:53], v10, s[32:35], 0 offen offset:0
    buffer_load_dwordx2 v[54:55], v10, s[32:35], 0 offen offset:32
    buffer_load_dwordx2 v[56:57], v10, s[32:35], 0 offen offset:64
    buffer_load_dwordx2 v[58:59], v10, s[32:35], 0 offen offset:96
    v_lshrrev_b32 v4, 1, v60
    v_xor_b32 v4, v4, v61
    v_lshlrev_b32 v2, 7, v60
    v_lshl_add_u32 v2, v4, 4, v2
    v_add_u32 v2, s45, v2
    v_xor_b32 v3, 64, v2
    v_bfe_u32 v8, v1, 2, 2
    v_lshl_add_u32 v11, v61, 3, v8
    v_lshlrev_b32 v11, 7, v11
    v_and_b32 v5, 3, v1
    v_lshl_add_u32 v11, v5, 3, v11
    v_add_u32 v11, 8192, v11
    v_lshrrev_b32 v8, 1, v8
    v_and_b32 v5, 1, v61
    v_lshl_or_b32 v8, v5, 1, v8
    v_xor_b32 v4, 0, v8
    v_lshl_add_u32 v4, v4, 5, v11
    v_xor_b32 v5, 1, v8
    v_lshl_add_u32 v5, v5, 5, v11
    v_xor_b32 v6, 2, v8
    v_lshl_add_u32 v6, v6, 5, v11
    v_xor_b32 v7, 3, v8
    v_lshl_add_u32 v7, v7, 5, v11
    v_add_u32 v28, 65536, v2
    v_add_u32 v29, 65536, v3
    v_add_u32 v30, 65536, v4
    v_add_u32 v31, 65536, v5
    v_add_u32 v32, 65536, v6
    v_add_u32 v33, 65536, v7
    v_mov_b32 v12, 0
    v_mov_b32 v13, 0
    v_mov_b32 v14, 0
    v_mov_b32 v15, 0
    v_mov_b32 v16, 0
    v_mov_b32 v17, 0
    v_mov_b32 v18, 0
    v_mov_b32 v19, 0
    v_mov_b32 v20, 0
    v_mov_b32 v21, 0
    v_mov_b32 v22, 0
    v_mov_b32 v23, 0
    v_mov_b32 v24, 0
    v_mov_b32 v25, 0
    v_mov_b32 v26, 0
    v_mov_b32 v27, 0
    s_barrier
    ds_read_b64_tr_b16 v[64:65], v4 offset:0
    ds_read_b64_tr_b16 v[66:67], v4 offset:512
    ds_read_b64_tr_b16 v[68:69], v5 offset:0
    ds_read_b64_tr_b16 v[70:71], v5 offset:512
    ds_read_b64_tr_b16 v[72:73], v6 offset:0
    ds_read_b64_tr_b16 v[74:75], v6 offset:512
    ds_read_b64_tr_b16 v[76:77], v7 offset:0
    ds_read_b64_tr_b16 v[78:79], v7 offset:512
    ds_read_b128 v[80:83], v2 offset:0
    s_waitcnt lgkmcnt(0)
    ds_read_b64_tr_b16 v[84:85], v4 offset:4096
    ds_read_b64_tr_b16 v[86:87], v4 offset:4608
    ds_read_b64_tr_b16 v[88:89], v5 offset:4096
    ds_read_b64_tr_b16 v[90:91], v5 offset:4608
    ds_read_b64_tr_b16 v[92:93], v6 offset:4096
    ds_read_b64_tr_b16 v[94:95], v6 offset:4608
    ds_read_b64_tr_b16 v[96:97], v7 offset:4096
    ds_read_b64_tr_b16 v[98:99], v7 offset:4608
    ds_read_b128 v[100:103], v3 offset:0
    v_mfma_f32_16x16x32_bf16 v[12:15], v[64:67], v[80:83], v[12:15]
    v_mfma_f32_16x16x32_bf16 v[16:19], v[68:71], v[80:83], v[16:19]
    v_mfma_f32_16x16x32_bf16 v[20:23], v[72:75], v[80:83], v[20:23]
    v_mfma_f32_16x16x32_bf16 v[24:27], v[76:79], v[80:83], v[24:27]
    s_barrier
    s_waitcnt lgkmcnt(0)
    ds_read_b64_tr_b16 v[64:65], v4 offset:16384
    ds_read_b64_tr_b16 v[66:67], v4 offset:16896
    ds_read_b64_tr_b16 v[68:69], v5 offset:16384
    ds_read_b64_tr_b16 v[70:71], v5 offset:16896
    ds_read_b64_tr_b16 v[72:73], v6 offset:16384
    ds_read_b64_tr_b16 v[74:75], v6 offset:16896
    ds_read_b64_tr_b16 v[76:77], v7 offset:16384
    ds_read_b64_tr_b16 v[78:79], v7 offset:16896
    ds_read_b128 v[80:83], v2 offset:16384
    v_mfma_f32_16x16x32_bf16 v[12:15], v[84:87], v[100:103], v[12:15]
    v_mfma_f32_16x16x32_bf16 v[16:19], v[88:91], v[100:103], v[16:19]
    v_mfma_f32_16x16x32_bf16 v[20:23], v[92:95], v[100:103], v[20:23]
    v_mfma_f32_16x16x32_bf16 v[24:27], v[96:99], v[100:103], v[24:27]
    s_waitcnt lgkmcnt(0)
    ds_read_b64_tr_b16 v[84:85], v4 offset:20480
    ds_read_b64_tr_b16 v[86:87], v4 offset:20992
    ds_read_b64_tr_b16 v[88:89], v5 offset:20480
    ds_read_b64_tr_b16 v[90:91], v5 offset:20992
    ds_read_b64_tr_b16 v[92:93], v6 offset:20480
    ds_read_b64_tr_b16 v[94:95], v6 offset:20992
    ds_read_b64_tr_b16 v[96:97], v7 offset:20480
    ds_read_b64_tr_b16 v[98:99], v7 offset:20992
    ds_read_b128 v[100:103], v3 offset:16384
    v_mfma_f32_16x16x32_bf16 v[12:15], v[64:67], v[80:83], v[12:15]
    v_mfma_f32_16x16x32_bf16 v[16:19], v[68:71], v[80:83], v[16:19]
    v_mfma_f32_16x16x32_bf16 v[20:23], v[72:75], v[80:83], v[20:23]
    v_mfma_f32_16x16x32_bf16 v[24:27], v[76:79], v[80:83], v[24:27]
    s_barrier
    s_waitcnt lgkmcnt(0)
    ds_read_b64_tr_b16 v[64:65], v4 offset:32768
    ds_read_b64_tr_b16 v[66:67], v4 offset:33280
    ds_read_b64_tr_b16 v[68:69], v5 offset:32768
    ds_read_b64_tr_b16 v[70:71], v5 offset:33280
    ds_read_b64_tr_b16 v[72:73], v6 offset:32768
    ds_read_b64_tr_b16 v[74:75], v6 offset:33280
    ds_read_b64_tr_b16 v[76:77], v7 offset:32768
    ds_read_b64_tr_b16 v[78:79], v7 offset:33280
    ds_read_b128 v[80:83], v2 offset:32768
    v_mfma_f32_16x16x32_bf16 v[12:15], v[84:87], v[100:103], v[12:15]
    v_mfma_f32_16x16x32_bf16 v[16:19], v[88:91], v[100:103], v[16:19]
    v_mfma_f32_16x16x32_bf16 v[20:23], v[92:95], v[100:103], v[20:23]
    v_mfma_f32_16x16x32_bf16 v[24:27], v[96:99], v[100:103], v[24:27]
    s_waitcnt lgkmcnt(0)
    ds_read_b64_tr_b16 v[84:85], v4 offset:36864
    ds_read_b64_tr_b16 v[86:87], v4 offset:37376
    ds_read_b64_tr_b16 v[88:89], v5 offset:36864
    ds_read_b64_tr_b16 v[90:91], v5 offset:37376
    ds_read_b64_tr_b16 v[92:93], v6 offset:36864
    ds_read_b64_tr_b16 v[94:95], v6 offset:37376
    ds_read_b64_tr_b16 v[96:97], v7 offset:36864
    ds_read_b64_tr_b16 v[98:99], v7 offset:37376
    ds_read_b128 v[100:103], v3 offset:32768
    v_mfma_f32_16x16x32_bf16 v[12:15], v[64:67], v[80:83], v[12:15]
    v_mfma_f32_16x16x32_bf16 v[16:19], v[68:71], v[80:83], v[16:19]
    v_mfma_f32_16x16x32_bf16 v[20:23], v[72:75], v[80:83], v[20:23]
    v_mfma_f32_16x16x32_bf16 v[24:27], v[76:79], v[80:83], v[24:27]
    s_barrier
    s_waitcnt lgkmcnt(0)
    ds_read_b64_tr_b16 v[64:65], v4 offset:49152
    ds_read_b64_tr_b16 v[66:67], v4 offset:49664
    ds_read_b64_tr_b16 v[68:69], v5 offset:49152
    ds_read_b64_tr_b16 v[70:71], v5 offset:49664
    ds_read_b64_tr_b16 v[72:73], v6 offset:49152
    ds_read_b64_tr_b16 v[74:75], v6 offset:49664
    ds_read_b64_tr_b16 v[76:77], v7 offset:49152
    ds_read_b64_tr_b16 v[78:79], v7 offset:49664
    ds_read_b128 v[80:83], v2 offset:49152
    v_mfma_f32_16x16x32_bf16 v[12:15], v[84:87], v[100:103], v[12:15]
    v_mfma_f32_16x16x32_bf16 v[16:19], v[88:91], v[100:103], v[16:19]
    v_mfma_f32_16x16x32_bf16 v[20:23], v[92:95], v[100:103], v[20:23]
    v_mfma_f32_16x16x32_bf16 v[24:27], v[96:99], v[100:103], v[24:27]
    s_waitcnt lgkmcnt(0)
    ds_read_b64_tr_b16 v[84:85], v4 offset:53248
    ds_read_b64_tr_b16 v[86:87], v4 offset:53760
    ds_read_b64_tr_b16 v[88:89], v5 offset:53248
    ds_read_b64_tr_b16 v[90:91], v5 offset:53760
    ds_read_b64_tr_b16 v[92:93], v6 offset:53248
    ds_read_b64_tr_b16 v[94:95], v6 offset:53760
    ds_read_b64_tr_b16 v[96:97], v7 offset:53248
    ds_read_b64_tr_b16 v[98:99], v7 offset:53760
    ds_read_b128 v[100:103], v3 offset:49152
    v_mfma_f32_16x16x32_bf16 v[12:15], v[64:67], v[80:83], v[12:15]
    v_mfma_f32_16x16x32_bf16 v[16:19], v[68:71], v[80:83], v[16:19]
    v_mfma_f32_16x16x32_bf16 v[20:23], v[72:75], v[80:83], v[20:23]
    v_mfma_f32_16x16x32_bf16 v[24:27], v[76:79], v[80:83], v[24:27]
    s_barrier
    s_waitcnt lgkmcnt(0)
    ds_read_b64_tr_b16 v[64:65], v30 offset:0
    ds_read_b64_tr_b16 v[66:67], v30 offset:512
    ds_read_b64_tr_b16 v[68:69], v31 offset:0
    ds_read_b64_tr_b16 v[70:71], v31 offset:512
    ds_read_b64_tr_b16 v[72:73], v32 offset:0
    ds_read_b64_tr_b16 v[74:75], v32 offset:512
    ds_read_b64_tr_b16 v[76:77], v33 offset:0
    ds_read_b64_tr_b16 v[78:79], v33 offset:512
    ds_read_b128 v[80:83], v28 offset:0
    v_mfma_f32_16x16x32_bf16 v[12:15], v[84:87], v[100:103], v[12:15]
    v_mfma_f32_16x16x32_bf16 v[16:19], v[88:91], v[100:103], v[16:19]
    v_mfma_f32_16x16x32_bf16 v[20:23], v[92:95], v[100:103], v[20:23]
    v_mfma_f32_16x16x32_bf16 v[24:27], v[96:99], v[100:103], v[24:27]
    s_waitcnt lgkmcnt(0)
    ds_read_b64_tr_b16 v[84:85], v30 offset:4096
    ds_read_b64_tr_b16 v[86:87], v30 offset:4608
    ds_read_b64_tr_b16 v[88:89], v31 offset:4096
    ds_read_b64_tr_b16 v[90:91], v31 offset:4608
    ds_read_b64_tr_b16 v[92:93], v32 offset:4096
    ds_read_b64_tr_b16 v[94:95], v32 offset:4608
    ds_read_b64_tr_b16 v[96:97], v33 offset:4096
    ds_read_b64_tr_b16 v[98:99], v33 offset:4608
    ds_read_b128 v[100:103], v29 offset:0
    v_mfma_f32_16x16x32_bf16 v[12:15], v[64:67], v[80:83], v[12:15]
    v_mfma_f32_16x16x32_bf16 v[16:19], v[68:71], v[80:83], v[16:19]
    v_mfma_f32_16x16x32_bf16 v[20:23], v[72:75], v[80:83], v[20:23]
    v_mfma_f32_16x16x32_bf16 v[24:27], v[76:79], v[80:83], v[24:27]
    s_barrier
    s_waitcnt lgkmcnt(0)
    ds_read_b64_tr_b16 v[64:65], v30 offset:16384
    ds_read_b64_tr_b16 v[66:67], v30 offset:16896
    ds_read_b64_tr_b16 v[68:69], v31 offset:16384
    ds_read_b64_tr_b16 v[70:71], v31 offset:16896
    ds_read_b64_tr_b16 v[72:73], v32 offset:16384
    ds_read_b64_tr_b16 v[74:75], v32 offset:16896
    ds_read_b64_tr_b16 v[76:77], v33 offset:16384
    ds_read_b64_tr_b16 v[78:79], v33 offset:16896
    ds_read_b128 v[80:83], v28 offset:16384
    v_mfma_f32_16x16x32_bf16 v[12:15], v[84:87], v[100:103], v[12:15]
    v_mfma_f32_16x16x32_bf16 v[16:19], v[88:91], v[100:103], v[16:19]
    v_mfma_f32_16x16x32_bf16 v[20:23], v[92:95], v[100:103], v[20:23]
    v_mfma_f32_16x16x32_bf16 v[24:27], v[96:99], v[100:103], v[24:27]
    s_waitcnt lgkmcnt(0)
    ds_read_b64_tr_b16 v[84:85], v30 offset:20480
    ds_read_b64_tr_b16 v[86:87], v30 offset:20992
    ds_read_b64_tr_b16 v[88:89], v31 offset:20480
    ds_read_b64_tr_b16 v[90:91], v31 offset:20992
    ds_read_b64_tr_b16 v[92:93], v32 offset:20480
    ds_read_b64_tr_b16 v[94:95], v32 offset:20992
    ds_read_b64_tr_b16 v[96:97], v33 offset:20480
    ds_read_b64_tr_b16 v[98:99], v33 offset:20992
    ds_read_b128 v[100:103], v29 offset:16384
    v_mfma_f32_16x16x32_bf16 v[12:15], v[64:67], v[80:83], v[12:15]
    v_mfma_f32_16x16x32_bf16 v[16:19], v[68:71], v[80:83], v[16:19]
    v_mfma_f32_16x16x32_bf16 v[20:23], v[72:75], v[80:83], v[20:23]
    v_mfma_f32_16x16x32_bf16 v[24:27], v[76:79], v[80:83], v[24:27]
    s_barrier
    s_waitcnt lgkmcnt(0)
    ds_read_b64_tr_b16 v[64:65], v30 offset:32768
    ds_read_b64_tr_b16 v[66:67], v30 offset:33280
    ds_read_b64_tr_b16 v[68:69], v31 offset:32768
    ds_read_b64_tr_b16 v[70:71], v31 offset:33280
    ds_read_b64_tr_b16 v[72:73], v32 offset:32768
    ds_read_b64_tr_b16 v[74:75], v32 offset:33280
    ds_read_b64_tr_b16 v[76:77], v33 offset:32768
    ds_read_b64_tr_b16 v[78:79], v33 offset:33280
    ds_read_b128 v[80:83], v28 offset:32768
    v_mfma_f32_16x16x32_bf16 v[12:15], v[84:87], v[100:103], v[12:15]
    v_mfma_f32_16x16x32_bf16 v[16:19], v[88:91], v[100:103], v[16:19]
    v_mfma_f32_16x16x32_bf16 v[20:23], v[92:95], v[100:103], v[20:23]
    v_mfma_f32_16x16x32_bf16 v[24:27], v[96:99], v[100:103], v[24:27]
    s_waitcnt lgkmcnt(0)
    ds_read_b64_tr_b16 v[84:85], v30 offset:36864
    ds_read_b64_tr_b16 v[86:87], v30 offset:37376
    ds_read_b64_tr_b16 v[88:89], v31 offset:36864
    ds_read_b64_tr_b16 v[90:91], v31 offset:37376
    ds_read_b64_tr_b16 v[92:93], v32 offset:36864
    ds_read_b64_tr_b16 v[94:95], v32 offset:37376
    ds_read_b64_tr_b16 v[96:97], v33 offset:36864
    ds_read_b64_tr_b16 v[98:99], v33 offset:37376
    ds_read_b128 v[100:103], v29 offset:32768
    v_mfma_f32_16x16x32_bf16 v[12:15], v[64:67], v[80:83], v[12:15]
    v_mfma_f32_16x16x32_bf16 v[16:19], v[68:71], v[80:83], v[16:19]
    v_mfma_f32_16x16x32_bf16 v[20:23], v[72:75], v[80:83], v[20:23]
    v_mfma_f32_16x16x32_bf16 v[24:27], v[76:79], v[80:83], v[24:27]
    s_barrier
    s_waitcnt lgkmcnt(0)
    ds_read_b64_tr_b16 v[64:65], v30 offset:49152
    ds_read_b64_tr_b16 v[66:67], v30 offset:49664
    ds_read_b64_tr_b16 v[68:69], v31 offset:49152
    ds_read_b64_tr_b16 v[70:71], v31 offset:49664
    ds_read_b64_tr_b16 v[72:73], v32 offset:49152
    ds_read_b64_tr_b16 v[74:75], v32 offset:49664
    ds_read_b64_tr_b16 v[76:77], v33 offset:49152
    ds_read_b64_tr_b16 v[78:79], v33 offset:49664
    ds_read_b128 v[80:83], v28 offset:49152
    v_mfma_f32_16x16x32_bf16 v[12:15], v[84:87], v[100:103], v[12:15]
    v_mfma_f32_16x16x32_bf16 v[16:19], v[88:91], v[100:103], v[16:19]
    v_mfma_f32_16x16x32_bf16 v[20:23], v[92:95], v[100:103], v[20:23]
    v_mfma_f32_16x16x32_bf16 v[24:27], v[96:99], v[100:103], v[24:27]
    s_waitcnt lgkmcnt(0)
    ds_read_b64_tr_b16 v[84:85], v30 offset:53248
    ds_read_b64_tr_b16 v[86:87], v30 offset:53760
    ds_read_b64_tr_b16 v[88:89], v31 offset:53248
    ds_read_b64_tr_b16 v[90:91], v31 offset:53760
    ds_read_b64_tr_b16 v[92:93], v32 offset:53248
    ds_read_b64_tr_b16 v[94:95], v32 offset:53760
    ds_read_b64_tr_b16 v[96:97], v33 offset:53248
    ds_read_b64_tr_b16 v[98:99], v33 offset:53760
    ds_read_b128 v[100:103], v29 offset:49152
    v_mfma_f32_16x16x32_bf16 v[12:15], v[64:67], v[80:83], v[12:15]
    v_mfma_f32_16x16x32_bf16 v[16:19], v[68:71], v[80:83], v[16:19]
    v_mfma_f32_16x16x32_bf16 v[20:23], v[72:75], v[80:83], v[20:23]
    v_mfma_f32_16x16x32_bf16 v[24:27], v[76:79], v[80:83], v[24:27]
    s_waitcnt lgkmcnt(0)
    v_mfma_f32_16x16x32_bf16 v[12:15], v[84:87], v[100:103], v[12:15]
    v_mfma_f32_16x16x32_bf16 v[16:19], v[88:91], v[100:103], v[16:19]
    v_mfma_f32_16x16x32_bf16 v[20:23], v[92:95], v[100:103], v[20:23]
    v_mfma_f32_16x16x32_bf16 v[24:27], v[96:99], v[100:103], v[24:27]
    s_mov_b32 s46, 0xffff0000
    v_mov_b32 v63, 0x3f803f80
    v_mov_b32 v108, 0
    v_mov_b32 v109, 0
    v_mov_b32 v110, 0
    s_waitcnt vmcnt(0)
    v_cvt_pk_bf16_f32 v120, v12, v13
    v_lshlrev_b32 v121, 16, v120
    v_and_b32 v122, s46, v120
    v_lshlrev_b32 v123, 16, v44
    v_and_b32 v124, s46, v44
    v_add_f32 v121, v121, v123
    v_add_f32 v122, v122, v124
    v_cvt_pk_bf16_f32 v112, v121, v122
    v_dot2c_f32_bf16 v108, v112, v63
    v_dot2c_f32_bf16 v109, v112, v112
    v_dot2c_f32_bf16 v110, v112, v52
    v_cvt_pk_bf16_f32 v120, v14, v15
    v_lshlrev_b32 v121, 16, v120
    v_and_b32 v122, s46, v120
    v_lshlrev_b32 v123, 16, v45
    v_and_b32 v124, s46, v45
    v_add_f32 v121, v121, v123
    v_add_f32 v122, v122, v124
    v_cvt_pk_bf16_f32 v113, v121, v122
    v_dot2c_f32_bf16 v108, v113, v63
    v_dot2c_f32_bf16 v109, v113, v113
    v_dot2c_f32_bf16 v110, v113, v53
    buffer_store_dwordx2 v[112:113], v9, s[24:27], 0 offen offset:0
    v_cvt_pk_bf16_f32 v120, v16, v17
    v_lshlrev_b32 v121, 16, v120
    v_and_b32 v122, s46, v120
    v_lshlrev_b32 v123, 16, v46
    v_and_b32 v124, s46, v46
    v_add_f32 v121, v121, v123
    v_add_f32 v122, v122, v124
    v_cvt_pk_bf16_f32 v114, v121, v122
    v_dot2c_f32_bf16 v108, v114, v63
    v_dot2c_f32_bf16 v109, v114, v114
    v_dot2c_f32_bf16 v110, v114, v54
    v_cvt_pk_bf16_f32 v120, v18, v19
    v_lshlrev_b32 v121, 16, v120
    v_and_b32 v122, s46, v120
    v_lshlrev_b32 v123, 16, v47
    v_and_b32 v124, s46, v47
    v_add_f32 v121, v121, v123
    v_add_f32 v122, v122, v124
    v_cvt_pk_bf16_f32 v115, v121, v122
    v_dot2c_f32_bf16 v108, v115, v63
    v_dot2c_f32_bf16 v109, v115, v115
    v_dot2c_f32_bf16 v110, v115, v55
    buffer_store_dwordx2 v[114:115], v9, s[24:27], 0 offen offset:32
    v_cvt_pk_bf16_f32 v120, v20, v21
    v_lshlrev_b32 v121, 16, v120
    v_and_b32 v122, s46, v120
    v_lshlrev_b32 v123, 16, v48
    v_and_b32 v124, s46, v48
    v_add_f32 v121, v121, v123
    v_add_f32 v122, v122, v124
    v_cvt_pk_bf16_f32 v116, v121, v122
    v_dot2c_f32_bf16 v108, v116, v63
    v_dot2c_f32_bf16 v109, v116, v116
    v_dot2c_f32_bf16 v110, v116, v56
    v_cvt_pk_bf16_f32 v120, v22, v23
    v_lshlrev_b32 v121, 16, v120
    v_and_b32 v122, s46, v120
    v_lshlrev_b32 v123, 16, v49
    v_and_b32 v124, s46, v49
    v_add_f32 v121, v121, v123
    v_add_f32 v122, v122, v124
    v_cvt_pk_bf16_f32 v117, v121, v122
    v_dot2c_f32_bf16 v108, v117, v63
    v_dot2c_f32_bf16 v109, v117, v117
    v_dot2c_f32_bf16 v110, v117, v57
    buffer_store_dwordx2 v[116:117], v9, s[24:27], 0 offen offset:64
    v_cvt_pk_bf16_f32 v120, v24, v25
    v_lshlrev_b32 v121, 16, v120
    v_and_b32 v122, s46, v120
    v_lshlrev_b32 v123, 16, v50
    v_and_b32 v124, s46, v50
    v_add_f32 v121, v121, v123
    v_add_f32 v122, v122, v124
    v_cvt_pk_bf16_f32 v118, v121, v122
    v_dot2c_f32_bf16 v108, v118, v63
    v_dot2c_f32_bf16 v109, v118, v118
    v_dot2c_f32_bf16 v110, v118, v58
    v_cvt_pk_bf16_f32 v120, v26, v27
    v_lshlrev_b32 v121, 16, v120
    v_and_b32 v122, s46, v120
    v_lshlrev_b32 v123, 16, v51
    v_and_b32 v124, s46, v51
    v_add_f32 v121, v121, v123
    v_add_f32 v122, v122, v124
    v_cvt_pk_bf16_f32 v119, v121, v122
    v_dot2c_f32_bf16 v108, v119, v63
    v_dot2c_f32_bf16 v109, v119, v119
    v_dot2c_f32_bf16 v110, v119, v59
    buffer_store_dwordx2 v[118:119], v9, s[24:27], 0 offen offset:96
    v_mov_b32 v125, v108
    s_nop 1
    v_permlane16_swap_b32 v108, v125
    v_add_f32 v108, v108, v125
    v_mov_b32 v125, v108
    s_nop 1
    v_permlane32_swap_b32 v108, v125
    v_add_f32 v108, v108, v125
    v_mov_b32 v126, v109
    s_nop 1
    v_permlane16_swap_b32 v109, v126
    v_add_f32 v109, v109, v126
    v_mov_b32 v126, v109
    s_nop 1
    v_permlane32_swap_b32 v109, v126
    v_add_f32 v109, v109, v126
    v_mov_b32 v127, v110
    s_nop 1
    v_permlane16_swap_b32 v110, v127
    v_add_f32 v110, v110, v127
    v_mov_b32 v127, v110
    s_nop 1
    v_permlane32_swap_b32 v110, v127
    v_add_f32 v110, v110, v127
    v_mov_b32 v111, 0
    v_cmp_eq_u32 vcc, 1, v61
    s_nop 1
    v_cndmask_b32 v108, v108, v109, vcc
    v_cmp_eq_u32 vcc, 2, v61
    s_nop 1
    v_cndmask_b32 v108, v108, v110, vcc
    v_cmp_eq_u32 vcc, 3, v61
    s_nop 1
    v_cndmask_b32 v108, v108, v111, vcc
    v_lshlrev_b32 v120, 4, v62
    v_lshl_add_u32 v120, v61, 2, v120
    buffer_atomic_add_f32 v108, v120, s[28:31], 0 offen
L_k2l1_done:
    s_endpgm
.globl k4l1_kernel
.p2align 8
.type k4l1_kernel,@function
k4l1_kernel:
    s_cmp_ge_u32 s2, 184
    s_cbranch_scc1 L_k4l1_done
    s_load_dwordx2 s[4:5], s[0:1], 80
    s_load_dwordx2 s[6:7], s[0:1], 40
    s_load_dwordx2 s[8:9], s[0:1], 48
    s_load_dwordx2 s[10:11], s[0:1], 32
    s_load_dwordx2 s[70:71], s[0:1], 64
    s_load_dwordx2 s[66:67], s[0:1], 56
    v_and_b32 v1, 63, v0
    v_lshrrev_b32 v2, 6, v0
    s_nop 0
    v_readfirstlane_b32 s68, v2
    s_mov_b32 s72, 0xffff0000
    s_mov_b32 s73, 0x3b000000
    s_mov_b32 s74, 0x3727c5ac
    v_lshlrev_b32 v3, 4, v0
    s_waitcnt lgkmcnt(0)
    s_add_u32 s12, s4, 2097152
    s_addc_u32 s13, s5, 0
    s_and_b32 s13, s13, 0xffff
    s_mov_b32 s14, 2097152
    s_mov_b32 s15, 0x00020000
    s_add_u32 s24, s4, 8388608
    s_addc_u32 s25, s5, 0
    s_and_b32 s25, s25, 0xffff
    s_mov_b32 s26, 32768
    s_mov_b32 s27, 0x00020000
    s_cmp_ge_u32 s2, 56
    s_cbranch_scc1 L_k4l1_ln
    s_and_b32 s69, s2, 7
    s_mul_i32 s69, s69, 7
    s_lshr_b32 s75, s2, 3
    s_add_u32 s69, s69, s75
    s_cmp_lt_u32 s68, 4
    s_cbranch_scc1 L_k4l1_comp
    s_sub_u32 s68, s68, 4
    s_mov_b32 s16, s6
    s_and_b32 s17, s7, 0xffff
    s_mov_b32 s18, 1835008
    s_mov_b32 s19, 0x00020000
    s_mov_b32 s20, s8
    s_and_b32 s21, s9, 0xffff
    s_mov_b32 s22, 1835008
    s_mov_b32 s23, 0x00020000
    s_mov_b32 s44, s66
    s_and_b32 s45, s67, 0xffff
    s_mov_b32 s46, 1835008
    s_mov_b32 s47, 0x00020000
    s_barrier
    v_lshrrev_b32 v5, 2, v1
    v_mul_u32_u24 v6, 3584, v5
    v_lshrrev_b32 v7, 5, v1
    v_lshlrev_b32 v7, 1, v7
    v_and_b32 v8, 3, v1
    v_xor_b32 v7, v7, v8
    v_lshl_add_u32 v6, v7, 4, v6
    s_lshl_b32 s75, s69, 6
    v_add_u32 v6, s75, v6
    s_mul_i32 s76, s68, 458752
    s_lshl_b32 s77, s68, 13
    s_add_u32 s40, s76, 0
    s_add_u32 m0, s77, 0
    s_nop 0
    buffer_load_dwordx4 v6, s[16:19], s40 offen lds
    s_add_u32 s40, s76, 57344
    s_add_u32 m0, s77, 1024
    s_nop 0
    buffer_load_dwordx4 v6, s[16:19], s40 offen lds
    s_add_u32 s40, s76, 114688
    s_add_u32 m0, s77, 2048
    s_nop 0
    buffer_load_dwordx4 v6, s[16:19], s40 offen lds
    s_add_u32 s40, s76, 172032
    s_add_u32 m0, s77, 3072
    s_nop 0
    buffer_load_dwordx4 v6, s[16:19], s40 offen lds
    s_add_u32 s40, s76, 229376
    s_add_u32 m0, s77, 4096
    s_nop 0
    buffer_load_dwordx4 v6, s[16:19], s40 offen lds
    s_add_u32 s40, s76, 286720
    s_add_u32 m0, s77, 5120
    s_nop 0
    buffer_load_dwordx4 v6, s[16:19], s40 offen lds
    s_add_u32 s40, s76, 344064
    s_add_u32 m0, s77, 6144
    s_nop 0
    buffer_load_dwordx4 v6, s[16:19], s40 offen lds
    s_add_u32 s40, s76, 401408
    s_add_u32 m0, s77, 7168
    s_nop 0
    buffer_load_dwordx4 v6, s[16:19], s40 offen lds
    s_add_u32 s40, s76, 0
    s_add_u32 m0, s77, 32768
    s_nop 0
    buffer_load_dwordx4 v6, s[20:23], s40 offen lds
    s_add_u32 s40, s76, 57344
    s_add_u32 m0, s77, 33792
    s_nop 0
    buffer_load_dwordx4 v6, s[20:23], s40 offen lds
    s_add_u32 s40, s76, 114688
    s_add_u32 m0, s77, 34816
    s_nop 0
    buffer_load_dwordx4 v6, s[20:23], s40 offen lds
    s_add_u32 s40, s76, 172032
    s_add_u32 m0, s77, 35840
    s_nop 0
    buffer_load_dwordx4 v6, s[20:23], s40 offen lds
    s_add_u32 s40, s76, 229376
    s_add_u32 m0, s77, 36864
    s_nop 0
    buffer_load_dwordx4 v6, s[20:23], s40 offen lds
    s_add_u32 s40, s76, 286720
    s_add_u32 m0, s77, 37888
    s_nop 0
    buffer_load_dwordx4 v6, s[20:23], s40 offen lds
    s_add_u32 s40, s76, 344064
    s_add_u32 m0, s77, 38912
    s_nop 0
    buffer_load_dwordx4 v6, s[20:23], s40 offen lds
    s_add_u32 s40, s76, 401408
    s_add_u32 m0, s77, 39936
    s_nop 0
    buffer_load_dwordx4 v6, s[20:23], s40 offen lds
    v_lshrrev_b32 v7, 1, v1
    v_and_b32 v8, 1, v1
    s_lshl_b32 s78, s69, 15
    s_lshl_b32 s79, s68, 13
    s_add_u32 s78, s78, s79
    s_and_b32 s40, s68, 1
    s_lshl_b32 s40, s40, 2
    s_or_b32 s40, s40, 0
    v_xor_b32 v9, s40, v7
    v_lshlrev_b32 v9, 5, v9
    v_lshl_add_u32 v9, v8, 4, v9
    s_add_u32 s41, s78, 0
    s_add_u32 m0, s79, 65536
    s_nop 0
    buffer_load_dwordx4 v9, s[44:47], s41 offen lds
    s_and_b32 s40, s68, 1
    s_lshl_b32 s40, s40, 2
    s_or_b32 s40, s40, 1
    v_xor_b32 v9, s40, v7
    v_lshlrev_b32 v9, 5, v9
    v_lshl_add_u32 v9, v8, 4, v9
    s_add_u32 s41, s78, 1024
    s_add_u32 m0, s79, 66560
    s_nop 0
    buffer_load_dwordx4 v9, s[44:47], s41 offen lds
    s_and_b32 s40, s68, 1
    s_lshl_b32 s40, s40, 2
    s_or_b32 s40, s40, 2
    v_xor_b32 v9, s40, v7
    v_lshlrev_b32 v9, 5, v9
    v_lshl_add_u32 v9, v8, 4, v9
    s_add_u32 s41, s78, 2048
    s_add_u32 m0, s79, 67584
    s_nop 0
    buffer_load_dwordx4 v9, s[44:47], s41 offen lds
    s_and_b32 s40, s68, 1
    s_lshl_b32 s40, s40, 2
    s_or_b32 s40, s40, 3
    v_xor_b32 v9, s40, v7
    v_lshlrev_b32 v9, 5, v9
    v_lshl_add_u32 v9, v8, 4, v9
    s_add_u32 s41, s78, 3072
    s_add_u32 m0, s79, 68608
    s_nop 0
    buffer_load_dwordx4 v9, s[44:47], s41 offen lds
    s_and_b32 s40, s68, 1
    s_lshl_b32 s40, s40, 2
    s_or_b32 s40, s40, 0
    v_xor_b32 v9, s40, v7
    v_lshlrev_b32 v9, 5, v9
    v_lshl_add_u32 v9, v8, 4, v9
    s_add_u32 s41, s78, 4096
    s_add_u32 m0, s79, 69632
    s_nop 0
    buffer_load_dwordx4 v9, s[44:47], s41 offen lds
    s_and_b32 s40, s68, 1
    s_lshl_b32 s40, s40, 2
    s_or_b32 s40, s40, 1
    v_xor_b32 v9, s40, v7
    v_lshlrev_b32 v9, 5, v9
    v_lshl_add_u32 v9, v8, 4, v9
    s_add_u32 s41, s78, 5120
    s_add_u32 m0, s79, 70656
    s_nop 0
    buffer_load_dwordx4 v9, s[44:47], s41 offen lds
    s_and_b32 s40, s68, 1
    s_lshl_b32 s40, s40, 2
    s_or_b32 s40, s40, 2
    v_xor_b32 v9, s40, v7
    v_lshlrev_b32 v9, 5, v9
    v_lshl_add_u32 v9, v8, 4, v9
    s_add_u32 s41, s78, 6144
    s_add_u32 m0, s79, 71680
    s_nop 0
    buffer_load_dwordx4 v9, s[44:47], s41 offen lds
    s_and_b32 s40, s68, 1
    s_lshl_b32 s40, s40, 2
    s_or_b32 s40, s40, 3
    v_xor_b32 v9, s40, v7
    v_lshlrev_b32 v9, 5, v9
    v_lshl_add_u32 v9, v8, 4, v9
    s_add_u32 s41, s78, 7168
    s_add_u32 m0, s79, 72704
    s_nop 0
    buffer_load_dwordx4 v9, s[44:47], s41 offen lds
    s_waitcnt vmcnt(0)
    s_barrier
    s_endpgm
L_k4l1_comp:
    s_mov_b32 s40, 0
    buffer_load_dwordx4 v[32:35], v3, s[24:27], s40 offen
    s_mov_b32 s40, 4096
    buffer_load_dwordx4 v[36:39], v3, s[24:27], s40 offen
    s_mov_b32 s40, 8192
    buffer_load_dwordx4 v[40:43], v3, s[24:27], s40 offen
    s_mov_b32 s40, 12288
    buffer_load_dwordx4 v[44:47], v3, s[24:27], s40 offen
    s_mov_b32 s40, 16384
    buffer_load_dwordx4 v[48:51], v3, s[24:27], s40 offen
    s_mov_b32 s40, 20480
    buffer_load_dwordx4 v[52:55], v3, s[24:27], s40 offen
    s_mov_b32 s40, 24576
    buffer_load_dwordx4 v[56:59], v3, s[24:27], s40 offen
    s_mov_b32 s40, 28672
    buffer_load_dwordx4 v[60:63], v3, s[24:27], s40 offen
    s_mov_b32 s28, s10
    s_and_b32 s29, s11, 0xffff
    s_mov_b32 s30, 1024
    s_mov_b32 s31, 0x00020000
    v_lshlrev_b32 v4, 4, v1
    buffer_load_dwordx4 v[64:67], v4, s[28:31], 0 offen
    s_add_u32 s32, s4, 8454144
    s_addc_u32 s33, s5, 0
    s_and_b32 s33, s33, 0xffff
    s_mov_b32 s34, 65536
    s_mov_b32 s35, 0x00020000
    s_lshl_b32 s77, s68, 13
    v_mov_b32 v5, 115840
    v_mov_b32 v6, 0
    ds_write_b32 v5, v6
    s_waitcnt lgkmcnt(0)
    s_barrier
    v_mov_b32 v8, 0x3f803f80
    v_mov_b32 v9, 0
    s_waitcnt vmcnt(0)
    v_dot2c_f32_bf16 v9, v64, v8
    v_dot2c_f32_bf16 v9, v65, v8
    v_dot2c_f32_bf16 v9, v66, v8
    v_dot2c_f32_bf16 v9, v67, v8
    s_nop 2
    v_add_f32_dpp v9, v9, v9 quad_perm:[1,0,3,2] row_mask:0xf bank_mask:0xf
    s_nop 1
    v_add_f32_dpp v9, v9, v9 quad_perm:[2,3,0,1] row_mask:0xf bank_mask:0xf
    s_nop 1
    v_add_f32_dpp v9, v9, v9 row_half_mirror row_mask:0xf bank_mask:0xf
    s_nop 1
    v_add_f32_dpp v9, v9, v9 row_mirror row_mask:0xf bank_mask:0xf
    v_mov_b32 v10, v9
    s_nop 1
    v_permlane16_swap_b32 v9, v10
    v_add_f32 v9, v9, v10
    v_mov_b32 v10, v9
    s_nop 1
    v_permlane32_swap_b32 v9, v10
    v_add_f32 v9, v9, v10
    v_mul_f32 v32, s73, v32
    v_mul_f32 v36, s73, v36
    v_mul_f32 v40, s73, v40
    v_mul_f32 v44, s73, v44
    v_mul_f32 v48, s73, v48
    v_mul_f32 v52, s73, v52
    v_mul_f32 v56, s73, v56
    v_mul_f32 v60, s73, v60
    v_mul_f32 v33, s73, v33
    v_mul_f32 v37, s73, v37
    v_mul_f32 v41, s73, v41
    v_mul_f32 v45, s73, v45
    v_mul_f32 v49, s73, v49
    v_mul_f32 v53, s73, v53
    v_mul_f32 v57, s73, v57
    v_mul_f32 v61, s73, v61
    v_fma_f32 v33, -v32, v32, v33
    v_fma_f32 v37, -v36, v36, v37
    v_fma_f32 v41, -v40, v40, v41
    v_fma_f32 v45, -v44, v44, v45
    v_fma_f32 v49, -v48, v48, v49
    v_fma_f32 v53, -v52, v52, v53
    v_fma_f32 v57, -v56, v56, v57
    v_fma_f32 v61, -v60, v60, v61
    v_max_f32 v33, 0, v33
    v_max_f32 v37, 0, v37
    v_max_f32 v41, 0, v41
    v_max_f32 v45, 0, v45
    v_max_f32 v49, 0, v49
    v_max_f32 v53, 0, v53
    v_max_f32 v57, 0, v57
    v_max_f32 v61, 0, v61
    v_cvt_pk_bf16_f32 v35, v32, v33
    v_cvt_pk_bf16_f32 v39, v36, v37
    v_cvt_pk_bf16_f32 v43, v40, v41
    v_cvt_pk_bf16_f32 v47, v44, v45
    v_cvt_pk_bf16_f32 v51, v48, v49
    v_cvt_pk_bf16_f32 v55, v52, v53
    v_cvt_pk_bf16_f32 v59, v56, v57
    v_cvt_pk_bf16_f32 v63, v60, v61
    v_lshlrev_b32 v32, 16, v35
    v_lshlrev_b32 v36, 16, v39
    v_lshlrev_b32 v40, 16, v43
    v_lshlrev_b32 v44, 16, v47
    v_lshlrev_b32 v48, 16, v51
    v_lshlrev_b32 v52, 16, v55
    v_lshlrev_b32 v56, 16, v59
    v_lshlrev_b32 v60, 16, v63
    v_and_b32 v33, s72, v35
    v_and_b32 v37, s72, v39
    v_and_b32 v41, s72, v43
    v_and_b32 v45, s72, v47
    v_and_b32 v49, s72, v51
    v_and_b32 v53, s72, v55
    v_and_b32 v57, s72, v59
    v_and_b32 v61, s72, v63
    v_add_f32 v33, s74, v33
    v_add_f32 v37, s74, v37
    v_add_f32 v41, s74, v41
    v_add_f32 v45, s74, v45
    v_add_f32 v49, s74, v49
    v_add_f32 v53, s74, v53
    v_add_f32 v57, s74, v57
    v_add_f32 v61, s74, v61
    v_cvt_pk_bf16_f32 v33, v33, v33
    v_cvt_pk_bf16_f32 v37, v37, v37
    v_cvt_pk_bf16_f32 v41, v41, v41
    v_cvt_pk_bf16_f32 v45, v45, v45
    v_cvt_pk_bf16_f32 v49, v49, v49
    v_cvt_pk_bf16_f32 v53, v53, v53
    v_cvt_pk_bf16_f32 v57, v57, v57
    v_cvt_pk_bf16_f32 v61, v61, v61
    v_lshlrev_b32 v33, 16, v33
    v_lshlrev_b32 v37, 16, v37
    v_lshlrev_b32 v41, 16, v41
    v_lshlrev_b32 v45, 16, v45
    v_lshlrev_b32 v49, 16, v49
    v_lshlrev_b32 v53, 16, v53
    v_lshlrev_b32 v57, 16, v57
    v_lshlrev_b32 v61, 16, v61
    v_sqrt_f32 v33, v33
    v_sqrt_f32 v37, v37
    v_sqrt_f32 v41, v41
    v_sqrt_f32 v45, v45
    v_sqrt_f32 v49, v49
    v_sqrt_f32 v53, v53
    v_sqrt_f32 v57, v57
    v_sqrt_f32 v61, v61
    v_cvt_pk_bf16_f32 v33, v33, v33
    v_cvt_pk_bf16_f32 v37, v37, v37
    v_cvt_pk_bf16_f32 v41, v41, v41
    v_cvt_pk_bf16_f32 v45, v45, v45
    v_cvt_pk_bf16_f32 v49, v49, v49
    v_cvt_pk_bf16_f32 v53, v53, v53
    v_cvt_pk_bf16_f32 v57, v57, v57
    v_cvt_pk_bf16_f32 v61, v61, v61
    v_lshlrev_b32 v33, 16, v33
    v_lshlrev_b32 v37, 16, v37
    v_lshlrev_b32 v41, 16, v41
    v_lshlrev_b32 v45, 16, v45
    v_lshlrev_b32 v49, 16, v49
    v_lshlrev_b32 v53, 16, v53
    v_lshlrev_b32 v57, 16, v57
    v_lshlrev_b32 v61, 16, v61
    v_rcp_f32 v33, v33
    v_rcp_f32 v37, v37
    v_rcp_f32 v41, v41
    v_rcp_f32 v45, v45
    v_rcp_f32 v49, v49
    v_rcp_f32 v53, v53
    v_rcp_f32 v57, v57
    v_rcp_f32 v61, v61
    v_fma_f32 v34, -v32, v9, v34
    v_fma_f32 v38, -v36, v9, v38
    v_fma_f32 v42, -v40, v9, v42
    v_fma_f32 v46, -v44, v9, v46
    v_fma_f32 v50, -v48, v9, v50
    v_fma_f32 v54, -v52, v9, v54
    v_fma_f32 v58, -v56, v9, v58
    v_fma_f32 v62, -v60, v9, v62
    v_mul_f32 v34, v34, v33
    v_mul_f32 v38, v38, v37
    v_mul_f32 v42, v42, v41
    v_mul_f32 v46, v46, v45
    v_mul_f32 v50, v50, v49
    v_mul_f32 v54, v54, v53
    v_mul_f32 v58, v58, v57
    v_mul_f32 v62, v62, v61
    v_cvt_pk_bf16_f32 v34, v34, v34
    v_cvt_pk_bf16_f32 v38, v38, v38
    v_cvt_pk_bf16_f32 v42, v42, v42
    v_cvt_pk_bf16_f32 v46, v46, v46
    v_cvt_pk_bf16_f32 v50, v50, v50
    v_cvt_pk_bf16_f32 v54, v54, v54
    v_cvt_pk_bf16_f32 v58, v58, v58
    v_cvt_pk_bf16_f32 v62, v62, v62
    v_lshlrev_b32 v34, 16, v34
    v_lshlrev_b32 v38, 16, v38
    v_lshlrev_b32 v42, 16, v42
    v_lshlrev_b32 v46, 16, v46
    v_lshlrev_b32 v50, 16, v50
    v_lshlrev_b32 v54, 16, v54
    v_lshlrev_b32 v58, 16, v58
    v_lshlrev_b32 v62, 16, v62
    v_ashrrev_i32 v35, 31, v34
    v_ashrrev_i32 v39, 31, v38
    v_ashrrev_i32 v43, 31, v42
    v_ashrrev_i32 v47, 31, v46
    v_ashrrev_i32 v51, 31, v50
    v_ashrrev_i32 v55, 31, v54
    v_ashrrev_i32 v59, 31, v58
    v_ashrrev_i32 v63, 31, v62
    v_or_b32 v35, 0x80000000, v35
    v_or_b32 v39, 0x80000000, v39
    v_or_b32 v43, 0x80000000, v43
    v_or_b32 v47, 0x80000000, v47
    v_or_b32 v51, 0x80000000, v51
    v_or_b32 v55, 0x80000000, v55
    v_or_b32 v59, 0x80000000, v59
    v_or_b32 v63, 0x80000000, v63
    v_xor_b32 v34, v34, v35
    v_xor_b32 v38, v38, v39
    v_xor_b32 v42, v42, v43
    v_xor_b32 v46, v46, v47
    v_xor_b32 v50, v50, v51
    v_xor_b32 v54, v54, v55
    v_xor_b32 v58, v58, v59
    v_xor_b32 v62, v62, v63
    v_sub_u32 v35, 2047, v0
    v_sub_u32 v39, 1791, v0
    v_sub_u32 v43, 1535, v0
    v_sub_u32 v47, 1279, v0
    v_sub_u32 v51, 1023, v0
    v_sub_u32 v55, 767, v0
    v_sub_u32 v59, 511, v0
    v_sub_u32 v63, 255, v0
    v_and_or_b32 v16, v34, s72, v35
    v_and_or_b32 v17, v38, s72, v39
    v_and_or_b32 v18, v42, s72, v43
    v_and_or_b32 v19, v46, s72, v47
    v_and_or_b32 v20, v50, s72, v51
    v_and_or_b32 v21, v54, s72, v55
    v_and_or_b32 v22, v58, s72, v59
    v_and_or_b32 v23, v62, s72, v63
    v_max_u32 v24, v16, v17
    v_min_u32 v17, v16, v17
    v_max_u32 v16, v18, v19
    v_min_u32 v19, v18, v19
    v_max_u32 v18, v20, v21
    v_min_u32 v21, v20, v21
    v_max_u32 v20, v22, v23
    v_min_u32 v23, v22, v23
    v_max_u32 v22, v24, v16
    v_min_u32 v16, v24, v16
    v_max_u32 v24, v17, v19
    v_min_u32 v19, v17, v19
    v_max_u32 v17, v18, v20
    v_min_u32 v20, v18, v20
    v_max_u32 v18, v21, v23
    v_min_u32 v23, v21, v23
    v_max_u32 v21, v24, v16
    v_min_u32 v16, v24, v16
    v_max_u32 v24, v18, v20
    v_min_u32 v20, v18, v20
    v_max_u32 v18, v22, v17
    v_min_u32 v17, v22, v17
    v_max_u32 v22, v19, v23
    v_min_u32 v23, v19, v23
    v_max_u32 v19, v21, v24
    v_min_u32 v24, v21, v24
    v_max_u32 v21, v16, v20
    v_min_u32 v20, v16, v20
    v_max_u32 v16, v19, v17
    v_min_u32 v17, v19, v17
    v_max_u32 v19, v22, v20
    v_min_u32 v20, v22, v20
    v_max_u32 v22, v21, v17
    v_min_u32 v17, v21, v17
    v_max_u32 v21, v19, v24
    v_min_u32 v24, v19, v24
    v_max_u32 v19, v21, v17
    v_min_u32 v17, v21, v17
    v_mov_b32 v26, 0
    v_max_u32_dpp v25, v18, v18 quad_perm:[1,0,3,2] row_mask:0xf bank_mask:0xf
    s_nop 1
    v_max_u32_dpp v25, v25, v25 quad_perm:[2,3,0,1] row_mask:0xf bank_mask:0xf
    s_nop 1
    v_max_u32_dpp v25, v25, v25 row_half_mirror row_mask:0xf bank_mask:0xf
    s_nop 1
    v_max_u32_dpp v25, v25, v25 row_mirror row_mask:0xf bank_mask:0xf
    s_nop 1
    v_max_u32_dpp v25, v25, v25 row_bcast:15 row_mask:0xa bank_mask:0xf
    s_nop 1
    v_max_u32_dpp v25, v25, v25 row_bcast:31 row_mask:0xc bank_mask:0xf
    s_nop 0
    v_readlane_b32 s50, v25, 63
    s_nop 1
    v_writelane_b32 v26, s50, 0
    v_cmp_eq_u32 vcc, s50, v18
    s_nop 1
    v_cndmask_b32 v18, v18, v16, vcc
    v_cndmask_b32 v16, v16, v22, vcc
    v_cndmask_b32 v22, v22, v19, vcc
    v_cndmask_b32 v19, v19, v17, vcc
    v_cndmask_b32 v17, v17, v24, vcc
    v_cndmask_b32 v24, v24, v20, vcc
    v_cndmask_b32 v20, v20, v23, vcc
    v_max_u32_dpp v25, v18, v18 quad_perm:[1,0,3,2] row_mask:0xf bank_mask:0xf
    s_nop 1
    v_max_u32_dpp v25, v25, v25 quad_perm:[2,3,0,1] row_mask:0xf bank_mask:0xf
    s_nop 1
    v_max_u32_dpp v25, v25, v25 row_half_mirror row_mask:0xf bank_mask:0xf
    s_nop 1
    v_max_u32_dpp v25, v25, v25 row_mirror row_mask:0xf bank_mask:0xf
    s_nop 1
    v_max_u32_dpp v25, v25, v25 row_bcast:15 row_mask:0xa bank_mask:0xf
    s_nop 1
    v_max_u32_dpp v25, v25, v25 row_bcast:31 row_mask:0xc bank_mask:0xf
    s_nop 0
    v_readlane_b32 s51, v25, 63
    s_nop 1
    v_writelane_b32 v26, s51, 1
    v_cmp_eq_u32 vcc, s51, v18
    s_nop 1
    v_cndmask_b32 v18, v18, v16, vcc
    v_cndmask_b32 v16, v16, v22, vcc
    v_cndmask_b32 v22, v22, v19, vcc
    v_cndmask_b32 v19, v19, v17, vcc
    v_cndmask_b32 v17, v17, v24, vcc
    v_cndmask_b32 v24, v24, v20, vcc
    v_max_u32_dpp v25, v18, v18 quad_perm:[1,0,3,2] row_mask:0xf bank_mask:0xf
    s_nop 1
    v_max_u32_dpp v25, v25, v25 quad_perm:[2,3,0,1] row_mask:0xf bank_mask:0xf
    s_nop 1
    v_max_u32_dpp v25, v25, v25 row_half_mirror row_mask:0xf bank_mask:0xf
    s_nop 1
    v_max_u32_dpp v25, v25, v25 row_mirror row_mask:0xf bank_mask:0xf
    s_nop 1
    v_max_u32_dpp v25, v25, v25 row_bcast:15 row_mask:0xa bank_mask:0xf
    s_nop 1
    v_max_u32_dpp v25, v25, v25 row_bcast:31 row_mask:0xc bank_mask:0xf
    s_nop 0
    v_readlane_b32 s52, v25, 63
    s_nop 1
    v_writelane_b32 v26, s52, 2
    v_cmp_eq_u32 vcc, s52, v18
    s_nop 1
    v_cndmask_b32 v18, v18, v16, vcc
    v_cndmask_b32 v16, v16, v22, vcc
    v_cndmask_b32 v22, v22, v19, vcc
    v_cndmask_b32 v19, v19, v17, vcc
    v_cndmask_b32 v17, v17, v24, vcc
    v_max_u32_dpp v25, v18, v18 quad_perm:[1,0,3,2] row_mask:0xf bank_mask:0xf
    s_nop 1
    v_max_u32_dpp v25, v25, v25 quad_perm:[2,3,0,1] row_mask:0xf bank_mask:0xf
    s_nop 1
    v_max_u32_dpp v25, v25, v25 row_half_mirror row_mask:0xf bank_mask:0xf
    s_nop 1
    v_max_u32_dpp v25, v25, v25 row_mirror row_mask:0xf bank_mask:0xf
    s_nop 1
    v_max_u32_dpp v25, v25, v25 row_bcast:15 row_mask:0xa bank_mask:0xf
    s_nop 1
    v_max_u32_dpp v25, v25, v25 row_bcast:31 row_mask:0xc bank_mask:0xf
    s_nop 0
    v_readlane_b32 s53, v25, 63
    s_nop 1
    v_writelane_b32 v26, s53, 3
    v_cmp_eq_u32 vcc, s53, v18
    s_nop 1
    v_cndmask_b32 v18, v18, v16, vcc
    v_cndmask_b32 v16, v16, v22, vcc
    v_cndmask_b32 v22, v22, v19, vcc
    v_cndmask_b32 v19, v19, v17, vcc
    v_max_u32_dpp v25, v18, v18 quad_perm:[1,0,3,2] row_mask:0xf bank_mask:0xf
    s_nop 1
    v_max_u32_dpp v25, v25, v25 quad_perm:[2,3,0,1] row_mask:0xf bank_mask:0xf
    s_nop 1
    v_max_u32_dpp v25, v25, v25 row_half_mirror row_mask:0xf bank_mask:0xf
    s_nop 1
    v_max_u32_dpp v25, v25, v25 row_mirror row_mask:0xf bank_mask:0xf
    s_nop 1
    v_max_u32_dpp v25, v25, v25 row_bcast:15 row_mask:0xa bank_mask:0xf
    s_nop 1
    v_max_u32_dpp v25, v25, v25 row_bcast:31 row_mask:0xc bank_mask:0xf
    s_nop 0
    v_readlane_b32 s54, v25, 63
    s_nop 1
    v_writelane_b32 v26, s54, 4
    v_cmp_eq_u32 vcc, s54, v18
    s_nop 1
    v_cndmask_b32 v18, v18, v16, vcc
    v_cndmask_b32 v16, v16, v22, vcc
    v_cndmask_b32 v22, v22, v19, vcc
    v_max_u32_dpp v25, v18, v18 quad_perm:[1,0,3,2] row_mask:0xf bank_mask:0xf
    s_nop 1
    v_max_u32_dpp v25, v25, v25 quad_perm:[2,3,0,1] row_mask:0xf bank_mask:0xf
    s_nop 1
    v_max_u32_dpp v25, v25, v25 row_half_mirror row_mask:0xf bank_mask:0xf
    s_nop 1
    v_max_u32_dpp v25, v25, v25 row_mirror row_mask:0xf bank_mask:0xf
    s_nop 1
    v_max_u32_dpp v25, v25, v25 row_bcast:15 row_mask:0xa bank_mask:0xf
    s_nop 1
    v_max_u32_dpp v25, v25, v25 row_bcast:31 row_mask:0xc bank_mask:0xf
    s_nop 0
    v_readlane_b32 s55, v25, 63
    s_nop 1
    v_writelane_b32 v26, s55, 5
    v_cmp_eq_u32 vcc, s55, v18
    s_nop 1
    v_cndmask_b32 v18, v18, v16, vcc
    v_cndmask_b32 v16, v16, v22, vcc
    s_nop 0
    v_max_u32_dpp v25, v18, v18 quad_perm:[1,0,3,2] row_mask:0xf bank_mask:0xf
    s_nop 1
    v_max_u32_dpp v25, v25, v25 quad_perm:[2,3,0,1] row_mask:0xf bank_mask:0xf
    s_nop 1
    v_max_u32_dpp v25, v25, v25 row_half_mirror row_mask:0xf bank_mask:0xf
    s_nop 1
    v_max_u32_dpp v25, v25, v25 row_mirror row_mask:0xf bank_mask:0xf
    s_nop 1
    v_max_u32_dpp v25, v25, v25 row_bcast:15 row_mask:0xa bank_mask:0xf
    s_nop 1
    v_max_u32_dpp v25, v25, v25 row_bcast:31 row_mask:0xc bank_mask:0xf
    s_nop 0
    v_readlane_b32 s56, v25, 63
    s_nop 1
    v_writelane_b32 v26, s56, 6
    v_cmp_eq_u32 vcc, s56, v18
    s_nop 1
    v_cndmask_b32 v18, v18, v16, vcc
    s_nop 1
    v_max_u32_dpp v25, v18, v18 quad_perm:[1,0,3,2] row_mask:0xf bank_mask:0xf
    s_nop 1
    v_max_u32_dpp v25, v25, v25 quad_perm:[2,3,0,1] row_mask:0xf bank_mask:0xf
    s_nop 1
    v_max_u32_dpp v25, v25, v25 row_half_mirror row_mask:0xf bank_mask:0xf
    s_nop 1
    v_max_u32_dpp v25, v25, v25 row_mirror row_mask:0xf bank_mask:0xf
    s_nop 1
    v_max_u32_dpp v25, v25, v25 row_bcast:15 row_mask:0xa bank_mask:0xf
    s_nop 1
    v_max_u32_dpp v25, v25, v25 row_bcast:31 row_mask:0xc bank_mask:0xf
    s_nop 0
    v_readlane_b32 s57, v25, 63
    s_nop 1
    v_writelane_b32 v26, s57, 7
    s_lshl_b32 s40, s68, 5
    v_lshlrev_b32 v27, 2, v1
    v_add_u32 v27, s40, v27
    v_add_u32 v27, 98304, v27
    v_cmp_gt_u32 vcc, 8, v1
    s_nop 0
    s_and_saveexec_b64 s[48:49], vcc
    ds_write_b32 v27, v26 offset:16384
    s_mov_b64 exec, 1
    v_mov_b32 v6, 1
    ds_add_u32 v5, v6
    s_mov_b64 exec, s[48:49]
L_k4l1_poll:
    ds_read_b32 v6, v5
    s_waitcnt lgkmcnt(0)
    v_readfirstlane_b32 s40, v6
    s_nop 0
    s_cmp_lt_u32 s40, 4
    s_cbranch_scc1 L_k4l1_poll
    v_and_b32 v27, 31, v1
    v_lshlrev_b32 v27, 2, v27
    v_add_u32 v27, 98304, v27
    ds_read_b32 v28, v27 offset:16384
    v_mov_b32 v26, 0
    s_waitcnt lgkmcnt(0)
    v_max_u32_dpp v25, v28, v28 quad_perm:[1,0,3,2] row_mask:0xf bank_mask:0xf
    s_nop 1
    v_max_u32_dpp v25, v25, v25 quad_perm:[2,3,0,1] row_mask:0xf bank_mask:0xf
    s_nop 1
    v_max_u32_dpp v25, v25, v25 row_half_mirror row_mask:0xf bank_mask:0xf
    s_nop 1
    v_max_u32_dpp v25, v25, v25 row_mirror row_mask:0xf bank_mask:0xf
    s_nop 1
    v_max_u32_dpp v25, v25, v25 row_bcast:15 row_mask:0xa bank_mask:0xf
    s_nop 1
    v_max_u32_dpp v25, v25, v25 row_bcast:31 row_mask:0xc bank_mask:0xf
    s_nop 0
    v_readlane_b32 s58, v25, 63
    s_nop 1
    v_writelane_b32 v26, s58, 0
    v_cmp_eq_u32 vcc, s58, v28
    s_nop 1
    v_cndmask_b32 v28, v28, 0, vcc
    s_nop 1
    v_max_u32_dpp v25, v28, v28 quad_perm:[1,0,3,2] row_mask:0xf bank_mask:0xf
    s_nop 1
    v_max_u32_dpp v25, v25, v25 quad_perm:[2,3,0,1] row_mask:0xf bank_mask:0xf
    s_nop 1
    v_max_u32_dpp v25, v25, v25 row_half_mirror row_mask:0xf bank_mask:0xf
    s_nop 1
    v_max_u32_dpp v25, v25, v25 row_mirror row_mask:0xf bank_mask:0xf
    s_nop 1
    v_max_u32_dpp v25, v25, v25 row_bcast:15 row_mask:0xa bank_mask:0xf
    s_nop 1
    v_max_u32_dpp v25, v25, v25 row_bcast:31 row_mask:0xc bank_mask:0xf
    s_nop 0
    v_readlane_b32 s59, v25, 63
    s_nop 1
    v_writelane_b32 v26, s59, 1
    v_cmp_eq_u32 vcc, s59, v28
    s_nop 1
    v_cndmask_b32 v28, v28, 0, vcc
    s_nop 1
    v_max_u32_dpp v25, v28, v28 quad_perm:[1,0,3,2] row_mask:0xf bank_mask:0xf
    s_nop 1
    v_max_u32_dpp v25, v25, v25 quad_perm:[2,3,0,1] row_mask:0xf bank_mask:0xf
    s_nop 1
    v_max_u32_dpp v25, v25, v25 row_half_mirror row_mask:0xf bank_mask:0xf
    s_nop 1
    v_max_u32_dpp v25, v25, v25 row_mirror row_mask:0xf bank_mask:0xf
    s_nop 1
    v_max_u32_dpp v25, v25, v25 row_bcast:15 row_mask:0xa bank_mask:0xf
    s_nop 1
    v_max_u32_dpp v25, v25, v25 row_bcast:31 row_mask:0xc bank_mask:0xf
    s_nop 0
    v_readlane_b32 s60, v25, 63
    s_nop 1
    v_writelane_b32 v26, s60, 2
    v_cmp_eq_u32 vcc, s60, v28
    s_nop 1
    v_cndmask_b32 v28, v28, 0, vcc
    s_nop 1
    v_max_u32_dpp v25, v28, v28 quad_perm:[1,0,3,2] row_mask:0xf bank_mask:0xf
    s_nop 1
    v_max_u32_dpp v25, v25, v25 quad_perm:[2,3,0,1] row_mask:0xf bank_mask:0xf
    s_nop 1
    v_max_u32_dpp v25, v25, v25 row_half_mirror row_mask:0xf bank_mask:0xf
    s_nop 1
    v_max_u32_dpp v25, v25, v25 row_mirror row_mask:0xf bank_mask:0xf
    s_nop 1
    v_max_u32_dpp v25, v25, v25 row_bcast:15 row_mask:0xa bank_mask:0xf
    s_nop 1
    v_max_u32_dpp v25, v25, v25 row_bcast:31 row_mask:0xc bank_mask:0xf
    s_nop 0
    v_readlane_b32 s61, v25, 63
    s_nop 1
    v_writelane_b32 v26, s61, 3
    v_cmp_eq_u32 vcc, s61, v28
    s_nop 1
    v_cndmask_b32 v28, v28, 0, vcc
    s_nop 1
    v_max_u32_dpp v25, v28, v28 quad_perm:[1,0,3,2] row_mask:0xf bank_mask:0xf
    s_nop 1
    v_max_u32_dpp v25, v25, v25 quad_perm:[2,3,0,1] row_mask:0xf bank_mask:0xf
    s_nop 1
    v_max_u32_dpp v25, v25, v25 row_half_mirror row_mask:0xf bank_mask:0xf
    s_nop 1
    v_max_u32_dpp v25, v25, v25 row_mirror row_mask:0xf bank_mask:0xf
    s_nop 1
    v_max_u32_dpp v25, v25, v25 row_bcast:15 row_mask:0xa bank_mask:0xf
    s_nop 1
    v_max_u32_dpp v25, v25, v25 row_bcast:31 row_mask:0xc bank_mask:0xf
    s_nop 0
    v_readlane_b32 s62, v25, 63
    s_nop 1
    v_writelane_b32 v26, s62, 4
    v_cmp_eq_u32 vcc, s62, v28
    s_nop 1
    v_cndmask_b32 v28, v28, 0, vcc
    s_nop 1
    v_max_u32_dpp v25, v28, v28 quad_perm:[1,0,3,2] row_mask:0xf bank_mask:0xf
    s_nop 1
    v_max_u32_dpp v25, v25, v25 quad_perm:[2,3,0,1] row_mask:0xf bank_mask:0xf
    s_nop 1
    v_max_u32_dpp v25, v25, v25 row_half_mirror row_mask:0xf bank_mask:0xf
    s_nop 1
    v_max_u32_dpp v25, v25, v25 row_mirror row_mask:0xf bank_mask:0xf
    s_nop 1
    v_max_u32_dpp v25, v25, v25 row_bcast:15 row_mask:0xa bank_mask:0xf
    s_nop 1
    v_max_u32_dpp v25, v25, v25 row_bcast:31 row_mask:0xc bank_mask:0xf
    s_nop 0
    v_readlane_b32 s63, v25, 63
    s_nop 1
    v_writelane_b32 v26, s63, 5
    v_cmp_eq_u32 vcc, s63, v28
    s_nop 1
    v_cndmask_b32 v28, v28, 0, vcc
    s_nop 1
    v_max_u32_dpp v25, v28, v28 quad_perm:[1,0,3,2] row_mask:0xf bank_mask:0xf
    s_nop 1
    v_max_u32_dpp v25, v25, v25 quad_perm:[2,3,0,1] row_mask:0xf bank_mask:0xf
    s_nop 1
    v_max_u32_dpp v25, v25, v25 row_half_mirror row_mask:0xf bank_mask:0xf
    s_nop 1
    v_max_u32_dpp v25, v25, v25 row_mirror row_mask:0xf bank_mask:0xf
    s_nop 1
    v_max_u32_dpp v25, v25, v25 row_bcast:15 row_mask:0xa bank_mask:0xf
    s_nop 1
    v_max_u32_dpp v25, v25, v25 row_bcast:31 row_mask:0xc bank_mask:0xf
    s_nop 0
    v_readlane_b32 s64, v25, 63
    s_nop 1
    v_writelane_b32 v26, s64, 6
    v_cmp_eq_u32 vcc, s64, v28
    s_nop 1
    v_cndmask_b32 v28, v28, 0, vcc
    s_nop 1
    v_max_u32_dpp v25, v28, v28 quad_perm:[1,0,3,2] row_mask:0xf bank_mask:0xf
    s_nop 1
    v_max_u32_dpp v25, v25, v25 quad_perm:[2,3,0,1] row_mask:0xf bank_mask:0xf
    s_nop 1
    v_max_u32_dpp v25, v25, v25 row_half_mirror row_mask:0xf bank_mask:0xf
    s_nop 1
    v_max_u32_dpp v25, v25, v25 row_mirror row_mask:0xf bank_mask:0xf
    s_nop 1
    v_max_u32_dpp v25, v25, v25 row_bcast:15 row_mask:0xa bank_mask:0xf
    s_nop 1
    v_max_u32_dpp v25, v25, v25 row_bcast:31 row_mask:0xc bank_mask:0xf
    s_nop 0
    v_readlane_b32 s65, v25, 63
    s_nop 1
    v_writelane_b32 v26, s65, 7
    v_and_b32 v27, 7, v1
    v_lshlrev_b32 v27, 2, v27
    ds_bpermute_b32 v28, v27, v26
    v_lshrrev_b32 v61, 4, v1
    s_or_b32 s40, s2, s68
    s_cmp_lg_u32 s40, 0
    s_cbranch_scc1 L_k4l1_nokeys
    v_lshlrev_b32 v27, 2, v1
    v_cmp_gt_u32 vcc, 8, v1
    s_nop 0
    s_and_saveexec_b64 s[48:49], vcc
    s_mov_b32 s40, 32768
    buffer_store_dword v26, v27, s[32:35], s40 offen
    s_mov_b64 exec, s[48:49]
L_k4l1_nokeys:
    s_waitcnt lgkmcnt(0)
    v_and_b32 v28, 0x7ff, v28
    v_sub_u32 v28, 2047, v28
    v_lshlrev_b32 v29, 10, v28
    v_lshl_add_u32 v29, v61, 4, v29
    s_lshl_b32 s40, s68, 8
    v_lshlrev_b32 v30, 4, v28
    buffer_load_dwordx2 v[14:15], v30, s[24:27], 0 offen
    buffer_load_dwordx4 v[32:35], v29, s[12:15], s40 offen offset:0
    buffer_load_dwordx4 v[36:39], v29, s[12:15], s40 offen offset:64
    buffer_load_dwordx4 v[40:43], v29, s[12:15], s40 offen offset:128
    buffer_load_dwordx4 v[44:47], v29, s[12:15], s40 offen offset:192
    v_bfe_u32 v62, v1, 2, 2
    v_lshl_add_u32 v62, v61, 3, v62
    v_lshlrev_b32 v62, 6, v62
    v_and_b32 v63, 1, v61
    v_lshl_add_u32 v62, v63, 5, v62
    v_and_b32 v63, 3, v1
    v_lshl_add_u32 v62, v63, 3, v62
    v_add_u32 v62, s77, v62
    v_xor_b32 v63, 32, v62
    s_barrier
    ds_read_b64_tr_b16 v[64:65], v62 offset:0
    ds_read_b64_tr_b16 v[66:67], v62 offset:256
    ds_read_b64_tr_b16 v[80:81], v63 offset:0
    ds_read_b64_tr_b16 v[82:83], v63 offset:256
    ds_read_b64_tr_b16 v[96:97], v62 offset:32768
    ds_read_b64_tr_b16 v[98:99], v62 offset:33024
    ds_read_b64_tr_b16 v[112:113], v63 offset:32768
    ds_read_b64_tr_b16 v[114:115], v63 offset:33024
    ds_read_b64_tr_b16 v[68:69], v62 offset:2048
    ds_read_b64_tr_b16 v[70:71], v62 offset:2304
    ds_read_b64_tr_b16 v[84:85], v63 offset:2048
    ds_read_b64_tr_b16 v[86:87], v63 offset:2304
    s_waitcnt lgkmcnt(10)
    ds_read_b64_tr_b16 v[100:101], v62 offset:34816
    ds_read_b64_tr_b16 v[102:103], v62 offset:35072
    s_waitcnt lgkmcnt(10)
    ds_read_b64_tr_b16 v[116:117], v63 offset:34816
    ds_read_b64_tr_b16 v[118:119], v63 offset:35072
    s_waitcnt lgkmcnt(10)
    ds_read_b64_tr_b16 v[72:73], v62 offset:4096
    ds_read_b64_tr_b16 v[74:75], v62 offset:4352
    s_waitcnt lgkmcnt(10)
    ds_read_b64_tr_b16 v[88:89], v63 offset:4096
    ds_read_b64_tr_b16 v[90:91], v63 offset:4352
    s_waitcnt lgkmcnt(10)
    ds_read_b64_tr_b16 v[104:105], v62 offset:36864
    ds_read_b64_tr_b16 v[106:107], v62 offset:37120
    s_waitcnt lgkmcnt(10)
    ds_read_b64_tr_b16 v[120:121], v63 offset:36864
    ds_read_b64_tr_b16 v[122:123], v63 offset:37120
    s_waitcnt lgkmcnt(10)
    ds_read_b64_tr_b16 v[76:77], v62 offset:6144
    ds_read_b64_tr_b16 v[78:79], v62 offset:6400
    s_waitcnt lgkmcnt(10)
    ds_read_b64_tr_b16 v[92:93], v63 offset:6144
    ds_read_b64_tr_b16 v[94:95], v63 offset:6400
    s_waitcnt lgkmcnt(10)
    ds_read_b64_tr_b16 v[108:109], v62 offset:38912
    ds_read_b64_tr_b16 v[110:111], v62 offset:39168
    s_waitcnt lgkmcnt(10)
    ds_read_b64_tr_b16 v[124:125], v63 offset:38912
    ds_read_b64_tr_b16 v[126:127], v63 offset:39168
    s_waitcnt vmcnt(4)
    v_mul_f32 v12, s73, v14
    v_mul_f32 v13, s73, v15
    v_fma_f32 v13, -v12, v12, v13
    v_max_f32 v13, 0, v13
    v_cvt_pk_bf16_f32 v12, v12, v13
    v_lshlrev_b32 v10, 16, v12
    v_and_b32 v13, s72, v12
    v_add_f32 v13, s74, v13
    v_cvt_pk_bf16_f32 v13, v13, v13
    v_lshlrev_b32 v13, 16, v13
    v_sqrt_f32 v13, v13
    s_nop 0
    v_cvt_pk_bf16_f32 v13, v13, v13
    v_lshlrev_b32 v13, 16, v13
    v_rcp_f32 v11, v13
    s_waitcnt vmcnt(0)
    v_lshlrev_b32 v12, 16, v32
    v_and_b32 v13, s72, v32
    v_sub_f32 v12, v12, v10
    v_sub_f32 v13, v13, v10
    v_cvt_pk_bf16_f32 v12, v12, v13
    v_and_b32 v13, s72, v12
    v_lshlrev_b32 v12, 16, v12
    v_mul_f32 v12, v12, v11
    v_mul_f32 v13, v13, v11
    v_cvt_pk_bf16_f32 v32, v12, v13
    v_lshlrev_b32 v12, 16, v33
    v_and_b32 v13, s72, v33
    v_sub_f32 v12, v12, v10
    v_sub_f32 v13, v13, v10
    v_cvt_pk_bf16_f32 v12, v12, v13
    v_and_b32 v13, s72, v12
    v_lshlrev_b32 v12, 16, v12
    v_mul_f32 v12, v12, v11
    v_mul_f32 v13, v13, v11
    v_cvt_pk_bf16_f32 v33, v12, v13
    v_lshlrev_b32 v12, 16, v34
    v_and_b32 v13, s72, v34
    v_sub_f32 v12, v12, v10
    v_sub_f32 v13, v13, v10
    v_cvt_pk_bf16_f32 v12, v12, v13
    v_and_b32 v13, s72, v12
    v_lshlrev_b32 v12, 16, v12
    v_mul_f32 v12, v12, v11
    v_mul_f32 v13, v13, v11
    v_cvt_pk_bf16_f32 v34, v12, v13
    v_lshlrev_b32 v12, 16, v35
    v_and_b32 v13, s72, v35
    v_sub_f32 v12, v12, v10
    v_sub_f32 v13, v13, v10
    v_cvt_pk_bf16_f32 v12, v12, v13
    v_and_b32 v13, s72, v12
    v_lshlrev_b32 v12, 16, v12
    v_mul_f32 v12, v12, v11
    v_mul_f32 v13, v13, v11
    v_cvt_pk_bf16_f32 v35, v12, v13
    v_lshlrev_b32 v12, 16, v36
    v_and_b32 v13, s72, v36
    v_sub_f32 v12, v12, v10
    v_sub_f32 v13, v13, v10
    v_cvt_pk_bf16_f32 v12, v12, v13
    v_and_b32 v13, s72, v12
    v_lshlrev_b32 v12, 16, v12
    v_mul_f32 v12, v12, v11
    v_mul_f32 v13, v13, v11
    v_cvt_pk_bf16_f32 v36, v12, v13
    v_lshlrev_b32 v12, 16, v37
    v_and_b32 v13, s72, v37
    v_sub_f32 v12, v12, v10
    v_sub_f32 v13, v13, v10
    v_cvt_pk_bf16_f32 v12, v12, v13
    v_and_b32 v13, s72, v12
    v_lshlrev_b32 v12, 16, v12
    v_mul_f32 v12, v12, v11
    v_mul_f32 v13, v13, v11
    v_cvt_pk_bf16_f32 v37, v12, v13
    v_lshlrev_b32 v12, 16, v38
    v_and_b32 v13, s72, v38
    v_sub_f32 v12, v12, v10
    v_sub_f32 v13, v13, v10
    v_cvt_pk_bf16_f32 v12, v12, v13
    v_and_b32 v13, s72, v12
    v_lshlrev_b32 v12, 16, v12
    v_mul_f32 v12, v12, v11
    v_mul_f32 v13, v13, v11
    v_cvt_pk_bf16_f32 v38, v12, v13
    v_lshlrev_b32 v12, 16, v39
    v_and_b32 v13, s72, v39
    v_sub_f32 v12, v12, v10
    v_sub_f32 v13, v13, v10
    v_cvt_pk_bf16_f32 v12, v12, v13
    v_and_b32 v13, s72, v12
    v_lshlrev_b32 v12, 16, v12
    v_mul_f32 v12, v12, v11
    v_mul_f32 v13, v13, v11
    v_cvt_pk_bf16_f32 v39, v12, v13
    v_lshlrev_b32 v12, 16, v40
    v_and_b32 v13, s72, v40
    v_sub_f32 v12, v12, v10
    v_sub_f32 v13, v13, v10
    v_cvt_pk_bf16_f32 v12, v12, v13
    v_and_b32 v13, s72, v12
    v_lshlrev_b32 v12, 16, v12
    v_mul_f32 v12, v12, v11
    v_mul_f32 v13, v13, v11
    v_cvt_pk_bf16_f32 v40, v12, v13
    v_lshlrev_b32 v12, 16, v41
    v_and_b32 v13, s72, v41
    v_sub_f32 v12, v12, v10
    v_sub_f32 v13, v13, v10
    v_cvt_pk_bf16_f32 v12, v12, v13
    v_and_b32 v13, s72, v12
    v_lshlrev_b32 v12, 16, v12
    v_mul_f32 v12, v12, v11
    v_mul_f32 v13, v13, v11
    v_cvt_pk_bf16_f32 v41, v12, v13
    v_lshlrev_b32 v12, 16, v42
    v_and_b32 v13, s72, v42
    v_sub_f32 v12, v12, v10
    v_sub_f32 v13, v13, v10
    v_cvt_pk_bf16_f32 v12, v12, v13
    v_and_b32 v13, s72, v12
    v_lshlrev_b32 v12, 16, v12
    v_mul_f32 v12, v12, v11
    v_mul_f32 v13, v13, v11
    v_cvt_pk_bf16_f32 v42, v12, v13
    v_lshlrev_b32 v12, 16, v43
    v_and_b32 v13, s72, v43
    v_sub_f32 v12, v12, v10
    v_sub_f32 v13, v13, v10
    v_cvt_pk_bf16_f32 v12, v12, v13
    v_and_b32 v13, s72, v12
    v_lshlrev_b32 v12, 16, v12
    v_mul_f32 v12, v12, v11
    v_mul_f32 v13, v13, v11
    v_cvt_pk_bf16_f32 v43, v12, v13
    v_lshlrev_b32 v12, 16, v44
    v_and_b32 v13, s72, v44
    v_sub_f32 v12, v12, v10
    v_sub_f32 v13, v13, v10
    v_cvt_pk_bf16_f32 v12, v12, v13
    v_and_b32 v13, s72, v12
    v_lshlrev_b32 v12, 16, v12
    v_mul_f32 v12, v12, v11
    v_mul_f32 v13, v13, v11
    v_cvt_pk_bf16_f32 v44, v12, v13
    v_lshlrev_b32 v12, 16, v45
    v_and_b32 v13, s72, v45
    v_sub_f32 v12, v12, v10
    v_sub_f32 v13, v13, v10
    v_cvt_pk_bf16_f32 v12, v12, v13
    v_and_b32 v13, s72, v12
    v_lshlrev_b32 v12, 16, v12
    v_mul_f32 v12, v12, v11
    v_mul_f32 v13, v13, v11
    v_cvt_pk_bf16_f32 v45, v12, v13
    v_lshlrev_b32 v12, 16, v46
    v_and_b32 v13, s72, v46
    v_sub_f32 v12, v12, v10
    v_sub_f32 v13, v13, v10
    v_cvt_pk_bf16_f32 v12, v12, v13
    v_and_b32 v13, s72, v12
    v_lshlrev_b32 v12, 16, v12
    v_mul_f32 v12, v12, v11
    v_mul_f32 v13, v13, v11
    v_cvt_pk_bf16_f32 v46, v12, v13
    v_lshlrev_b32 v12, 16, v47
    v_and_b32 v13, s72, v47
    v_sub_f32 v12, v12, v10
    v_sub_f32 v13, v13, v10
    v_cvt_pk_bf16_f32 v12, v12, v13
    v_and_b32 v13, s72, v12
    v_lshlrev_b32 v12, 16, v12
    v_mul_f32 v12, v12, v11
    v_mul_f32 v13, v13, v11
    v_cvt_pk_bf16_f32 v47, v12, v13
    v_mov_b32 v16, 0
    v_mov_b32 v17, 0
    v_mov_b32 v18, 0
    v_mov_b32 v19, 0
    v_mov_b32 v20, 0
    v_mov_b32 v21, 0
    v_mov_b32 v22, 0
    v_mov_b32 v23, 0
    v_mov_b32 v24, 0
    v_mov_b32 v25, 0
    v_mov_b32 v26, 0
    v_mov_b32 v27, 0
    v_mov_b32 v28, 0
    v_mov_b32 v29, 0
    v_mov_b32 v30, 0
    v_mov_b32 v31, 0
    s_waitcnt lgkmcnt(0)
    v_mfma_f32_16x16x32_bf16 v[16:19], v[64:67], v[32:35], v[16:19]
    v_mfma_f32_16x16x32_bf16 v[20:23], v[80:83], v[32:35], v[20:23]
    v_mfma_f32_16x16x32_bf16 v[24:27], v[96:99], v[32:35], v[24:27]
    v_mfma_f32_16x16x32_bf16 v[28:31], v[112:115], v[32:35], v[28:31]
    v_mfma_f32_16x16x32_bf16 v[16:19], v[68:71], v[36:39], v[16:19]
    v_mfma_f32_16x16x32_bf16 v[20:23], v[84:87], v[36:39], v[20:23]
    v_mfma_f32_16x16x32_bf16 v[24:27], v[100:103], v[36:39], v[24:27]
    v_mfma_f32_16x16x32_bf16 v[28:31], v[116:119], v[36:39], v[28:31]
    v_mfma_f32_16x16x32_bf16 v[16:19], v[72:75], v[40:43], v[16:19]
    v_mfma_f32_16x16x32_bf16 v[20:23], v[88:91], v[40:43], v[20:23]
    v_mfma_f32_16x16x32_bf16 v[24:27], v[104:107], v[40:43], v[24:27]
    v_mfma_f32_16x16x32_bf16 v[28:31], v[120:123], v[40:43], v[28:31]
    v_mfma_f32_16x16x32_bf16 v[16:19], v[76:79], v[44:47], v[16:19]
    v_mfma_f32_16x16x32_bf16 v[20:23], v[92:95], v[44:47], v[20:23]
    v_mfma_f32_16x16x32_bf16 v[24:27], v[108:111], v[44:47], v[24:27]
    v_mfma_f32_16x16x32_bf16 v[28:31], v[124:127], v[44:47], v[28:31]
    v_bfe_u32 v60, v1, 2, 2
    v_lshl_add_u32 v36, v61, 3, v60
    v_lshlrev_b32 v36, 10, v36
    v_and_b32 v37, 3, v1
    v_lshl_add_u32 v36, v37, 3, v36
    v_add_u32 v36, 65536, v36
    v_and_b32 v37, 1, v61
    v_lshl_or_b32 v60, v37, 2, v60
    s_lshl_b32 s40, s68, 8
    v_add_u32 v36, s40, v36
    v_xor_b32 v37, 0, v60
    v_lshl_add_u32 v40, v37, 5, v36
    v_xor_b32 v37, 1, v60
    v_lshl_add_u32 v41, v37, 5, v36
    v_xor_b32 v37, 2, v60
    v_lshl_add_u32 v42, v37, 5, v36
    v_xor_b32 v37, 3, v60
    v_lshl_add_u32 v43, v37, 5, v36
    v_xor_b32 v37, 4, v60
    v_lshl_add_u32 v44, v37, 5, v36
    v_xor_b32 v37, 5, v60
    v_lshl_add_u32 v45, v37, 5, v36
    v_xor_b32 v37, 6, v60
    v_lshl_add_u32 v46, v37, 5, v36
    v_xor_b32 v37, 7, v60
    v_lshl_add_u32 v47, v37, 5, v36
    ds_read_b64_tr_b16 v[96:97], v40
    ds_read_b64_tr_b16 v[98:99], v40 offset:4096
    ds_read_b64_tr_b16 v[100:101], v41
    ds_read_b64_tr_b16 v[102:103], v41 offset:4096
    ds_read_b64_tr_b16 v[104:105], v42
    ds_read_b64_tr_b16 v[106:107], v42 offset:4096
    ds_read_b64_tr_b16 v[108:109], v43
    ds_read_b64_tr_b16 v[110:111], v43 offset:4096
    ds_read_b64_tr_b16 v[112:113], v44
    ds_read_b64_tr_b16 v[114:115], v44 offset:4096
    ds_read_b64_tr_b16 v[116:117], v45
    ds_read_b64_tr_b16 v[118:119], v45 offset:4096
    ds_read_b64_tr_b16 v[120:121], v46
    ds_read_b64_tr_b16 v[122:123], v46 offset:4096
    s_waitcnt lgkmcnt(8)
    ds_read_b64_tr_b16 v[124:125], v47
    ds_read_b64_tr_b16 v[126:127], v47 offset:4096
    s_lshl_b32 s40, s68, 12
    v_lshlrev_b32 v56, 4, v1
    v_add_u32 v56, 98304, v56
    v_add_u32 v57, s40, v56
    ds_write_b128 v57, v[16:19] offset:0
    ds_write_b128 v57, v[20:23] offset:1024
    ds_write_b128 v57, v[24:27] offset:2048
    ds_write_b128 v57, v[28:31] offset:3072
    s_waitcnt lgkmcnt(0)
    s_barrier
    s_cmp_ge_u32 s68, 2
    s_cbranch_scc1 L_k4l1_skiph
    s_lshl_b32 s40, s68, 10
    v_add_u32 v57, s40, v56
    ds_read_b128 v[64:67], v57 offset:0
    ds_read_b128 v[68:71], v57 offset:2048
    ds_read_b128 v[72:75], v57 offset:4096
    ds_read_b128 v[76:79], v57 offset:6144
    ds_read_b128 v[80:83], v57 offset:8192
    ds_read_b128 v[84:87], v57 offset:10240
    ds_read_b128 v[88:91], v57 offset:12288
    ds_read_b128 v[92:95], v57 offset:14336
    s_waitcnt lgkmcnt(0)
    v_add_f32 v64, v64, v72
    v_add_f32 v80, v80, v88
    v_add_f32 v65, v65, v73
    v_add_f32 v81, v81, v89
    v_add_f32 v66, v66, v74
    v_add_f32 v82, v82, v90
    v_add_f32 v67, v67, v75
    v_add_f32 v83, v83, v91
    v_add_f32 v68, v68, v76
    v_add_f32 v84, v84, v92
    v_add_f32 v69, v69, v77
    v_add_f32 v85, v85, v93
    v_add_f32 v70, v70, v78
    v_add_f32 v86, v86, v94
    v_add_f32 v71, v71, v79
    v_add_f32 v87, v87, v95
    v_add_f32 v64, v64, v80
    v_add_f32 v65, v65, v81
    v_add_f32 v66, v66, v82
    v_add_f32 v67, v67, v83
    v_add_f32 v68, v68, v84
    v_add_f32 v69, v69, v85
    v_add_f32 v70, v70, v86
    v_add_f32 v71, v71, v87
    v_cvt_pk_bf16_f32 v72, v64, v65
    v_lshlrev_b32 v64, 16, v72
    v_and_b32 v65, s72, v72
    v_cvt_pk_bf16_f32 v72, v66, v67
    v_lshlrev_b32 v66, 16, v72
    v_and_b32 v67, s72, v72
    v_cvt_pk_bf16_f32 v72, v68, v69
    v_lshlrev_b32 v68, 16, v72
    v_and_b32 v69, s72, v72
    v_cvt_pk_bf16_f32 v72, v70, v71
    v_lshlrev_b32 v70, 16, v72
    v_and_b32 v71, s72, v72
    s_mov_b32 s40, 0xbfb8aa3b
    v_mul_f32 v72, s40, v64
    v_mul_f32 v73, s40, v65
    v_mul_f32 v74, s40, v66
    v_mul_f32 v75, s40, v67
    v_exp_f32 v72, v72
    v_exp_f32 v73, v73
    v_exp_f32 v74, v74
    v_exp_f32 v75, v75
    v_add_f32 v72, 1.0, v72
    v_add_f32 v73, 1.0, v73
    v_add_f32 v74, 1.0, v74
    v_add_f32 v75, 1.0, v75
    v_rcp_f32 v72, v72
    v_rcp_f32 v73, v73
    v_rcp_f32 v74, v74
    v_rcp_f32 v75, v75
    v_mul_f32 v64, v64, v72
    v_mul_f32 v65, v65, v73
    v_mul_f32 v66, v66, v74
    v_mul_f32 v67, v67, v75
    v_cvt_pk_bf16_f32 v72, v64, v65
    v_lshlrev_b32 v64, 16, v72
    v_and_b32 v65, s72, v72
    v_cvt_pk_bf16_f32 v72, v66, v67
    v_lshlrev_b32 v66, 16, v72
    v_and_b32 v67, s72, v72
    v_mul_f32 v64, v64, v68
    v_mul_f32 v65, v65, v69
    v_mul_f32 v66, v66, v70
    v_mul_f32 v67, v67, v71
    v_cvt_pk_bf16_f32 v76, v64, v65
    v_cvt_pk_bf16_f32 v77, v66, v67
    v_and_b32 v58, 15, v1
    v_lshlrev_b32 v58, 6, v58
    v_lshl_add_u32 v58, v61, 3, v58
    s_lshl_b32 s40, s68, 5
    v_add_u32 v58, s40, v58
    v_add_u32 v58, 98304, v58
    ds_write_b64 v58, v[76:77] offset:16512
L_k4l1_skiph:
    s_waitcnt lgkmcnt(0)
    s_barrier
    v_and_b32 v58, 15, v1
    v_lshlrev_b32 v59, 6, v58
    v_lshl_add_u32 v59, v61, 4, v59
    v_add_u32 v59, 98304, v59
    ds_read_b128 v[32:35], v59 offset:16512
    s_add_u32 s36, s4, 9437184
    s_addc_u32 s37, s5, 0
    s_and_b32 s37, s37, 0xffff
    s_mov_b32 s38, 917504
    s_mov_b32 s39, 0x00020000
    v_lshlrev_b32 v38, 11, v58
    v_lshl_add_u32 v38, v61, 4, v38
    s_lshl_b32 s40, s69, 14
    s_lshl_b32 s41, s68, 9
    s_add_u32 s40, s40, s41
    v_add_u32 v38, s40, v38
    s_waitcnt lgkmcnt(0)
    v_mfma_f32_16x16x32_bf16 v[64:67], v[96:99], v[32:35], 0
    v_mfma_f32_16x16x32_bf16 v[68:71], v[100:103], v[32:35], 0
    v_mfma_f32_16x16x32_bf16 v[72:75], v[104:107], v[32:35], 0
    v_mfma_f32_16x16x32_bf16 v[76:79], v[108:111], v[32:35], 0
    v_mfma_f32_16x16x32_bf16 v[80:83], v[112:115], v[32:35], 0
    v_mfma_f32_16x16x32_bf16 v[84:87], v[116:119], v[32:35], 0
    v_mfma_f32_16x16x32_bf16 v[88:91], v[120:123], v[32:35], 0
    v_mfma_f32_16x16x32_bf16 v[92:95], v[124:127], v[32:35], 0
    v_cmp_gt_u32 vcc, 8, v58
    s_nop 0
    s_and_saveexec_b64 s[48:49], vcc
    buffer_store_dwordx4 v[64:67], v38, s[36:39], 0 offen offset:0
    buffer_store_dwordx4 v[68:71], v38, s[36:39], 0 offen offset:64
    buffer_store_dwordx4 v[72:75], v38, s[36:39], 0 offen offset:128
    buffer_store_dwordx4 v[76:79], v38, s[36:39], 0 offen offset:192
    buffer_store_dwordx4 v[80:83], v38, s[36:39], 0 offen offset:256
    buffer_store_dwordx4 v[84:87], v38, s[36:39], 0 offen offset:320
    buffer_store_dwordx4 v[88:91], v38, s[36:39], 0 offen offset:384
    buffer_store_dwordx4 v[92:95], v38, s[36:39], 0 offen offset:448
    s_mov_b64 exec, s[48:49]
    s_branch L_k4l1_done
L_k4l1_ln:
    s_add_u32 s36, s4, 4194304
    s_addc_u32 s37, s5, 0
    s_and_b32 s37, s37, 0xffff
    s_mov_b32 s38, 2097152
    s_mov_b32 s39, 0x00020000
    s_sub_u32 s40, s2, 56
    s_lshl_b32 s40, s40, 4
    v_lshrrev_b32 v2, 5, v0
    v_add_u32 v2, s40, v2
    v_lshlrev_b32 v3, 4, v2
    buffer_load_dwordx2 v[14:15], v3, s[24:27], 0 offen
    v_and_b32 v4, 31, v0
    v_lshlrev_b32 v3, 10, v2
    v_lshl_add_u32 v3, v4, 4, v3
    buffer_load_dwordx4 v[32:35], v3, s[12:15], 0 offen offset:0
    buffer_load_dwordx4 v[36:39], v3, s[12:15], 0 offen offset:512
    s_waitcnt vmcnt(2)
    v_mul_f32 v12, s73, v14
    v_mul_f32 v13, s73, v15
    v_fma_f32 v13, -v12, v12, v13
    v_max_f32 v13, 0, v13
    v_cvt_pk_bf16_f32 v12, v12, v13
    v_lshlrev_b32 v10, 16, v12
    v_and_b32 v13, s72, v12
    v_add_f32 v13, s74, v13
    v_cvt_pk_bf16_f32 v13, v13, v13
    v_lshlrev_b32 v13, 16, v13
    v_sqrt_f32 v13, v13
    s_nop 0
    v_cvt_pk_bf16_f32 v13, v13, v13
    v_lshlrev_b32 v13, 16, v13
    v_rcp_f32 v11, v13
    s_waitcnt vmcnt(1)
    v_lshlrev_b32 v12, 16, v32
    v_and_b32 v13, s72, v32
    v_sub_f32 v12, v12, v10
    v_sub_f32 v13, v13, v10
    v_cvt_pk_bf16_f32 v12, v12, v13
    v_and_b32 v13, s72, v12
    v_lshlrev_b32 v12, 16, v12
    v_mul_f32 v12, v12, v11
    v_mul_f32 v13, v13, v11
    v_cvt_pk_bf16_f32 v16, v12, v13
    v_lshlrev_b32 v12, 16, v32
    v_and_b32 v13, s72, v32
    v_lshlrev_b32 v17, 16, v16
    v_and_b32 v18, s72, v16
    v_add_f32 v12, v12, v17
    v_add_f32 v13, v13, v18
    v_cvt_pk_bf16_f32 v48, v12, v13
    v_lshlrev_b32 v12, 16, v33
    v_and_b32 v13, s72, v33
    v_sub_f32 v12, v12, v10
    v_sub_f32 v13, v13, v10
    v_cvt_pk_bf16_f32 v12, v12, v13
    v_and_b32 v13, s72, v12
    v_lshlrev_b32 v12, 16, v12
    v_mul_f32 v12, v12, v11
    v_mul_f32 v13, v13, v11
    v_cvt_pk_bf16_f32 v16, v12, v13
    v_lshlrev_b32 v12, 16, v33
    v_and_b32 v13, s72, v33
    v_lshlrev_b32 v17, 16, v16
    v_and_b32 v18, s72, v16
    v_add_f32 v12, v12, v17
    v_add_f32 v13, v13, v18
    v_cvt_pk_bf16_f32 v49, v12, v13
    v_lshlrev_b32 v12, 16, v34
    v_and_b32 v13, s72, v34
    v_sub_f32 v12, v12, v10
    v_sub_f32 v13, v13, v10
    v_cvt_pk_bf16_f32 v12, v12, v13
    v_and_b32 v13, s72, v12
    v_lshlrev_b32 v12, 16, v12
    v_mul_f32 v12, v12, v11
    v_mul_f32 v13, v13, v11
    v_cvt_pk_bf16_f32 v16, v12, v13
    v_lshlrev_b32 v12, 16, v34
    v_and_b32 v13, s72, v34
    v_lshlrev_b32 v17, 16, v16
    v_and_b32 v18, s72, v16
    v_add_f32 v12, v12, v17
    v_add_f32 v13, v13, v18
    v_cvt_pk_bf16_f32 v50, v12, v13
    v_lshlrev_b32 v12, 16, v35
    v_and_b32 v13, s72, v35
    v_sub_f32 v12, v12, v10
    v_sub_f32 v13, v13, v10
    v_cvt_pk_bf16_f32 v12, v12, v13
    v_and_b32 v13, s72, v12
    v_lshlrev_b32 v12, 16, v12
    v_mul_f32 v12, v12, v11
    v_mul_f32 v13, v13, v11
    v_cvt_pk_bf16_f32 v16, v12, v13
    v_lshlrev_b32 v12, 16, v35
    v_and_b32 v13, s72, v35
    v_lshlrev_b32 v17, 16, v16
    v_and_b32 v18, s72, v16
    v_add_f32 v12, v12, v17
    v_add_f32 v13, v13, v18
    v_cvt_pk_bf16_f32 v51, v12, v13
    buffer_store_dwordx4 v[48:51], v3, s[36:39], 0 offen offset:0
    s_waitcnt vmcnt(1)
    v_lshlrev_b32 v12, 16, v36
    v_and_b32 v13, s72, v36
    v_sub_f32 v12, v12, v10
    v_sub_f32 v13, v13, v10
    v_cvt_pk_bf16_f32 v12, v12, v13
    v_and_b32 v13, s72, v12
    v_lshlrev_b32 v12, 16, v12
    v_mul_f32 v12, v12, v11
    v_mul_f32 v13, v13, v11
    v_cvt_pk_bf16_f32 v16, v12, v13
    v_lshlrev_b32 v12, 16, v36
    v_and_b32 v13, s72, v36
    v_lshlrev_b32 v17, 16, v16
    v_and_b32 v18, s72, v16
    v_add_f32 v12, v12, v17
    v_add_f32 v13, v13, v18
    v_cvt_pk_bf16_f32 v52, v12, v13
    v_lshlrev_b32 v12, 16, v37
    v_and_b32 v13, s72, v37
    v_sub_f32 v12, v12, v10
    v_sub_f32 v13, v13, v10
    v_cvt_pk_bf16_f32 v12, v12, v13
    v_and_b32 v13, s72, v12
    v_lshlrev_b32 v12, 16, v12
    v_mul_f32 v12, v12, v11
    v_mul_f32 v13, v13, v11
    v_cvt_pk_bf16_f32 v16, v12, v13
    v_lshlrev_b32 v12, 16, v37
    v_and_b32 v13, s72, v37
    v_lshlrev_b32 v17, 16, v16
    v_and_b32 v18, s72, v16
    v_add_f32 v12, v12, v17
    v_add_f32 v13, v13, v18
    v_cvt_pk_bf16_f32 v53, v12, v13
    v_lshlrev_b32 v12, 16, v38
    v_and_b32 v13, s72, v38
    v_sub_f32 v12, v12, v10
    v_sub_f32 v13, v13, v10
    v_cvt_pk_bf16_f32 v12, v12, v13
    v_and_b32 v13, s72, v12
    v_lshlrev_b32 v12, 16, v12
    v_mul_f32 v12, v12, v11
    v_mul_f32 v13, v13, v11
    v_cvt_pk_bf16_f32 v16, v12, v13
    v_lshlrev_b32 v12, 16, v38
    v_and_b32 v13, s72, v38
    v_lshlrev_b32 v17, 16, v16
    v_and_b32 v18, s72, v16
    v_add_f32 v12, v12, v17
    v_add_f32 v13, v13, v18
    v_cvt_pk_bf16_f32 v54, v12, v13
    v_lshlrev_b32 v12, 16, v39
    v_and_b32 v13, s72, v39
    v_sub_f32 v12, v12, v10
    v_sub_f32 v13, v13, v10
    v_cvt_pk_bf16_f32 v12, v12, v13
    v_and_b32 v13, s72, v12
    v_lshlrev_b32 v12, 16, v12
    v_mul_f32 v12, v12, v11
    v_mul_f32 v13, v13, v11
    v_cvt_pk_bf16_f32 v16, v12, v13
    v_lshlrev_b32 v12, 16, v39
    v_and_b32 v13, s72, v39
    v_lshlrev_b32 v17, 16, v16
    v_and_b32 v18, s72, v16
    v_add_f32 v12, v12, v17
    v_add_f32 v13, v13, v18
    v_cvt_pk_bf16_f32 v55, v12, v13
    buffer_store_dwordx4 v[52:55], v3, s[36:39], 0 offen offset:512
L_k4l1_done:
    s_endpgm
.globl k5l1_kernel
.p2align 8
.type k5l1_kernel,@function
k5l1_kernel:
    s_cmp_ge_u32 s2, 32
    s_cbranch_scc1 L_k5l1_done
    s_load_dwordx2 s[4:5], s[0:1], 80
    s_load_dwordx2 s[70:71], s[0:1], 64
    s_mov_b32 s72, 0xffff0000
    s_mov_b32 s73, 0x3b000000
    s_mov_b32 s74, 0x3727c5ac
    s_lshr_b32 s68, s2, 2
    s_and_b32 s69, s2, 3
    v_and_b32 v1, 31, v0
    v_lshrrev_b32 v2, 5, v0
    v_mul_u32_u24 v3, 114688, v2
    v_lshl_add_u32 v3, v1, 4, v3
    s_lshl_b32 s40, s68, 11
    s_lshl_b32 s41, s69, 9
    s_add_u32 s40, s40, s41
    v_add_u32 v3, s40, v3
    s_waitcnt lgkmcnt(0)
    s_add_u32 s36, s4, 9437184
    s_addc_u32 s37, s5, 0
    s_and_b32 s37, s37, 0xffff
    s_mov_b32 s38, 917504
    s_mov_b32 s39, 0x00020000
    s_add_u32 s32, s4, 8454144
    s_addc_u32 s33, s5, 0
    s_and_b32 s33, s33, 0xffff
    s_mov_b32 s34, 65536
    s_mov_b32 s35, 0x00020000
    s_lshl_b32 s41, s68, 2
    s_add_u32 s41, s41, 32768
    v_mov_b32 v4, 0
    buffer_load_dword v26, v4, s[32:35], s41 offen
    s_mov_b32 s40, 0
    buffer_load_dwordx4 v[32:35], v3, s[36:39], s40 offen
    s_mov_b32 s40, 16384
    buffer_load_dwordx4 v[36:39], v3, s[36:39], s40 offen
    s_mov_b32 s40, 32768
    buffer_load_dwordx4 v[40:43], v3, s[36:39], s40 offen
    s_mov_b32 s40, 49152
    buffer_load_dwordx4 v[44:47], v3, s[36:39], s40 offen
    s_mov_b32 s40, 65536
    buffer_load_dwordx4 v[48:51], v3, s[36:39], s40 offen
    s_mov_b32 s40, 81920
    buffer_load_dwordx4 v[52:55], v3, s[36:39], s40 offen
    s_mov_b32 s40, 98304
    buffer_load_dwordx4 v[56:59], v3, s[36:39], s40 offen
    s_add_u32 s12, s4, 2097152
    s_addc_u32 s13, s5, 0
    s_and_b32 s13, s13, 0xffff
    s_mov_b32 s14, 2097152
    s_mov_b32 s15, 0x00020000
    s_add_u32 s24, s4, 8388608
    s_addc_u32 s25, s5, 0
    s_and_b32 s25, s25, 0xffff
    s_mov_b32 s26, 32768
    s_mov_b32 s27, 0x00020000
    s_add_u32 s44, s4, 4194304
    s_addc_u32 s45, s5, 0
    s_and_b32 s45, s45, 0xffff
    s_mov_b32 s46, 2097152
    s_mov_b32 s47, 0x00020000
    s_waitcnt vmcnt(7)
    v_and_b32 v28, 0x7ff, v26
    v_sub_u32 v28, 2047, v28
    v_lshlrev_b32 v30, 4, v28
    buffer_load_dwordx2 v[14:15], v30, s[24:27], 0 offen
    v_lshlrev_b32 v31, 10, v28
    v_lshl_add_u32 v31, v1, 3, v31
    s_lshl_b32 s41, s69, 8
    v_add_u32 v31, s41, v31
    buffer_load_dwordx2 v[16:17], v31, s[12:15], 0 offen
    s_waitcnt vmcnt(2)
    v_add_f32 v32, v32, v36
    v_add_f32 v33, v33, v37
    v_add_f32 v34, v34, v38
    v_add_f32 v35, v35, v39
    v_add_f32 v32, v32, v40
    v_add_f32 v33, v33, v41
    v_add_f32 v34, v34, v42
    v_add_f32 v35, v35, v43
    v_add_f32 v32, v32, v44
    v_add_f32 v33, v33, v45
    v_add_f32 v34, v34, v46
    v_add_f32 v35, v35, v47
    v_add_f32 v32, v32, v48
    v_add_f32 v33, v33, v49
    v_add_f32 v34, v34, v50
    v_add_f32 v35, v35, v51
    v_add_f32 v32, v32, v52
    v_add_f32 v33, v33, v53
    v_add_f32 v34, v34, v54
    v_add_f32 v35, v35, v55
    v_add_f32 v32, v32, v56
    v_add_f32 v33, v33, v57
    v_add_f32 v34, v34, v58
    v_add_f32 v35, v35, v59
    v_lshlrev_b32 v5, 4, v0
    ds_write_b128 v5, v[32:35]
    s_waitcnt lgkmcnt(0)
    s_barrier
    v_cmp_gt_u32 vcc, 32, v0
    s_nop 0
    s_and_saveexec_b64 s[48:49], vcc
    s_cbranch_execz L_k5l1_done
    ds_read_b128 v[32:35], v5 offset:0
    ds_read_b128 v[36:39], v5 offset:512
    ds_read_b128 v[40:43], v5 offset:1024
    ds_read_b128 v[44:47], v5 offset:1536
    ds_read_b128 v[48:51], v5 offset:2048
    ds_read_b128 v[52:55], v5 offset:2560
    ds_read_b128 v[56:59], v5 offset:3072
    ds_read_b128 v[60:63], v5 offset:3584
    s_waitcnt lgkmcnt(0)
    v_add_f32 v32, v32, v36
    v_add_f32 v33, v33, v37
    v_add_f32 v34, v34, v38
    v_add_f32 v35, v35, v39
    v_add_f32 v32, v32, v40
    v_add_f32 v33, v33, v41
    v_add_f32 v34, v34, v42
    v_add_f32 v35, v35, v43
    v_add_f32 v32, v32, v44
    v_add_f32 v33, v33, v45
    v_add_f32 v34, v34, v46
    v_add_f32 v35, v35, v47
    v_add_f32 v32, v32, v48
    v_add_f32 v33, v33, v49
    v_add_f32 v34, v34, v50
    v_add_f32 v35, v35, v51
    v_add_f32 v32, v32, v52
    v_add_f32 v33, v33, v53
    v_add_f32 v34, v34, v54
    v_add_f32 v35, v35, v55
    v_add_f32 v32, v32, v56
    v_add_f32 v33, v33, v57
    v_add_f32 v34, v34, v58
    v_add_f32 v35, v35, v59
    v_add_f32 v32, v32, v60
    v_add_f32 v33, v33, v61
    v_add_f32 v34, v34, v62
    v_add_f32 v35, v35, v63
    v_cvt_pk_bf16_f32 v40, v32, v33
    v_lshlrev_b32 v32, 16, v40
    v_and_b32 v33, s72, v40
    v_cvt_pk_bf16_f32 v40, v34, v35
    v_lshlrev_b32 v34, 16, v40
    v_and_b32 v35, s72, v40
    v_and_b32 v20, s72, v26
    v_ashrrev_i32 v21, 31, v20
    v_not_b32 v21, v21
    v_or_b32 v21, 0x80000000, v21
    v_xor_b32 v20, v20, v21
    v_and_b32 v20, s72, v20
    s_mov_b32 s40, 0xbfb8aa3b
    v_mul_f32 v20, s40, v20
    v_exp_f32 v20, v20
    s_nop 0
    v_add_f32 v20, 1.0, v20
    v_rcp_f32 v20, v20
    s_nop 0
    v_cvt_pk_bf16_f32 v20, v20, v20
    v_lshlrev_b32 v20, 16, v20
    v_mul_f32 v32, v32, v20
    v_mul_f32 v33, v33, v20
    v_mul_f32 v34, v34, v20
    v_mul_f32 v35, v35, v20
    v_cvt_pk_bf16_f32 v44, v32, v33
    v_cvt_pk_bf16_f32 v45, v34, v35
    s_waitcnt vmcnt(0)
    v_mul_f32 v12, s73, v14
    v_mul_f32 v13, s73, v15
    v_fma_f32 v13, -v12, v12, v13
    v_max_f32 v13, 0, v13
    v_cvt_pk_bf16_f32 v12, v12, v13
    v_lshlrev_b32 v10, 16, v12
    v_and_b32 v13, s72, v12
    v_add_f32 v13, s74, v13
    v_cvt_pk_bf16_f32 v13, v13, v13
    v_lshlrev_b32 v13, 16, v13
    v_sqrt_f32 v13, v13
    s_nop 0
    v_cvt_pk_bf16_f32 v13, v13, v13
    v_lshlrev_b32 v13, 16, v13
    v_rcp_f32 v11, v13
    v_lshlrev_b32 v12, 16, v16
    v_and_b32 v13, s72, v16
    v_sub_f32 v12, v12, v10
    v_sub_f32 v13, v13, v10
    v_cvt_pk_bf16_f32 v12, v12, v13
    v_and_b32 v13, s72, v12
    v_lshlrev_b32 v12, 16, v12
    v_mul_f32 v12, v12, v11
    v_mul_f32 v13, v13, v11
    v_cvt_pk_bf16_f32 v18, v12, v13
    v_lshlrev_b32 v12, 16, v18
    v_and_b32 v13, s72, v18
    v_lshlrev_b32 v19, 16, v44
    v_and_b32 v22, s72, v44
    v_add_f32 v12, v12, v19
    v_add_f32 v13, v13, v22
    v_cvt_pk_bf16_f32 v18, v12, v13
    v_lshlrev_b32 v12, 16, v16
    v_and_b32 v13, s72, v16
    v_lshlrev_b32 v19, 16, v18
    v_and_b32 v22, s72, v18
    v_add_f32 v12, v12, v19
    v_add_f32 v13, v13, v22
    v_cvt_pk_bf16_f32 v46, v12, v13
    v_lshlrev_b32 v12, 16, v17
    v_and_b32 v13, s72, v17
    v_sub_f32 v12, v12, v10
    v_sub_f32 v13, v13, v10
    v_cvt_pk_bf16_f32 v12, v12, v13
    v_and_b32 v13, s72, v12
    v_lshlrev_b32 v12, 16, v12
    v_mul_f32 v12, v12, v11
    v_mul_f32 v13, v13, v11
    v_cvt_pk_bf16_f32 v18, v12, v13
    v_lshlrev_b32 v12, 16, v18
    v_and_b32 v13, s72, v18
    v_lshlrev_b32 v19, 16, v45
    v_and_b32 v22, s72, v45
    v_add_f32 v12, v12, v19
    v_add_f32 v13, v13, v22
    v_cvt_pk_bf16_f32 v18, v12, v13
    v_lshlrev_b32 v12, 16, v17
    v_and_b32 v13, s72, v17
    v_lshlrev_b32 v19, 16, v18
    v_and_b32 v22, s72, v18
    v_add_f32 v12, v12, v19
    v_add_f32 v13, v13, v22
    v_cvt_pk_bf16_f32 v47, v12, v13
    buffer_store_dwordx2 v[46:47], v31, s[44:47], 0 offen
L_k5l1_done:
    s_endpgm
.globl k1l2_kernel
.p2align 8
.type k1l2_kernel,@function
k1l2_kernel:
    s_cmp_ge_u32 s2, 256
    s_cbranch_scc1 L_k1l2_done
    s_load_dwordx2 s[4:5], s[0:1], 80
    s_load_dwordx2 s[6:7], s[0:1], 8
    s_load_dwordx2 s[8:9], s[0:1], 80
    s_and_b32 s28, s2, 7
    s_lshr_b32 s29, s2, 3
    s_lshr_b32 s30, s28, 1
    s_lshl_b32 s30, s30, 3
    s_lshr_b32 s31, s29, 2
    s_add_u32 s30, s30, s31
    s_and_b32 s28, s28, 1
    s_lshl_b32 s28, s28, 2
    s_and_b32 s29, s29, 3
    s_add_u32 s29, s28, s29
    s_lshl_b32 s31, s30, 6
    v_and_b32 v1, 63, v0
    v_lshrrev_b32 v2, 6, v0
    s_nop 0
    v_readfirstlane_b32 s30, v2
    v_lshrrev_b32 v10, 3, v1
    v_and_b32 v11, 7, v1
    v_lshrrev_b32 v12, 4, v1
    s_cmp_lt_u32 s30, 4
    s_cbranch_scc1 L_k1l2_comp
    s_sub_u32 s30, s30, 4
    s_lshl_b32 s34, s30, 4
    s_add_u32 s34, s34, s31
    v_add_u32 v13, s34, v10
    v_lshlrev_b32 v13, 10, v13
    v_xor_b32 v14, v11, v12
    v_lshl_add_u32 v2, v14, 4, v13
    v_xor_b32 v14, 4, v14
    v_lshl_add_u32 v3, v14, 4, v13
    v_add_u32 v3, 8192, v3
    s_lshl_b32 s34, s30, 2
    s_add_u32 s34, s34, s31
    s_sub_u32 s34, s34, 16
    v_add_u32 v13, s34, v10
    v_lshlrev_b32 v13, 10, v13
    s_lshl_b32 s34, s30, 1
    v_add_u32 v14, s34, v12
    v_and_b32 v14, 7, v14
    v_xor_b32 v14, v11, v14
    v_lshl_add_u32 v4, v14, 4, v13
    v_bfe_u32 v13, v10, 1, 1
    s_and_b32 s34, s30, 1
    s_lshl_b32 s34, s34, 1
    v_or_b32 v13, s34, v13
    v_lshrrev_b32 v14, 1, v11
    v_xor_b32 v13, v13, v14
    v_mul_u32_u24 v5, 3072, v10
    v_lshl_add_u32 v5, v13, 5, v5
    v_and_b32 v14, 1, v11
    v_lshl_add_u32 v5, v14, 4, v5
    s_lshl_b32 s34, s29, 7
    v_add_u32 v5, s34, v5
    s_mul_i32 s32, s30, 24576
    s_lshl_b32 s33, s30, 10
    s_lshl_b32 s35, s30, 11
    s_add_u32 s35, s35, 2048
    s_lshl_b32 s36, s30, 9
    s_waitcnt lgkmcnt(0)
    s_add_u32 s12, s4, 4194304
    s_addc_u32 s13, s5, 0
    s_and_b32 s13, s13, 0xffff
    s_mov_b32 s14, 2097152
    s_mov_b32 s15, 0x00020000
    s_mov_b32 s16, s6
    s_and_b32 s17, s7, 0xffff
    s_mov_b32 s18, 1572864
    s_mov_b32 s19, 0x00020000
    s_mov_b64 s[56:57], 0xffffffff
    s_mov_b32 s37, 0
    s_add_u32 m0, s35, 0
    s_nop 0
    buffer_load_dwordx4 v2, s[12:15], s37 offen lds
    s_add_u32 m0, s35, 1024
    s_nop 0
    buffer_load_dwordx4 v3, s[12:15], s37 offen lds
    s_add_u32 m0, s36, 0
    s_mov_b64 exec, s[56:57]
    buffer_load_dwordx4 v4, s[12:15], s37 offen lds
    s_mov_b64 exec, -1
    s_add_u32 s34, s32, 0
    s_add_u32 m0, s33, 10240
    s_nop 0
    buffer_load_dwordx4 v5, s[16:19], s34 offen lds
    s_add_u32 s34, s32, 98304
    s_add_u32 m0, s33, 14336
    s_nop 0
    buffer_load_dwordx4 v5, s[16:19], s34 offen lds
    s_add_u32 s34, s32, 1024
    s_add_u32 m0, s33, 18432
    s_nop 0
    buffer_load_dwordx4 v5, s[16:19], s34 offen lds
    s_add_u32 s34, s32, 99328
    s_add_u32 m0, s33, 22528
    s_nop 0
    buffer_load_dwordx4 v5, s[16:19], s34 offen lds
    s_add_u32 s34, s32, 2048
    s_add_u32 m0, s33, 26624
    s_nop 0
    buffer_load_dwordx4 v5, s[16:19], s34 offen lds
    s_add_u32 s34, s32, 100352
    s_add_u32 m0, s33, 30720
    s_nop 0
    buffer_load_dwordx4 v5, s[16:19], s34 offen lds
    s_mov_b32 s37, 128
    s_add_u32 m0, s35, 34816
    s_nop 0
    buffer_load_dwordx4 v2, s[12:15], s37 offen lds
    s_add_u32 m0, s35, 35840
    s_nop 0
    buffer_load_dwordx4 v3, s[12:15], s37 offen lds
    s_add_u32 m0, s36, 34816
    s_mov_b64 exec, s[56:57]
    buffer_load_dwordx4 v4, s[12:15], s37 offen lds
    s_mov_b64 exec, -1
    s_add_u32 s34, s32, 196608
    s_add_u32 m0, s33, 45056
    s_nop 0
    buffer_load_dwordx4 v5, s[16:19], s34 offen lds
    s_add_u32 s34, s32, 294912
    s_add_u32 m0, s33, 49152
    s_nop 0
    buffer_load_dwordx4 v5, s[16:19], s34 offen lds
    s_add_u32 s34, s32, 197632
    s_add_u32 m0, s33, 53248
    s_nop 0
    buffer_load_dwordx4 v5, s[16:19], s34 offen lds
    s_add_u32 s34, s32, 295936
    s_add_u32 m0, s33, 57344
    s_nop 0
    buffer_load_dwordx4 v5, s[16:19], s34 offen lds
    s_add_u32 s34, s32, 198656
    s_add_u32 m0, s33, 61440
    s_nop 0
    buffer_load_dwordx4 v5, s[16:19], s34 offen lds
    s_add_u32 s34, s32, 296960
    s_add_u32 m0, s33, 65536
    s_nop 0
    buffer_load_dwordx4 v5, s[16:19], s34 offen lds
    v_lshlrev_b32 v6, 5, v1
    v_add_u32 v6, s35, v6
    v_and_b32 v7, 31, v1
    v_lshlrev_b32 v7, 4, v7
    v_add_u32 v7, s36, v7
    v_mov_b32 v120, 0
    v_mov_b32 v121, 0
    v_mov_b32 v122, 0
    v_mov_b32 v123, 0
    v_mov_b32 v124, 0
    v_mov_b32 v125, 0
    v_mov_b32 v126, 0
    v_mov_b32 v127, 0
    s_mov_b32 s52, 0xffff0000
    s_mov_b32 s53, 0x3b000000
    s_mov_b32 s54, 0x3727c5ac
    s_waitcnt vmcnt(9)
    s_barrier
    ds_read_b128 v[100:103], v6 offset:0
    ds_read_b128 v[104:107], v6 offset:16
    ds_read_b128 v[108:111], v7 offset:0
    s_mov_b32 s37, 256
    s_add_u32 m0, s35, 69632
    s_nop 0
    buffer_load_dwordx4 v2, s[12:15], s37 offen lds
    s_add_u32 m0, s35, 70656
    s_nop 0
    buffer_load_dwordx4 v3, s[12:15], s37 offen lds
    s_add_u32 m0, s36, 69632
    s_mov_b64 exec, s[56:57]
    buffer_load_dwordx4 v4, s[12:15], s37 offen lds
    s_mov_b64 exec, -1
    s_add_u32 s34, s32, 393216
    s_add_u32 m0, s33, 79872
    s_nop 0
    buffer_load_dwordx4 v5, s[16:19], s34 offen lds
    s_add_u32 s34, s32, 491520
    s_add_u32 m0, s33, 83968
    s_nop 0
    buffer_load_dwordx4 v5, s[16:19], s34 offen lds
    s_add_u32 s34, s32, 394240
    s_add_u32 m0, s33, 88064
    s_nop 0
    buffer_load_dwordx4 v5, s[16:19], s34 offen lds
    s_add_u32 s34, s32, 492544
    s_add_u32 m0, s33, 92160
    s_nop 0
    buffer_load_dwordx4 v5, s[16:19], s34 offen lds
    s_add_u32 s34, s32, 395264
    s_add_u32 m0, s33, 96256
    s_nop 0
    buffer_load_dwordx4 v5, s[16:19], s34 offen lds
    s_add_u32 s34, s32, 493568
    s_add_u32 m0, s33, 100352
    s_nop 0
    buffer_load_dwordx4 v5, s[16:19], s34 offen lds
    s_waitcnt lgkmcnt(0)
    v_lshlrev_b32 v112, 16, v100
    v_and_b32 v113, s52, v100
    v_add_f32 v120, v120, v112
    v_add_f32 v121, v121, v113
    v_fma_f32 v122, v112, v112, v122
    v_fma_f32 v123, v113, v113, v123
    v_lshlrev_b32 v112, 16, v101
    v_and_b32 v113, s52, v101
    v_add_f32 v120, v120, v112
    v_add_f32 v121, v121, v113
    v_fma_f32 v122, v112, v112, v122
    v_fma_f32 v123, v113, v113, v123
    v_lshlrev_b32 v112, 16, v102
    v_and_b32 v113, s52, v102
    v_add_f32 v120, v120, v112
    v_add_f32 v121, v121, v113
    v_fma_f32 v122, v112, v112, v122
    v_fma_f32 v123, v113, v113, v123
    v_lshlrev_b32 v112, 16, v103
    v_and_b32 v113, s52, v103
    v_add_f32 v120, v120, v112
    v_add_f32 v121, v121, v113
    v_fma_f32 v122, v112, v112, v122
    v_fma_f32 v123, v113, v113, v123
    v_lshlrev_b32 v112, 16, v104
    v_and_b32 v113, s52, v104
    v_add_f32 v120, v120, v112
    v_add_f32 v121, v121, v113
    v_fma_f32 v122, v112, v112, v122
    v_fma_f32 v123, v113, v113, v123
    v_lshlrev_b32 v112, 16, v105
    v_and_b32 v113, s52, v105
    v_add_f32 v120, v120, v112
    v_add_f32 v121, v121, v113
    v_fma_f32 v122, v112, v112, v122
    v_fma_f32 v123, v113, v113, v123
    v_lshlrev_b32 v112, 16, v106
    v_and_b32 v113, s52, v106
    v_add_f32 v120, v120, v112
    v_add_f32 v121, v121, v113
    v_fma_f32 v122, v112, v112, v122
    v_fma_f32 v123, v113, v113, v123
    v_lshlrev_b32 v112, 16, v107
    v_and_b32 v113, s52, v107
    v_add_f32 v120, v120, v112
    v_add_f32 v121, v121, v113
    v_fma_f32 v122, v112, v112, v122
    v_fma_f32 v123, v113, v113, v123
    v_lshlrev_b32 v112, 16, v108
    v_and_b32 v113, s52, v108
    v_add_f32 v124, v124, v112
    v_add_f32 v125, v125, v113
    v_fma_f32 v126, v112, v112, v126
    v_fma_f32 v127, v113, v113, v127
    v_lshlrev_b32 v112, 16, v109
    v_and_b32 v113, s52, v109
    v_add_f32 v124, v124, v112
    v_add_f32 v125, v125, v113
    v_fma_f32 v126, v112, v112, v126
    v_fma_f32 v127, v113, v113, v127
    v_lshlrev_b32 v112, 16, v110
    v_and_b32 v113, s52, v110
    v_add_f32 v124, v124, v112
    v_add_f32 v125, v125, v113
    v_fma_f32 v126, v112, v112, v126
    v_fma_f32 v127, v113, v113, v127
    v_lshlrev_b32 v112, 16, v111
    v_and_b32 v113, s52, v111
    v_add_f32 v124, v124, v112
    v_add_f32 v125, v125, v113
    v_fma_f32 v126, v112, v112, v126
    v_fma_f32 v127, v113, v113, v127
    s_waitcnt vmcnt(9)
    s_barrier
    ds_read_b128 v[100:103], v6 offset:34816
    ds_read_b128 v[104:107], v6 offset:34832
    ds_read_b128 v[108:111], v7 offset:34816
    s_mov_b32 s37, 384
    s_add_u32 m0, s35, 104448
    s_nop 0
    buffer_load_dwordx4 v2, s[12:15], s37 offen lds
    s_add_u32 m0, s35, 105472
    s_nop 0
    buffer_load_dwordx4 v3, s[12:15], s37 offen lds
    s_add_u32 m0, s36, 104448
    s_mov_b64 exec, s[56:57]
    buffer_load_dwordx4 v4, s[12:15], s37 offen lds
    s_mov_b64 exec, -1
    s_add_u32 s34, s32, 589824
    s_add_u32 m0, s33, 114688
    s_nop 0
    buffer_load_dwordx4 v5, s[16:19], s34 offen lds
    s_add_u32 s34, s32, 688128
    s_add_u32 m0, s33, 118784
    s_nop 0
    buffer_load_dwordx4 v5, s[16:19], s34 offen lds
    s_add_u32 s34, s32, 590848
    s_add_u32 m0, s33, 122880
    s_nop 0
    buffer_load_dwordx4 v5, s[16:19], s34 offen lds
    s_add_u32 s34, s32, 689152
    s_add_u32 m0, s33, 126976
    s_nop 0
    buffer_load_dwordx4 v5, s[16:19], s34 offen lds
    s_add_u32 s34, s32, 591872
    s_add_u32 m0, s33, 131072
    s_nop 0
    buffer_load_dwordx4 v5, s[16:19], s34 offen lds
    s_add_u32 s34, s32, 690176
    s_add_u32 m0, s33, 135168
    s_nop 0
    buffer_load_dwordx4 v5, s[16:19], s34 offen lds
    s_waitcnt lgkmcnt(0)
    v_lshlrev_b32 v112, 16, v100
    v_and_b32 v113, s52, v100
    v_add_f32 v120, v120, v112
    v_add_f32 v121, v121, v113
    v_fma_f32 v122, v112, v112, v122
    v_fma_f32 v123, v113, v113, v123
    v_lshlrev_b32 v112, 16, v101
    v_and_b32 v113, s52, v101
    v_add_f32 v120, v120, v112
    v_add_f32 v121, v121, v113
    v_fma_f32 v122, v112, v112, v122
    v_fma_f32 v123, v113, v113, v123
    v_lshlrev_b32 v112, 16, v102
    v_and_b32 v113, s52, v102
    v_add_f32 v120, v120, v112
    v_add_f32 v121, v121, v113
    v_fma_f32 v122, v112, v112, v122
    v_fma_f32 v123, v113, v113, v123
    v_lshlrev_b32 v112, 16, v103
    v_and_b32 v113, s52, v103
    v_add_f32 v120, v120, v112
    v_add_f32 v121, v121, v113
    v_fma_f32 v122, v112, v112, v122
    v_fma_f32 v123, v113, v113, v123
    v_lshlrev_b32 v112, 16, v104
    v_and_b32 v113, s52, v104
    v_add_f32 v120, v120, v112
    v_add_f32 v121, v121, v113
    v_fma_f32 v122, v112, v112, v122
    v_fma_f32 v123, v113, v113, v123
    v_lshlrev_b32 v112, 16, v105
    v_and_b32 v113, s52, v105
    v_add_f32 v120, v120, v112
    v_add_f32 v121, v121, v113
    v_fma_f32 v122, v112, v112, v122
    v_fma_f32 v123, v113, v113, v123
    v_lshlrev_b32 v112, 16, v106
    v_and_b32 v113, s52, v106
    v_add_f32 v120, v120, v112
    v_add_f32 v121, v121, v113
    v_fma_f32 v122, v112, v112, v122
    v_fma_f32 v123, v113, v113, v123
    v_lshlrev_b32 v112, 16, v107
    v_and_b32 v113, s52, v107
    v_add_f32 v120, v120, v112
    v_add_f32 v121, v121, v113
    v_fma_f32 v122, v112, v112, v122
    v_fma_f32 v123, v113, v113, v123
    v_lshlrev_b32 v112, 16, v108
    v_and_b32 v113, s52, v108
    v_add_f32 v124, v124, v112
    v_add_f32 v125, v125, v113
    v_fma_f32 v126, v112, v112, v126
    v_fma_f32 v127, v113, v113, v127
    v_lshlrev_b32 v112, 16, v109
    v_and_b32 v113, s52, v109
    v_add_f32 v124, v124, v112
    v_add_f32 v125, v125, v113
    v_fma_f32 v126, v112, v112, v126
    v_fma_f32 v127, v113, v113, v127
    v_lshlrev_b32 v112, 16, v110
    v_and_b32 v113, s52, v110
    v_add_f32 v124, v124, v112
    v_add_f32 v125, v125, v113
    v_fma_f32 v126, v112, v112, v126
    v_fma_f32 v127, v113, v113, v127
    v_lshlrev_b32 v112, 16, v111
    v_and_b32 v113, s52, v111
    v_add_f32 v124, v124, v112
    v_add_f32 v125, v125, v113
    v_fma_f32 v126, v112, v112, v126
    v_fma_f32 v127, v113, v113, v127
    s_waitcnt vmcnt(9)
    s_barrier
    v_add_u32 v6, 69632, v6
    v_add_u32 v7, 69632, v7
    ds_read_b128 v[100:103], v6 offset:0
    ds_read_b128 v[104:107], v6 offset:16
    ds_read_b128 v[108:111], v7 offset:0
    s_mov_b32 s37, 512
    s_add_u32 m0, s35, 0
    s_nop 0
    buffer_load_dwordx4 v2, s[12:15], s37 offen lds
    s_add_u32 m0, s35, 1024
    s_nop 0
    buffer_load_dwordx4 v3, s[12:15], s37 offen lds
    s_add_u32 m0, s36, 0
    s_mov_b64 exec, s[56:57]
    buffer_load_dwordx4 v4, s[12:15], s37 offen lds
    s_mov_b64 exec, -1
    s_add_u32 s34, s32, 786432
    s_add_u32 m0, s33, 10240
    s_nop 0
    buffer_load_dwordx4 v5, s[16:19], s34 offen lds
    s_add_u32 s34, s32, 884736
    s_add_u32 m0, s33, 14336
    s_nop 0
    buffer_load_dwordx4 v5, s[16:19], s34 offen lds
    s_add_u32 s34, s32, 787456
    s_add_u32 m0, s33, 18432
    s_nop 0
    buffer_load_dwordx4 v5, s[16:19], s34 offen lds
    s_add_u32 s34, s32, 885760
    s_add_u32 m0, s33, 22528
    s_nop 0
    buffer_load_dwordx4 v5, s[16:19], s34 offen lds
    s_add_u32 s34, s32, 788480
    s_add_u32 m0, s33, 26624
    s_nop 0
    buffer_load_dwordx4 v5, s[16:19], s34 offen lds
    s_add_u32 s34, s32, 886784
    s_add_u32 m0, s33, 30720
    s_nop 0
    buffer_load_dwordx4 v5, s[16:19], s34 offen lds
    s_waitcnt lgkmcnt(0)
    v_lshlrev_b32 v112, 16, v100
    v_and_b32 v113, s52, v100
    v_add_f32 v120, v120, v112
    v_add_f32 v121, v121, v113
    v_fma_f32 v122, v112, v112, v122
    v_fma_f32 v123, v113, v113, v123
    v_lshlrev_b32 v112, 16, v101
    v_and_b32 v113, s52, v101
    v_add_f32 v120, v120, v112
    v_add_f32 v121, v121, v113
    v_fma_f32 v122, v112, v112, v122
    v_fma_f32 v123, v113, v113, v123
    v_lshlrev_b32 v112, 16, v102
    v_and_b32 v113, s52, v102
    v_add_f32 v120, v120, v112
    v_add_f32 v121, v121, v113
    v_fma_f32 v122, v112, v112, v122
    v_fma_f32 v123, v113, v113, v123
    v_lshlrev_b32 v112, 16, v103
    v_and_b32 v113, s52, v103
    v_add_f32 v120, v120, v112
    v_add_f32 v121, v121, v113
    v_fma_f32 v122, v112, v112, v122
    v_fma_f32 v123, v113, v113, v123
    v_lshlrev_b32 v112, 16, v104
    v_and_b32 v113, s52, v104
    v_add_f32 v120, v120, v112
    v_add_f32 v121, v121, v113
    v_fma_f32 v122, v112, v112, v122
    v_fma_f32 v123, v113, v113, v123
    v_lshlrev_b32 v112, 16, v105
    v_and_b32 v113, s52, v105
    v_add_f32 v120, v120, v112
    v_add_f32 v121, v121, v113
    v_fma_f32 v122, v112, v112, v122
    v_fma_f32 v123, v113, v113, v123
    v_lshlrev_b32 v112, 16, v106
    v_and_b32 v113, s52, v106
    v_add_f32 v120, v120, v112
    v_add_f32 v121, v121, v113
    v_fma_f32 v122, v112, v112, v122
    v_fma_f32 v123, v113, v113, v123
    v_lshlrev_b32 v112, 16, v107
    v_and_b32 v113, s52, v107
    v_add_f32 v120, v120, v112
    v_add_f32 v121, v121, v113
    v_fma_f32 v122, v112, v112, v122
    v_fma_f32 v123, v113, v113, v123
    v_lshlrev_b32 v112, 16, v108
    v_and_b32 v113, s52, v108
    v_add_f32 v124, v124, v112
    v_add_f32 v125, v125, v113
    v_fma_f32 v126, v112, v112, v126
    v_fma_f32 v127, v113, v113, v127
    v_lshlrev_b32 v112, 16, v109
    v_and_b32 v113, s52, v109
    v_add_f32 v124, v124, v112
    v_add_f32 v125, v125, v113
    v_fma_f32 v126, v112, v112, v126
    v_fma_f32 v127, v113, v113, v127
    v_lshlrev_b32 v112, 16, v110
    v_and_b32 v113, s52, v110
    v_add_f32 v124, v124, v112
    v_add_f32 v125, v125, v113
    v_fma_f32 v126, v112, v112, v126
    v_fma_f32 v127, v113, v113, v127
    v_lshlrev_b32 v112, 16, v111
    v_and_b32 v113, s52, v111
    v_add_f32 v124, v124, v112
    v_add_f32 v125, v125, v113
    v_fma_f32 v126, v112, v112, v126
    v_fma_f32 v127, v113, v113, v127
    s_waitcnt vmcnt(9)
    s_barrier
    ds_read_b128 v[100:103], v6 offset:34816
    ds_read_b128 v[104:107], v6 offset:34832
    ds_read_b128 v[108:111], v7 offset:34816
    s_mov_b32 s37, 640
    s_add_u32 m0, s35, 34816
    s_nop 0
    buffer_load_dwordx4 v2, s[12:15], s37 offen lds
    s_add_u32 m0, s35, 35840
    s_nop 0
    buffer_load_dwordx4 v3, s[12:15], s37 offen lds
    s_add_u32 m0, s36, 34816
    s_mov_b64 exec, s[56:57]
    buffer_load_dwordx4 v4, s[12:15], s37 offen lds
    s_mov_b64 exec, -1
    s_add_u32 s34, s32, 983040
    s_add_u32 m0, s33, 45056
    s_nop 0
    buffer_load_dwordx4 v5, s[16:19], s34 offen lds
    s_add_u32 s34, s32, 1081344
    s_add_u32 m0, s33, 49152
    s_nop 0
    buffer_load_dwordx4 v5, s[16:19], s34 offen lds
    s_add_u32 s34, s32, 984064
    s_add_u32 m0, s33, 53248
    s_nop 0
    buffer_load_dwordx4 v5, s[16:19], s34 offen lds
    s_add_u32 s34, s32, 1082368
    s_add_u32 m0, s33, 57344
    s_nop 0
    buffer_load_dwordx4 v5, s[16:19], s34 offen lds
    s_add_u32 s34, s32, 985088
    s_add_u32 m0, s33, 61440
    s_nop 0
    buffer_load_dwordx4 v5, s[16:19], s34 offen lds
    s_add_u32 s34, s32, 1083392
    s_add_u32 m0, s33, 65536
    s_nop 0
    buffer_load_dwordx4 v5, s[16:19], s34 offen lds
    s_waitcnt lgkmcnt(0)
    v_lshlrev_b32 v112, 16, v100
    v_and_b32 v113, s52, v100
    v_add_f32 v120, v120, v112
    v_add_f32 v121, v121, v113
    v_fma_f32 v122, v112, v112, v122
    v_fma_f32 v123, v113, v113, v123
    v_lshlrev_b32 v112, 16, v101
    v_and_b32 v113, s52, v101
    v_add_f32 v120, v120, v112
    v_add_f32 v121, v121, v113
    v_fma_f32 v122, v112, v112, v122
    v_fma_f32 v123, v113, v113, v123
    v_lshlrev_b32 v112, 16, v102
    v_and_b32 v113, s52, v102
    v_add_f32 v120, v120, v112
    v_add_f32 v121, v121, v113
    v_fma_f32 v122, v112, v112, v122
    v_fma_f32 v123, v113, v113, v123
    v_lshlrev_b32 v112, 16, v103
    v_and_b32 v113, s52, v103
    v_add_f32 v120, v120, v112
    v_add_f32 v121, v121, v113
    v_fma_f32 v122, v112, v112, v122
    v_fma_f32 v123, v113, v113, v123
    v_lshlrev_b32 v112, 16, v104
    v_and_b32 v113, s52, v104
    v_add_f32 v120, v120, v112
    v_add_f32 v121, v121, v113
    v_fma_f32 v122, v112, v112, v122
    v_fma_f32 v123, v113, v113, v123
    v_lshlrev_b32 v112, 16, v105
    v_and_b32 v113, s52, v105
    v_add_f32 v120, v120, v112
    v_add_f32 v121, v121, v113
    v_fma_f32 v122, v112, v112, v122
    v_fma_f32 v123, v113, v113, v123
    v_lshlrev_b32 v112, 16, v106
    v_and_b32 v113, s52, v106
    v_add_f32 v120, v120, v112
    v_add_f32 v121, v121, v113
    v_fma_f32 v122, v112, v112, v122
    v_fma_f32 v123, v113, v113, v123
    v_lshlrev_b32 v112, 16, v107
    v_and_b32 v113, s52, v107
    v_add_f32 v120, v120, v112
    v_add_f32 v121, v121, v113
    v_fma_f32 v122, v112, v112, v122
    v_fma_f32 v123, v113, v113, v123
    v_lshlrev_b32 v112, 16, v108
    v_and_b32 v113, s52, v108
    v_add_f32 v124, v124, v112
    v_add_f32 v125, v125, v113
    v_fma_f32 v126, v112, v112, v126
    v_fma_f32 v127, v113, v113, v127
    v_lshlrev_b32 v112, 16, v109
    v_and_b32 v113, s52, v109
    v_add_f32 v124, v124, v112
    v_add_f32 v125, v125, v113
    v_fma_f32 v126, v112, v112, v126
    v_fma_f32 v127, v113, v113, v127
    v_lshlrev_b32 v112, 16, v110
    v_and_b32 v113, s52, v110
    v_add_f32 v124, v124, v112
    v_add_f32 v125, v125, v113
    v_fma_f32 v126, v112, v112, v126
    v_fma_f32 v127, v113, v113, v127
    v_lshlrev_b32 v112, 16, v111
    v_and_b32 v113, s52, v111
    v_add_f32 v124, v124, v112
    v_add_f32 v125, v125, v113
    v_fma_f32 v126, v112, v112, v126
    v_fma_f32 v127, v113, v113, v127
    s_waitcnt vmcnt(9)
    s_barrier
    v_subrev_u32 v6, 69632, v6
    v_subrev_u32 v7, 69632, v7
    ds_read_b128 v[100:103], v6 offset:0
    ds_read_b128 v[104:107], v6 offset:16
    ds_read_b128 v[108:111], v7 offset:0
    s_mov_b32 s37, 768
    s_add_u32 m0, s35, 69632
    s_nop 0
    buffer_load_dwordx4 v2, s[12:15], s37 offen lds
    s_add_u32 m0, s35, 70656
    s_nop 0
    buffer_load_dwordx4 v3, s[12:15], s37 offen lds
    s_add_u32 m0, s36, 69632
    s_mov_b64 exec, s[56:57]
    buffer_load_dwordx4 v4, s[12:15], s37 offen lds
    s_mov_b64 exec, -1
    s_add_u32 s34, s32, 1179648
    s_add_u32 m0, s33, 79872
    s_nop 0
    buffer_load_dwordx4 v5, s[16:19], s34 offen lds
    s_add_u32 s34, s32, 1277952
    s_add_u32 m0, s33, 83968
    s_nop 0
    buffer_load_dwordx4 v5, s[16:19], s34 offen lds
    s_add_u32 s34, s32, 1180672
    s_add_u32 m0, s33, 88064
    s_nop 0
    buffer_load_dwordx4 v5, s[16:19], s34 offen lds
    s_add_u32 s34, s32, 1278976
    s_add_u32 m0, s33, 92160
    s_nop 0
    buffer_load_dwordx4 v5, s[16:19], s34 offen lds
    s_add_u32 s34, s32, 1181696
    s_add_u32 m0, s33, 96256
    s_nop 0
    buffer_load_dwordx4 v5, s[16:19], s34 offen lds
    s_add_u32 s34, s32, 1280000
    s_add_u32 m0, s33, 100352
    s_nop 0
    buffer_load_dwordx4 v5, s[16:19], s34 offen lds
    s_waitcnt lgkmcnt(0)
    v_lshlrev_b32 v112, 16, v100
    v_and_b32 v113, s52, v100
    v_add_f32 v120, v120, v112
    v_add_f32 v121, v121, v113
    v_fma_f32 v122, v112, v112, v122
    v_fma_f32 v123, v113, v113, v123
    v_lshlrev_b32 v112, 16, v101
    v_and_b32 v113, s52, v101
    v_add_f32 v120, v120, v112
    v_add_f32 v121, v121, v113
    v_fma_f32 v122, v112, v112, v122
    v_fma_f32 v123, v113, v113, v123
    v_lshlrev_b32 v112, 16, v102
    v_and_b32 v113, s52, v102
    v_add_f32 v120, v120, v112
    v_add_f32 v121, v121, v113
    v_fma_f32 v122, v112, v112, v122
    v_fma_f32 v123, v113, v113, v123
    v_lshlrev_b32 v112, 16, v103
    v_and_b32 v113, s52, v103
    v_add_f32 v120, v120, v112
    v_add_f32 v121, v121, v113
    v_fma_f32 v122, v112, v112, v122
    v_fma_f32 v123, v113, v113, v123
    v_lshlrev_b32 v112, 16, v104
    v_and_b32 v113, s52, v104
    v_add_f32 v120, v120, v112
    v_add_f32 v121, v121, v113
    v_fma_f32 v122, v112, v112, v122
    v_fma_f32 v123, v113, v113, v123
    v_lshlrev_b32 v112, 16, v105
    v_and_b32 v113, s52, v105
    v_add_f32 v120, v120, v112
    v_add_f32 v121, v121, v113
    v_fma_f32 v122, v112, v112, v122
    v_fma_f32 v123, v113, v113, v123
    v_lshlrev_b32 v112, 16, v106
    v_and_b32 v113, s52, v106
    v_add_f32 v120, v120, v112
    v_add_f32 v121, v121, v113
    v_fma_f32 v122, v112, v112, v122
    v_fma_f32 v123, v113, v113, v123
    v_lshlrev_b32 v112, 16, v107
    v_and_b32 v113, s52, v107
    v_add_f32 v120, v120, v112
    v_add_f32 v121, v121, v113
    v_fma_f32 v122, v112, v112, v122
    v_fma_f32 v123, v113, v113, v123
    v_lshlrev_b32 v112, 16, v108
    v_and_b32 v113, s52, v108
    v_add_f32 v124, v124, v112
    v_add_f32 v125, v125, v113
    v_fma_f32 v126, v112, v112, v126
    v_fma_f32 v127, v113, v113, v127
    v_lshlrev_b32 v112, 16, v109
    v_and_b32 v113, s52, v109
    v_add_f32 v124, v124, v112
    v_add_f32 v125, v125, v113
    v_fma_f32 v126, v112, v112, v126
    v_fma_f32 v127, v113, v113, v127
    v_lshlrev_b32 v112, 16, v110
    v_and_b32 v113, s52, v110
    v_add_f32 v124, v124, v112
    v_add_f32 v125, v125, v113
    v_fma_f32 v126, v112, v112, v126
    v_fma_f32 v127, v113, v113, v127
    v_lshlrev_b32 v112, 16, v111
    v_and_b32 v113, s52, v111
    v_add_f32 v124, v124, v112
    v_add_f32 v125, v125, v113
    v_fma_f32 v126, v112, v112, v126
    v_fma_f32 v127, v113, v113, v127
    s_waitcnt vmcnt(9)
    s_barrier
    ds_read_b128 v[100:103], v6 offset:34816
    ds_read_b128 v[104:107], v6 offset:34832
    ds_read_b128 v[108:111], v7 offset:34816
    s_mov_b32 s37, 896
    s_add_u32 m0, s35, 104448
    s_nop 0
    buffer_load_dwordx4 v2, s[12:15], s37 offen lds
    s_add_u32 m0, s35, 105472
    s_nop 0
    buffer_load_dwordx4 v3, s[12:15], s37 offen lds
    s_add_u32 m0, s36, 104448
    s_mov_b64 exec, s[56:57]
    buffer_load_dwordx4 v4, s[12:15], s37 offen lds
    s_mov_b64 exec, -1
    s_add_u32 s34, s32, 1376256
    s_add_u32 m0, s33, 114688
    s_nop 0
    buffer_load_dwordx4 v5, s[16:19], s34 offen lds
    s_add_u32 s34, s32, 1474560
    s_add_u32 m0, s33, 118784
    s_nop 0
    buffer_load_dwordx4 v5, s[16:19], s34 offen lds
    s_add_u32 s34, s32, 1377280
    s_add_u32 m0, s33, 122880
    s_nop 0
    buffer_load_dwordx4 v5, s[16:19], s34 offen lds
    s_add_u32 s34, s32, 1475584
    s_add_u32 m0, s33, 126976
    s_nop 0
    buffer_load_dwordx4 v5, s[16:19], s34 offen lds
    s_add_u32 s34, s32, 1378304
    s_add_u32 m0, s33, 131072
    s_nop 0
    buffer_load_dwordx4 v5, s[16:19], s34 offen lds
    s_add_u32 s34, s32, 1476608
    s_add_u32 m0, s33, 135168
    s_nop 0
    buffer_load_dwordx4 v5, s[16:19], s34 offen lds
    s_waitcnt lgkmcnt(0)
    v_lshlrev_b32 v112, 16, v100
    v_and_b32 v113, s52, v100
    v_add_f32 v120, v120, v112
    v_add_f32 v121, v121, v113
    v_fma_f32 v122, v112, v112, v122
    v_fma_f32 v123, v113, v113, v123
    v_lshlrev_b32 v112, 16, v101
    v_and_b32 v113, s52, v101
    v_add_f32 v120, v120, v112
    v_add_f32 v121, v121, v113
    v_fma_f32 v122, v112, v112, v122
    v_fma_f32 v123, v113, v113, v123
    v_lshlrev_b32 v112, 16, v102
    v_and_b32 v113, s52, v102
    v_add_f32 v120, v120, v112
    v_add_f32 v121, v121, v113
    v_fma_f32 v122, v112, v112, v122
    v_fma_f32 v123, v113, v113, v123
    v_lshlrev_b32 v112, 16, v103
    v_and_b32 v113, s52, v103
    v_add_f32 v120, v120, v112
    v_add_f32 v121, v121, v113
    v_fma_f32 v122, v112, v112, v122
    v_fma_f32 v123, v113, v113, v123
    v_lshlrev_b32 v112, 16, v104
    v_and_b32 v113, s52, v104
    v_add_f32 v120, v120, v112
    v_add_f32 v121, v121, v113
    v_fma_f32 v122, v112, v112, v122
    v_fma_f32 v123, v113, v113, v123
    v_lshlrev_b32 v112, 16, v105
    v_and_b32 v113, s52, v105
    v_add_f32 v120, v120, v112
    v_add_f32 v121, v121, v113
    v_fma_f32 v122, v112, v112, v122
    v_fma_f32 v123, v113, v113, v123
    v_lshlrev_b32 v112, 16, v106
    v_and_b32 v113, s52, v106
    v_add_f32 v120, v120, v112
    v_add_f32 v121, v121, v113
    v_fma_f32 v122, v112, v112, v122
    v_fma_f32 v123, v113, v113, v123
    v_lshlrev_b32 v112, 16, v107
    v_and_b32 v113, s52, v107
    v_add_f32 v120, v120, v112
    v_add_f32 v121, v121, v113
    v_fma_f32 v122, v112, v112, v122
    v_fma_f32 v123, v113, v113, v123
    v_lshlrev_b32 v112, 16, v108
    v_and_b32 v113, s52, v108
    v_add_f32 v124, v124, v112
    v_add_f32 v125, v125, v113
    v_fma_f32 v126, v112, v112, v126
    v_fma_f32 v127, v113, v113, v127
    v_lshlrev_b32 v112, 16, v109
    v_and_b32 v113, s52, v109
    v_add_f32 v124, v124, v112
    v_add_f32 v125, v125, v113
    v_fma_f32 v126, v112, v112, v126
    v_fma_f32 v127, v113, v113, v127
    v_lshlrev_b32 v112, 16, v110
    v_and_b32 v113, s52, v110
    v_add_f32 v124, v124, v112
    v_add_f32 v125, v125, v113
    v_fma_f32 v126, v112, v112, v126
    v_fma_f32 v127, v113, v113, v127
    v_lshlrev_b32 v112, 16, v111
    v_and_b32 v113, s52, v111
    v_add_f32 v124, v124, v112
    v_add_f32 v125, v125, v113
    v_fma_f32 v126, v112, v112, v126
    v_fma_f32 v127, v113, v113, v127
    s_waitcnt vmcnt(9)
    s_barrier
    v_add_u32 v6, 69632, v6
    v_add_u32 v7, 69632, v7
    ds_read_b128 v[100:103], v6 offset:0
    ds_read_b128 v[104:107], v6 offset:16
    ds_read_b128 v[108:111], v7 offset:0
    s_waitcnt lgkmcnt(0)
    v_lshlrev_b32 v112, 16, v100
    v_and_b32 v113, s52, v100
    v_add_f32 v120, v120, v112
    v_add_f32 v121, v121, v113
    v_fma_f32 v122, v112, v112, v122
    v_fma_f32 v123, v113, v113, v123
    v_lshlrev_b32 v112, 16, v101
    v_and_b32 v113, s52, v101
    v_add_f32 v120, v120, v112
    v_add_f32 v121, v121, v113
    v_fma_f32 v122, v112, v112, v122
    v_fma_f32 v123, v113, v113, v123
    v_lshlrev_b32 v112, 16, v102
    v_and_b32 v113, s52, v102
    v_add_f32 v120, v120, v112
    v_add_f32 v121, v121, v113
    v_fma_f32 v122, v112, v112, v122
    v_fma_f32 v123, v113, v113, v123
    v_lshlrev_b32 v112, 16, v103
    v_and_b32 v113, s52, v103
    v_add_f32 v120, v120, v112
    v_add_f32 v121, v121, v113
    v_fma_f32 v122, v112, v112, v122
    v_fma_f32 v123, v113, v113, v123
    v_lshlrev_b32 v112, 16, v104
    v_and_b32 v113, s52, v104
    v_add_f32 v120, v120, v112
    v_add_f32 v121, v121, v113
    v_fma_f32 v122, v112, v112, v122
    v_fma_f32 v123, v113, v113, v123
    v_lshlrev_b32 v112, 16, v105
    v_and_b32 v113, s52, v105
    v_add_f32 v120, v120, v112
    v_add_f32 v121, v121, v113
    v_fma_f32 v122, v112, v112, v122
    v_fma_f32 v123, v113, v113, v123
    v_lshlrev_b32 v112, 16, v106
    v_and_b32 v113, s52, v106
    v_add_f32 v120, v120, v112
    v_add_f32 v121, v121, v113
    v_fma_f32 v122, v112, v112, v122
    v_fma_f32 v123, v113, v113, v123
    v_lshlrev_b32 v112, 16, v107
    v_and_b32 v113, s52, v107
    v_add_f32 v120, v120, v112
    v_add_f32 v121, v121, v113
    v_fma_f32 v122, v112, v112, v122
    v_fma_f32 v123, v113, v113, v123
    v_lshlrev_b32 v112, 16, v108
    v_and_b32 v113, s52, v108
    v_add_f32 v124, v124, v112
    v_add_f32 v125, v125, v113
    v_fma_f32 v126, v112, v112, v126
    v_fma_f32 v127, v113, v113, v127
    v_lshlrev_b32 v112, 16, v109
    v_and_b32 v113, s52, v109
    v_add_f32 v124, v124, v112
    v_add_f32 v125, v125, v113
    v_fma_f32 v126, v112, v112, v126
    v_fma_f32 v127, v113, v113, v127
    v_lshlrev_b32 v112, 16, v110
    v_and_b32 v113, s52, v110
    v_add_f32 v124, v124, v112
    v_add_f32 v125, v125, v113
    v_fma_f32 v126, v112, v112, v126
    v_fma_f32 v127, v113, v113, v127
    v_lshlrev_b32 v112, 16, v111
    v_and_b32 v113, s52, v111
    v_add_f32 v124, v124, v112
    v_add_f32 v125, v125, v113
    v_fma_f32 v126, v112, v112, v126
    v_fma_f32 v127, v113, v113, v127
    s_waitcnt vmcnt(0)
    s_barrier
    ds_read_b128 v[100:103], v6 offset:34816
    ds_read_b128 v[104:107], v6 offset:34832
    ds_read_b128 v[108:111], v7 offset:34816
    s_waitcnt lgkmcnt(0)
    v_lshlrev_b32 v112, 16, v100
    v_and_b32 v113, s52, v100
    v_add_f32 v120, v120, v112
    v_add_f32 v121, v121, v113
    v_fma_f32 v122, v112, v112, v122
    v_fma_f32 v123, v113, v113, v123
    v_lshlrev_b32 v112, 16, v101
    v_and_b32 v113, s52, v101
    v_add_f32 v120, v120, v112
    v_add_f32 v121, v121, v113
    v_fma_f32 v122, v112, v112, v122
    v_fma_f32 v123, v113, v113, v123
    v_lshlrev_b32 v112, 16, v102
    v_and_b32 v113, s52, v102
    v_add_f32 v120, v120, v112
    v_add_f32 v121, v121, v113
    v_fma_f32 v122, v112, v112, v122
    v_fma_f32 v123, v113, v113, v123
    v_lshlrev_b32 v112, 16, v103
    v_and_b32 v113, s52, v103
    v_add_f32 v120, v120, v112
    v_add_f32 v121, v121, v113
    v_fma_f32 v122, v112, v112, v122
    v_fma_f32 v123, v113, v113, v123
    v_lshlrev_b32 v112, 16, v104
    v_and_b32 v113, s52, v104
    v_add_f32 v120, v120, v112
    v_add_f32 v121, v121, v113
    v_fma_f32 v122, v112, v112, v122
    v_fma_f32 v123, v113, v113, v123
    v_lshlrev_b32 v112, 16, v105
    v_and_b32 v113, s52, v105
    v_add_f32 v120, v120, v112
    v_add_f32 v121, v121, v113
    v_fma_f32 v122, v112, v112, v122
    v_fma_f32 v123, v113, v113, v123
    v_lshlrev_b32 v112, 16, v106
    v_and_b32 v113, s52, v106
    v_add_f32 v120, v120, v112
    v_add_f32 v121, v121, v113
    v_fma_f32 v122, v112, v112, v122
    v_fma_f32 v123, v113, v113, v123
    v_lshlrev_b32 v112, 16, v107
    v_and_b32 v113, s52, v107
    v_add_f32 v120, v120, v112
    v_add_f32 v121, v121, v113
    v_fma_f32 v122, v112, v112, v122
    v_fma_f32 v123, v113, v113, v123
    v_lshlrev_b32 v112, 16, v108
    v_and_b32 v113, s52, v108
    v_add_f32 v124, v124, v112
    v_add_f32 v125, v125, v113
    v_fma_f32 v126, v112, v112, v126
    v_fma_f32 v127, v113, v113, v127
    v_lshlrev_b32 v112, 16, v109
    v_and_b32 v113, s52, v109
    v_add_f32 v124, v124, v112
    v_add_f32 v125, v125, v113
    v_fma_f32 v126, v112, v112, v126
    v_fma_f32 v127, v113, v113, v127
    v_lshlrev_b32 v112, 16, v110
    v_and_b32 v113, s52, v110
    v_add_f32 v124, v124, v112
    v_add_f32 v125, v125, v113
    v_fma_f32 v126, v112, v112, v126
    v_fma_f32 v127, v113, v113, v127
    v_lshlrev_b32 v112, 16, v111
    v_and_b32 v113, s52, v111
    v_add_f32 v124, v124, v112
    v_add_f32 v125, v125, v113
    v_fma_f32 v126, v112, v112, v126
    v_fma_f32 v127, v113, v113, v127
    v_add_f32 v120, v120, v121
    v_add_f32 v121, v122, v123
    v_add_f32 v122, v124, v125
    v_add_f32 v123, v126, v127
    v_add_f32_dpp v120, v120, v120 quad_perm:[1,0,3,2] row_mask:0xf bank_mask:0xf
    v_add_f32_dpp v121, v121, v121 quad_perm:[1,0,3,2] row_mask:0xf bank_mask:0xf
    v_add_f32_dpp v122, v122, v122 quad_perm:[1,0,3,2] row_mask:0xf bank_mask:0xf
    v_add_f32_dpp v123, v123, v123 quad_perm:[1,0,3,2] row_mask:0xf bank_mask:0xf
    v_add_f32_dpp v120, v120, v120 quad_perm:[2,3,0,1] row_mask:0xf bank_mask:0xf
    v_add_f32_dpp v121, v121, v121 quad_perm:[2,3,0,1] row_mask:0xf bank_mask:0xf
    v_add_f32_dpp v122, v122, v122 quad_perm:[2,3,0,1] row_mask:0xf bank_mask:0xf
    v_add_f32_dpp v123, v123, v123 quad_perm:[2,3,0,1] row_mask:0xf bank_mask:0xf
    s_nop 0
    v_add_f32_dpp v122, v122, v122 row_half_mirror row_mask:0xf bank_mask:0xf
    v_add_f32_dpp v123, v123, v123 row_half_mirror row_mask:0xf bank_mask:0xf
    v_mul_f32 v112, s53, v120
    v_mul_f32 v113, s53, v121
    v_fma_f32 v113, -v112, v112, v113
    v_max_f32 v113, 0, v113
    v_cvt_pk_bf16_f32 v112, v112, v113
    v_lshlrev_b32 v124, 16, v112
    v_and_b32 v113, s52, v112
    v_add_f32 v113, s54, v113
    v_cvt_pk_bf16_f32 v113, v113, v113
    v_lshlrev_b32 v113, 16, v113
    v_sqrt_f32 v113, v113
    s_nop 0
    v_cvt_pk_bf16_f32 v113, v113, v113
    v_lshlrev_b32 v113, 16, v113
    v_rcp_f32 v125, v113
    v_mul_f32 v114, s53, v122
    v_mul_f32 v115, s53, v123
    v_fma_f32 v115, -v114, v114, v115
    v_max_f32 v115, 0, v115
    v_cvt_pk_bf16_f32 v114, v114, v115
    v_lshlrev_b32 v126, 16, v114
    v_and_b32 v115, s52, v114
    v_add_f32 v115, s54, v115
    v_cvt_pk_bf16_f32 v115, v115, v115
    v_lshlrev_b32 v115, 16, v115
    v_sqrt_f32 v115, v115
    s_nop 0
    v_cvt_pk_bf16_f32 v115, v115, v115
    v_lshlrev_b32 v115, 16, v115
    v_rcp_f32 v127, v115
    v_lshrrev_b32 v112, 2, v1
    v_lshlrev_b32 v112, 3, v112
    s_lshl_b32 s34, s30, 7
    v_add_u32 v112, s34, v112
    ds_write_b64 v112, v[124:125] offset:0
    v_bfe_u32 v112, v1, 3, 2
    v_lshlrev_b32 v112, 3, v112
    s_lshl_b32 s34, s30, 5
    v_add_u32 v112, s34, v112
    ds_write_b64 v112, v[126:127] offset:512
    s_mov_b32 s20, s8
    s_and_b32 s21, s9, 0xffff
    s_mov_b32 s22, 2097152
    s_mov_b32 s23, 0x00020000
    s_waitcnt lgkmcnt(0)
    s_barrier
    s_add_u32 s30, s30, 4
    s_branch L_k1l2_attn
L_k1l2_comp:
    s_lshl_b32 s35, s30, 11
    s_add_u32 s35, s35, 2048
    s_waitcnt lgkmcnt(0)
    s_mov_b32 s20, s8
    s_and_b32 s21, s9, 0xffff
    s_mov_b32 s22, 2097152
    s_mov_b32 s23, 0x00020000
    v_and_b32 v10, 15, v1
    v_lshrrev_b32 v13, 1, v10
    v_xor_b32 v13, v13, v12
    v_lshlrev_b32 v6, 7, v10
    v_lshl_add_u32 v6, v13, 4, v6
    v_xor_b32 v7, 64, v6
    v_add_u32 v8, s35, v6
    v_add_u32 v9, s35, v7
    v_bfe_u32 v13, v1, 2, 2
    v_lshl_add_u32 v14, v12, 3, v13
    v_lshlrev_b32 v164, 7, v14
    v_lshrrev_b32 v13, 1, v13
    v_and_b32 v14, 1, v12
    v_lshl_or_b32 v13, v14, 1, v13
    v_xor_b32 v13, s30, v13
    v_lshl_add_u32 v164, v13, 5, v164
    v_and_b32 v14, 3, v1
    v_lshl_add_u32 v164, v14, 3, v164
    v_add_u32 v164, 10240, v164
    v_add_u32 v165, 69632, v6
    v_add_u32 v166, 69632, v7
    v_add_u32 v167, 69632, v8
    v_add_u32 v168, 69632, v9
    v_add_u32 v169, 69632, v164
    v_mov_b32 v16, 0
    v_mov_b32 v17, 0
    v_mov_b32 v18, 0
    v_mov_b32 v19, 0
    v_mov_b32 v20, 0
    v_mov_b32 v21, 0
    v_mov_b32 v22, 0
    v_mov_b32 v23, 0
    v_mov_b32 v24, 0
    v_mov_b32 v25, 0
    v_mov_b32 v26, 0
    v_mov_b32 v27, 0
    v_mov_b32 v28, 0
    v_mov_b32 v29, 0
    v_mov_b32 v30, 0
    v_mov_b32 v31, 0
    v_mov_b32 v32, 0
    v_mov_b32 v33, 0
    v_mov_b32 v34, 0
    v_mov_b32 v35, 0
    v_mov_b32 v36, 0
    v_mov_b32 v37, 0
    v_mov_b32 v38, 0
    v_mov_b32 v39, 0
    v_mov_b32 v40, 0
    v_mov_b32 v41, 0
    v_mov_b32 v42, 0
    v_mov_b32 v43, 0
    v_mov_b32 v44, 0
    v_mov_b32 v45, 0
    v_mov_b32 v46, 0
    v_mov_b32 v47, 0
    v_mov_b32 v48, 0
    v_mov_b32 v49, 0
    v_mov_b32 v50, 0
    v_mov_b32 v51, 0
    v_mov_b32 v52, 0
    v_mov_b32 v53, 0
    v_mov_b32 v54, 0
    v_mov_b32 v55, 0
    v_mov_b32 v56, 0
    v_mov_b32 v57, 0
    v_mov_b32 v58, 0
    v_mov_b32 v59, 0
    v_mov_b32 v60, 0
    v_mov_b32 v61, 0
    v_mov_b32 v62, 0
    v_mov_b32 v63, 0
    v_mov_b32 v64, 0
    v_mov_b32 v65, 0
    v_mov_b32 v66, 0
    v_mov_b32 v67, 0
    v_mov_b32 v68, 0
    v_mov_b32 v69, 0
    v_mov_b32 v70, 0
    v_mov_b32 v71, 0
    v_mov_b32 v72, 0
    v_mov_b32 v73, 0
    v_mov_b32 v74, 0
    v_mov_b32 v75, 0
    v_mov_b32 v76, 0
    v_mov_b32 v77, 0
    v_mov_b32 v78, 0
    v_mov_b32 v79, 0
    v_mov_b32 v80, 0
    v_mov_b32 v81, 0
    v_mov_b32 v82, 0
    v_mov_b32 v83, 0
    v_mov_b32 v84, 0
    v_mov_b32 v85, 0
    v_mov_b32 v86, 0
    v_mov_b32 v87, 0
    v_mov_b32 v160, 0x3f803f80
    v_mov_b32 v161, 0x3f803f80
    v_mov_b32 v162, 0x3f803f80
    v_mov_b32 v163, 0x3f803f80
    v_mov_b32 v170, 0
    v_mov_b32 v171, 0
    v_mov_b32 v172, 0
    v_mov_b32 v173, 0
    s_barrier
    ds_read_b64_tr_b16 v[136:137], v164 offset:0
    ds_read_b64_tr_b16 v[138:139], v164 offset:512
    ds_read_b64_tr_b16 v[140:141], v164 offset:8192
    ds_read_b64_tr_b16 v[142:143], v164 offset:8704
    ds_read_b64_tr_b16 v[144:145], v164 offset:16384
    ds_read_b64_tr_b16 v[146:147], v164 offset:16896
    ds_read_b128 v[88:91], v6 offset:2048
    ds_read_b128 v[92:95], v6 offset:4096
    ds_read_b128 v[96:99], v6 offset:6144
    ds_read_b128 v[100:103], v6 offset:8192
    ds_read_b128 v[104:107], v6 offset:0
    s_waitcnt lgkmcnt(0)
    ds_read_b64_tr_b16 v[148:149], v164 offset:4096
    ds_read_b64_tr_b16 v[150:151], v164 offset:4608
    ds_read_b64_tr_b16 v[152:153], v164 offset:12288
    ds_read_b64_tr_b16 v[154:155], v164 offset:12800
    ds_read_b64_tr_b16 v[156:157], v164 offset:20480
    ds_read_b64_tr_b16 v[158:159], v164 offset:20992
    ds_read_b128 v[112:115], v7 offset:2048
    ds_read_b128 v[116:119], v7 offset:4096
    ds_read_b128 v[120:123], v7 offset:6144
    ds_read_b128 v[124:127], v7 offset:8192
    ds_read_b128 v[128:131], v7 offset:0
    v_mfma_f32_16x16x32_bf16 v[16:19], v[136:139], v[88:91], v[16:19]
    v_mfma_f32_16x16x32_bf16 v[20:23], v[136:139], v[92:95], v[20:23]
    v_mfma_f32_16x16x32_bf16 v[24:27], v[136:139], v[96:99], v[24:27]
    v_mfma_f32_16x16x32_bf16 v[28:31], v[136:139], v[100:103], v[28:31]
    v_mfma_f32_16x16x32_bf16 v[76:79], v[136:139], v[160:163], v[76:79]
    v_mfma_f32_16x16x32_bf16 v[36:39], v[140:143], v[88:91], v[36:39]
    v_mfma_f32_16x16x32_bf16 v[40:43], v[140:143], v[92:95], v[40:43]
    v_mfma_f32_16x16x32_bf16 v[44:47], v[140:143], v[96:99], v[44:47]
    v_mfma_f32_16x16x32_bf16 v[48:51], v[140:143], v[100:103], v[48:51]
    v_mfma_f32_16x16x32_bf16 v[52:55], v[140:143], v[104:107], v[52:55]
    v_mfma_f32_16x16x32_bf16 v[80:83], v[140:143], v[160:163], v[80:83]
    v_mfma_f32_16x16x32_bf16 v[56:59], v[144:147], v[88:91], v[56:59]
    v_mfma_f32_16x16x32_bf16 v[60:63], v[144:147], v[92:95], v[60:63]
    v_mfma_f32_16x16x32_bf16 v[64:67], v[144:147], v[96:99], v[64:67]
    v_mfma_f32_16x16x32_bf16 v[68:71], v[144:147], v[100:103], v[68:71]
    v_mfma_f32_16x16x32_bf16 v[72:75], v[144:147], v[104:107], v[72:75]
    v_mfma_f32_16x16x32_bf16 v[84:87], v[144:147], v[160:163], v[84:87]
    s_waitcnt lgkmcnt(0)
    s_barrier
    ds_read_b64_tr_b16 v[136:137], v164 offset:34816
    ds_read_b64_tr_b16 v[138:139], v164 offset:35328
    ds_read_b64_tr_b16 v[140:141], v164 offset:43008
    ds_read_b64_tr_b16 v[142:143], v164 offset:43520
    ds_read_b64_tr_b16 v[144:145], v164 offset:51200
    ds_read_b64_tr_b16 v[146:147], v164 offset:51712
    ds_read_b128 v[88:91], v6 offset:36864
    ds_read_b128 v[92:95], v6 offset:38912
    ds_read_b128 v[96:99], v6 offset:40960
    ds_read_b128 v[100:103], v6 offset:43008
    ds_read_b128 v[104:107], v6 offset:34816
    v_mfma_f32_16x16x32_bf16 v[16:19], v[148:151], v[112:115], v[16:19]
    v_mfma_f32_16x16x32_bf16 v[20:23], v[148:151], v[116:119], v[20:23]
    v_mfma_f32_16x16x32_bf16 v[24:27], v[148:151], v[120:123], v[24:27]
    v_mfma_f32_16x16x32_bf16 v[28:31], v[148:151], v[124:127], v[28:31]
    v_mfma_f32_16x16x32_bf16 v[76:79], v[148:151], v[160:163], v[76:79]
    v_mfma_f32_16x16x32_bf16 v[36:39], v[152:155], v[112:115], v[36:39]
    v_mfma_f32_16x16x32_bf16 v[40:43], v[152:155], v[116:119], v[40:43]
    v_mfma_f32_16x16x32_bf16 v[44:47], v[152:155], v[120:123], v[44:47]
    v_mfma_f32_16x16x32_bf16 v[48:51], v[152:155], v[124:127], v[48:51]
    v_mfma_f32_16x16x32_bf16 v[52:55], v[152:155], v[128:131], v[52:55]
    v_mfma_f32_16x16x32_bf16 v[80:83], v[152:155], v[160:163], v[80:83]
    v_mfma_f32_16x16x32_bf16 v[56:59], v[156:159], v[112:115], v[56:59]
    v_mfma_f32_16x16x32_bf16 v[60:63], v[156:159], v[116:119], v[60:63]
    v_mfma_f32_16x16x32_bf16 v[64:67], v[156:159], v[120:123], v[64:67]
    v_mfma_f32_16x16x32_bf16 v[68:71], v[156:159], v[124:127], v[68:71]
    v_mfma_f32_16x16x32_bf16 v[72:75], v[156:159], v[128:131], v[72:75]
    v_mfma_f32_16x16x32_bf16 v[84:87], v[156:159], v[160:163], v[84:87]
    s_waitcnt lgkmcnt(0)
    ds_read_b64_tr_b16 v[148:149], v164 offset:38912
    ds_read_b64_tr_b16 v[150:151], v164 offset:39424
    ds_read_b64_tr_b16 v[152:153], v164 offset:47104
    ds_read_b64_tr_b16 v[154:155], v164 offset:47616
    ds_read_b64_tr_b16 v[156:157], v164 offset:55296
    ds_read_b64_tr_b16 v[158:159], v164 offset:55808
    ds_read_b128 v[112:115], v7 offset:36864
    ds_read_b128 v[116:119], v7 offset:38912
    ds_read_b128 v[120:123], v7 offset:40960
    ds_read_b128 v[124:127], v7 offset:43008
    ds_read_b128 v[128:131], v7 offset:34816
    v_mfma_f32_16x16x32_bf16 v[16:19], v[136:139], v[88:91], v[16:19]
    v_mfma_f32_16x16x32_bf16 v[20:23], v[136:139], v[92:95], v[20:23]
    v_mfma_f32_16x16x32_bf16 v[24:27], v[136:139], v[96:99], v[24:27]
    v_mfma_f32_16x16x32_bf16 v[28:31], v[136:139], v[100:103], v[28:31]
    v_mfma_f32_16x16x32_bf16 v[76:79], v[136:139], v[160:163], v[76:79]
    v_mfma_f32_16x16x32_bf16 v[36:39], v[140:143], v[88:91], v[36:39]
    v_mfma_f32_16x16x32_bf16 v[40:43], v[140:143], v[92:95], v[40:43]
    v_mfma_f32_16x16x32_bf16 v[44:47], v[140:143], v[96:99], v[44:47]
    v_mfma_f32_16x16x32_bf16 v[48:51], v[140:143], v[100:103], v[48:51]
    v_mfma_f32_16x16x32_bf16 v[52:55], v[140:143], v[104:107], v[52:55]
    v_mfma_f32_16x16x32_bf16 v[80:83], v[140:143], v[160:163], v[80:83]
    v_mfma_f32_16x16x32_bf16 v[56:59], v[144:147], v[88:91], v[56:59]
    v_mfma_f32_16x16x32_bf16 v[60:63], v[144:147], v[92:95], v[60:63]
    v_mfma_f32_16x16x32_bf16 v[64:67], v[144:147], v[96:99], v[64:67]
    v_mfma_f32_16x16x32_bf16 v[68:71], v[144:147], v[100:103], v[68:71]
    v_mfma_f32_16x16x32_bf16 v[72:75], v[144:147], v[104:107], v[72:75]
    v_mfma_f32_16x16x32_bf16 v[84:87], v[144:147], v[160:163], v[84:87]
    s_waitcnt lgkmcnt(0)
    s_barrier
    ds_read_b64_tr_b16 v[136:137], v169 offset:0
    ds_read_b64_tr_b16 v[138:139], v169 offset:512
    ds_read_b64_tr_b16 v[140:141], v169 offset:8192
    ds_read_b64_tr_b16 v[142:143], v169 offset:8704
    ds_read_b64_tr_b16 v[144:145], v169 offset:16384
    ds_read_b64_tr_b16 v[146:147], v169 offset:16896
    ds_read_b128 v[88:91], v165 offset:2048
    ds_read_b128 v[92:95], v165 offset:4096
    ds_read_b128 v[96:99], v165 offset:6144
    ds_read_b128 v[100:103], v165 offset:8192
    ds_read_b128 v[104:107], v165 offset:0
    v_mfma_f32_16x16x32_bf16 v[16:19], v[148:151], v[112:115], v[16:19]
    v_mfma_f32_16x16x32_bf16 v[20:23], v[148:151], v[116:119], v[20:23]
    v_mfma_f32_16x16x32_bf16 v[24:27], v[148:151], v[120:123], v[24:27]
    v_mfma_f32_16x16x32_bf16 v[28:31], v[148:151], v[124:127], v[28:31]
    v_mfma_f32_16x16x32_bf16 v[76:79], v[148:151], v[160:163], v[76:79]
    v_mfma_f32_16x16x32_bf16 v[36:39], v[152:155], v[112:115], v[36:39]
    v_mfma_f32_16x16x32_bf16 v[40:43], v[152:155], v[116:119], v[40:43]
    v_mfma_f32_16x16x32_bf16 v[44:47], v[152:155], v[120:123], v[44:47]
    v_mfma_f32_16x16x32_bf16 v[48:51], v[152:155], v[124:127], v[48:51]
    v_mfma_f32_16x16x32_bf16 v[52:55], v[152:155], v[128:131], v[52:55]
    v_mfma_f32_16x16x32_bf16 v[80:83], v[152:155], v[160:163], v[80:83]
    v_mfma_f32_16x16x32_bf16 v[56:59], v[156:159], v[112:115], v[56:59]
    v_mfma_f32_16x16x32_bf16 v[60:63], v[156:159], v[116:119], v[60:63]
    v_mfma_f32_16x16x32_bf16 v[64:67], v[156:159], v[120:123], v[64:67]
    v_mfma_f32_16x16x32_bf16 v[68:71], v[156:159], v[124:127], v[68:71]
    v_mfma_f32_16x16x32_bf16 v[72:75], v[156:159], v[128:131], v[72:75]
    v_mfma_f32_16x16x32_bf16 v[84:87], v[156:159], v[160:163], v[84:87]
    s_waitcnt lgkmcnt(0)
    ds_read_b64_tr_b16 v[148:149], v169 offset:4096
    ds_read_b64_tr_b16 v[150:151], v169 offset:4608
    ds_read_b64_tr_b16 v[152:153], v169 offset:12288
    ds_read_b64_tr_b16 v[154:155], v169 offset:12800
    ds_read_b64_tr_b16 v[156:157], v169 offset:20480
    ds_read_b64_tr_b16 v[158:159], v169 offset:20992
    ds_read_b128 v[112:115], v166 offset:2048
    ds_read_b128 v[116:119], v166 offset:4096
    ds_read_b128 v[120:123], v166 offset:6144
    ds_read_b128 v[124:127], v166 offset:8192
    ds_read_b128 v[128:131], v166 offset:0
    v_mfma_f32_16x16x32_bf16 v[16:19], v[136:139], v[88:91], v[16:19]
    v_mfma_f32_16x16x32_bf16 v[20:23], v[136:139], v[92:95], v[20:23]
    v_mfma_f32_16x16x32_bf16 v[24:27], v[136:139], v[96:99], v[24:27]
    v_mfma_f32_16x16x32_bf16 v[28:31], v[136:139], v[100:103], v[28:31]
    v_mfma_f32_16x16x32_bf16 v[76:79], v[136:139], v[160:163], v[76:79]
    v_mfma_f32_16x16x32_bf16 v[36:39], v[140:143], v[88:91], v[36:39]
    v_mfma_f32_16x16x32_bf16 v[40:43], v[140:143], v[92:95], v[40:43]
    v_mfma_f32_16x16x32_bf16 v[44:47], v[140:143], v[96:99], v[44:47]
    v_mfma_f32_16x16x32_bf16 v[48:51], v[140:143], v[100:103], v[48:51]
    v_mfma_f32_16x16x32_bf16 v[52:55], v[140:143], v[104:107], v[52:55]
    v_mfma_f32_16x16x32_bf16 v[80:83], v[140:143], v[160:163], v[80:83]
    v_mfma_f32_16x16x32_bf16 v[56:59], v[144:147], v[88:91], v[56:59]
    v_mfma_f32_16x16x32_bf16 v[60:63], v[144:147], v[92:95], v[60:63]
    v_mfma_f32_16x16x32_bf16 v[64:67], v[144:147], v[96:99], v[64:67]
    v_mfma_f32_16x16x32_bf16 v[68:71], v[144:147], v[100:103], v[68:71]
    v_mfma_f32_16x16x32_bf16 v[72:75], v[144:147], v[104:107], v[72:75]
    v_mfma_f32_16x16x32_bf16 v[84:87], v[144:147], v[160:163], v[84:87]
    s_waitcnt lgkmcnt(0)
    s_barrier
    ds_read_b64_tr_b16 v[136:137], v169 offset:34816
    ds_read_b64_tr_b16 v[138:139], v169 offset:35328
    ds_read_b64_tr_b16 v[140:141], v169 offset:43008
    ds_read_b64_tr_b16 v[142:143], v169 offset:43520
    ds_read_b64_tr_b16 v[144:145], v169 offset:51200
    ds_read_b64_tr_b16 v[146:147], v169 offset:51712
    ds_read_b128 v[88:91], v165 offset:36864
    ds_read_b128 v[92:95], v165 offset:38912
    ds_read_b128 v[96:99], v165 offset:40960
    ds_read_b128 v[100:103], v165 offset:43008
    ds_read_b128 v[104:107], v165 offset:34816
    v_mfma_f32_16x16x32_bf16 v[16:19], v[148:151], v[112:115], v[16:19]
    v_mfma_f32_16x16x32_bf16 v[20:23], v[148:151], v[116:119], v[20:23]
    v_mfma_f32_16x16x32_bf16 v[24:27], v[148:151], v[120:123], v[24:27]
    v_mfma_f32_16x16x32_bf16 v[28:31], v[148:151], v[124:127], v[28:31]
    v_mfma_f32_16x16x32_bf16 v[76:79], v[148:151], v[160:163], v[76:79]
    v_mfma_f32_16x16x32_bf16 v[36:39], v[152:155], v[112:115], v[36:39]
    v_mfma_f32_16x16x32_bf16 v[40:43], v[152:155], v[116:119], v[40:43]
    v_mfma_f32_16x16x32_bf16 v[44:47], v[152:155], v[120:123], v[44:47]
    v_mfma_f32_16x16x32_bf16 v[48:51], v[152:155], v[124:127], v[48:51]
    v_mfma_f32_16x16x32_bf16 v[52:55], v[152:155], v[128:131], v[52:55]
    v_mfma_f32_16x16x32_bf16 v[80:83], v[152:155], v[160:163], v[80:83]
    v_mfma_f32_16x16x32_bf16 v[56:59], v[156:159], v[112:115], v[56:59]
    v_mfma_f32_16x16x32_bf16 v[60:63], v[156:159], v[116:119], v[60:63]
    v_mfma_f32_16x16x32_bf16 v[64:67], v[156:159], v[120:123], v[64:67]
    v_mfma_f32_16x16x32_bf16 v[68:71], v[156:159], v[124:127], v[68:71]
    v_mfma_f32_16x16x32_bf16 v[72:75], v[156:159], v[128:131], v[72:75]
    v_mfma_f32_16x16x32_bf16 v[84:87], v[156:159], v[160:163], v[84:87]
    s_waitcnt lgkmcnt(0)
    ds_read_b64_tr_b16 v[148:149], v169 offset:38912
    ds_read_b64_tr_b16 v[150:151], v169 offset:39424
    ds_read_b64_tr_b16 v[152:153], v169 offset:47104
    ds_read_b64_tr_b16 v[154:155], v169 offset:47616
    ds_read_b64_tr_b16 v[156:157], v169 offset:55296
    ds_read_b64_tr_b16 v[158:159], v169 offset:55808
    ds_read_b128 v[112:115], v166 offset:36864
    ds_read_b128 v[116:119], v166 offset:38912
    ds_read_b128 v[120:123], v166 offset:40960
    ds_read_b128 v[124:127], v166 offset:43008
    ds_read_b128 v[128:131], v166 offset:34816
    v_mfma_f32_16x16x32_bf16 v[16:19], v[136:139], v[88:91], v[16:19]
    v_mfma_f32_16x16x32_bf16 v[20:23], v[136:139], v[92:95], v[20:23]
    v_mfma_f32_16x16x32_bf16 v[24:27], v[136:139], v[96:99], v[24:27]
    v_mfma_f32_16x16x32_bf16 v[28:31], v[136:139], v[100:103], v[28:31]
    v_mfma_f32_16x16x32_bf16 v[76:79], v[136:139], v[160:163], v[76:79]
    v_mfma_f32_16x16x32_bf16 v[36:39], v[140:143], v[88:91], v[36:39]
    v_mfma_f32_16x16x32_bf16 v[40:43], v[140:143], v[92:95], v[40:43]
    v_mfma_f32_16x16x32_bf16 v[44:47], v[140:143], v[96:99], v[44:47]
    v_mfma_f32_16x16x32_bf16 v[48:51], v[140:143], v[100:103], v[48:51]
    v_mfma_f32_16x16x32_bf16 v[52:55], v[140:143], v[104:107], v[52:55]
    v_mfma_f32_16x16x32_bf16 v[80:83], v[140:143], v[160:163], v[80:83]
    v_mfma_f32_16x16x32_bf16 v[56:59], v[144:147], v[88:91], v[56:59]
    v_mfma_f32_16x16x32_bf16 v[60:63], v[144:147], v[92:95], v[60:63]
    v_mfma_f32_16x16x32_bf16 v[64:67], v[144:147], v[96:99], v[64:67]
    v_mfma_f32_16x16x32_bf16 v[68:71], v[144:147], v[100:103], v[68:71]
    v_mfma_f32_16x16x32_bf16 v[72:75], v[144:147], v[104:107], v[72:75]
    v_mfma_f32_16x16x32_bf16 v[84:87], v[144:147], v[160:163], v[84:87]
    s_waitcnt lgkmcnt(0)
    s_barrier
    ds_read_b64_tr_b16 v[136:137], v164 offset:0
    ds_read_b64_tr_b16 v[138:139], v164 offset:512
    ds_read_b64_tr_b16 v[140:141], v164 offset:8192
    ds_read_b64_tr_b16 v[142:143], v164 offset:8704
    ds_read_b64_tr_b16 v[144:145], v164 offset:16384
    ds_read_b64_tr_b16 v[146:147], v164 offset:16896
    ds_read_b128 v[88:91], v6 offset:2048
    ds_read_b128 v[92:95], v6 offset:4096
    ds_read_b128 v[96:99], v6 offset:6144
    ds_read_b128 v[100:103], v6 offset:8192
    ds_read_b128 v[104:107], v6 offset:0
    v_mfma_f32_16x16x32_bf16 v[16:19], v[148:151], v[112:115], v[16:19]
    v_mfma_f32_16x16x32_bf16 v[20:23], v[148:151], v[116:119], v[20:23]
    v_mfma_f32_16x16x32_bf16 v[24:27], v[148:151], v[120:123], v[24:27]
    v_mfma_f32_16x16x32_bf16 v[28:31], v[148:151], v[124:127], v[28:31]
    v_mfma_f32_16x16x32_bf16 v[76:79], v[148:151], v[160:163], v[76:79]
    v_mfma_f32_16x16x32_bf16 v[36:39], v[152:155], v[112:115], v[36:39]
    v_mfma_f32_16x16x32_bf16 v[40:43], v[152:155], v[116:119], v[40:43]
    v_mfma_f32_16x16x32_bf16 v[44:47], v[152:155], v[120:123], v[44:47]
    v_mfma_f32_16x16x32_bf16 v[48:51], v[152:155], v[124:127], v[48:51]
    v_mfma_f32_16x16x32_bf16 v[52:55], v[152:155], v[128:131], v[52:55]
    v_mfma_f32_16x16x32_bf16 v[80:83], v[152:155], v[160:163], v[80:83]
    v_mfma_f32_16x16x32_bf16 v[56:59], v[156:159], v[112:115], v[56:59]
    v_mfma_f32_16x16x32_bf16 v[60:63], v[156:159], v[116:119], v[60:63]
    v_mfma_f32_16x16x32_bf16 v[64:67], v[156:159], v[120:123], v[64:67]
    v_mfma_f32_16x16x32_bf16 v[68:71], v[156:159], v[124:127], v[68:71]
    v_mfma_f32_16x16x32_bf16 v[72:75], v[156:159], v[128:131], v[72:75]
    v_mfma_f32_16x16x32_bf16 v[84:87], v[156:159], v[160:163], v[84:87]
    s_waitcnt lgkmcnt(0)
    ds_read_b64_tr_b16 v[148:149], v164 offset:4096
    ds_read_b64_tr_b16 v[150:151], v164 offset:4608
    ds_read_b64_tr_b16 v[152:153], v164 offset:12288
    ds_read_b64_tr_b16 v[154:155], v164 offset:12800
    ds_read_b64_tr_b16 v[156:157], v164 offset:20480
    ds_read_b64_tr_b16 v[158:159], v164 offset:20992
    ds_read_b128 v[112:115], v7 offset:2048
    ds_read_b128 v[116:119], v7 offset:4096
    ds_read_b128 v[120:123], v7 offset:6144
    ds_read_b128 v[124:127], v7 offset:8192
    ds_read_b128 v[128:131], v7 offset:0
    v_mfma_f32_16x16x32_bf16 v[16:19], v[136:139], v[88:91], v[16:19]
    v_mfma_f32_16x16x32_bf16 v[20:23], v[136:139], v[92:95], v[20:23]
    v_mfma_f32_16x16x32_bf16 v[24:27], v[136:139], v[96:99], v[24:27]
    v_mfma_f32_16x16x32_bf16 v[28:31], v[136:139], v[100:103], v[28:31]
    v_mfma_f32_16x16x32_bf16 v[76:79], v[136:139], v[160:163], v[76:79]
    v_mfma_f32_16x16x32_bf16 v[36:39], v[140:143], v[88:91], v[36:39]
    v_mfma_f32_16x16x32_bf16 v[40:43], v[140:143], v[92:95], v[40:43]
    v_mfma_f32_16x16x32_bf16 v[44:47], v[140:143], v[96:99], v[44:47]
    v_mfma_f32_16x16x32_bf16 v[48:51], v[140:143], v[100:103], v[48:51]
    v_mfma_f32_16x16x32_bf16 v[52:55], v[140:143], v[104:107], v[52:55]
    v_mfma_f32_16x16x32_bf16 v[80:83], v[140:143], v[160:163], v[80:83]
    v_mfma_f32_16x16x32_bf16 v[56:59], v[144:147], v[88:91], v[56:59]
    v_mfma_f32_16x16x32_bf16 v[60:63], v[144:147], v[92:95], v[60:63]
    v_mfma_f32_16x16x32_bf16 v[64:67], v[144:147], v[96:99], v[64:67]
    v_mfma_f32_16x16x32_bf16 v[68:71], v[144:147], v[100:103], v[68:71]
    v_mfma_f32_16x16x32_bf16 v[72:75], v[144:147], v[104:107], v[72:75]
    v_mfma_f32_16x16x32_bf16 v[84:87], v[144:147], v[160:163], v[84:87]
    s_waitcnt lgkmcnt(0)
    s_barrier
    ds_read_b64_tr_b16 v[136:137], v164 offset:34816
    ds_read_b64_tr_b16 v[138:139], v164 offset:35328
    ds_read_b64_tr_b16 v[140:141], v164 offset:43008
    ds_read_b64_tr_b16 v[142:143], v164 offset:43520
    ds_read_b64_tr_b16 v[144:145], v164 offset:51200
    ds_read_b64_tr_b16 v[146:147], v164 offset:51712
    ds_read_b128 v[88:91], v6 offset:36864
    ds_read_b128 v[92:95], v6 offset:38912
    ds_read_b128 v[96:99], v6 offset:40960
    ds_read_b128 v[100:103], v6 offset:43008
    ds_read_b128 v[104:107], v6 offset:34816
    v_mfma_f32_16x16x32_bf16 v[16:19], v[148:151], v[112:115], v[16:19]
    v_mfma_f32_16x16x32_bf16 v[20:23], v[148:151], v[116:119], v[20:23]
    v_mfma_f32_16x16x32_bf16 v[24:27], v[148:151], v[120:123], v[24:27]
    v_mfma_f32_16x16x32_bf16 v[28:31], v[148:151], v[124:127], v[28:31]
    v_mfma_f32_16x16x32_bf16 v[76:79], v[148:151], v[160:163], v[76:79]
    v_mfma_f32_16x16x32_bf16 v[36:39], v[152:155], v[112:115], v[36:39]
    v_mfma_f32_16x16x32_bf16 v[40:43], v[152:155], v[116:119], v[40:43]
    v_mfma_f32_16x16x32_bf16 v[44:47], v[152:155], v[120:123], v[44:47]
    v_mfma_f32_16x16x32_bf16 v[48:51], v[152:155], v[124:127], v[48:51]
    v_mfma_f32_16x16x32_bf16 v[52:55], v[152:155], v[128:131], v[52:55]
    v_mfma_f32_16x16x32_bf16 v[80:83], v[152:155], v[160:163], v[80:83]
    v_mfma_f32_16x16x32_bf16 v[56:59], v[156:159], v[112:115], v[56:59]
    v_mfma_f32_16x16x32_bf16 v[60:63], v[156:159], v[116:119], v[60:63]
    v_mfma_f32_16x16x32_bf16 v[64:67], v[156:159], v[120:123], v[64:67]
    v_mfma_f32_16x16x32_bf16 v[68:71], v[156:159], v[124:127], v[68:71]
    v_mfma_f32_16x16x32_bf16 v[72:75], v[156:159], v[128:131], v[72:75]
    v_mfma_f32_16x16x32_bf16 v[84:87], v[156:159], v[160:163], v[84:87]
    s_waitcnt lgkmcnt(0)
    ds_read_b64_tr_b16 v[148:149], v164 offset:38912
    ds_read_b64_tr_b16 v[150:151], v164 offset:39424
    ds_read_b64_tr_b16 v[152:153], v164 offset:47104
    ds_read_b64_tr_b16 v[154:155], v164 offset:47616
    ds_read_b64_tr_b16 v[156:157], v164 offset:55296
    ds_read_b64_tr_b16 v[158:159], v164 offset:55808
    ds_read_b128 v[112:115], v7 offset:36864
    ds_read_b128 v[116:119], v7 offset:38912
    ds_read_b128 v[120:123], v7 offset:40960
    ds_read_b128 v[124:127], v7 offset:43008
    ds_read_b128 v[128:131], v7 offset:34816
    v_mfma_f32_16x16x32_bf16 v[16:19], v[136:139], v[88:91], v[16:19]
    v_mfma_f32_16x16x32_bf16 v[20:23], v[136:139], v[92:95], v[20:23]
    v_mfma_f32_16x16x32_bf16 v[24:27], v[136:139], v[96:99], v[24:27]
    v_mfma_f32_16x16x32_bf16 v[28:31], v[136:139], v[100:103], v[28:31]
    v_mfma_f32_16x16x32_bf16 v[76:79], v[136:139], v[160:163], v[76:79]
    v_mfma_f32_16x16x32_bf16 v[36:39], v[140:143], v[88:91], v[36:39]
    v_mfma_f32_16x16x32_bf16 v[40:43], v[140:143], v[92:95], v[40:43]
    v_mfma_f32_16x16x32_bf16 v[44:47], v[140:143], v[96:99], v[44:47]
    v_mfma_f32_16x16x32_bf16 v[48:51], v[140:143], v[100:103], v[48:51]
    v_mfma_f32_16x16x32_bf16 v[52:55], v[140:143], v[104:107], v[52:55]
    v_mfma_f32_16x16x32_bf16 v[80:83], v[140:143], v[160:163], v[80:83]
    v_mfma_f32_16x16x32_bf16 v[56:59], v[144:147], v[88:91], v[56:59]
    v_mfma_f32_16x16x32_bf16 v[60:63], v[144:147], v[92:95], v[60:63]
    v_mfma_f32_16x16x32_bf16 v[64:67], v[144:147], v[96:99], v[64:67]
    v_mfma_f32_16x16x32_bf16 v[68:71], v[144:147], v[100:103], v[68:71]
    v_mfma_f32_16x16x32_bf16 v[72:75], v[144:147], v[104:107], v[72:75]
    v_mfma_f32_16x16x32_bf16 v[84:87], v[144:147], v[160:163], v[84:87]
    s_waitcnt lgkmcnt(0)
    s_barrier
    ds_read_b64_tr_b16 v[136:137], v169 offset:0
    ds_read_b64_tr_b16 v[138:139], v169 offset:512
    ds_read_b64_tr_b16 v[140:141], v169 offset:8192
    ds_read_b64_tr_b16 v[142:143], v169 offset:8704
    ds_read_b64_tr_b16 v[144:145], v169 offset:16384
    ds_read_b64_tr_b16 v[146:147], v169 offset:16896
    ds_read_b128 v[88:91], v165 offset:2048
    ds_read_b128 v[92:95], v165 offset:4096
    ds_read_b128 v[96:99], v165 offset:6144
    ds_read_b128 v[100:103], v165 offset:8192
    ds_read_b128 v[104:107], v165 offset:0
    v_mfma_f32_16x16x32_bf16 v[16:19], v[148:151], v[112:115], v[16:19]
    v_mfma_f32_16x16x32_bf16 v[20:23], v[148:151], v[116:119], v[20:23]
    v_mfma_f32_16x16x32_bf16 v[24:27], v[148:151], v[120:123], v[24:27]
    v_mfma_f32_16x16x32_bf16 v[28:31], v[148:151], v[124:127], v[28:31]
    v_mfma_f32_16x16x32_bf16 v[76:79], v[148:151], v[160:163], v[76:79]
    v_mfma_f32_16x16x32_bf16 v[36:39], v[152:155], v[112:115], v[36:39]
    v_mfma_f32_16x16x32_bf16 v[40:43], v[152:155], v[116:119], v[40:43]
    v_mfma_f32_16x16x32_bf16 v[44:47], v[152:155], v[120:123], v[44:47]
    v_mfma_f32_16x16x32_bf16 v[48:51], v[152:155], v[124:127], v[48:51]
    v_mfma_f32_16x16x32_bf16 v[52:55], v[152:155], v[128:131], v[52:55]
    v_mfma_f32_16x16x32_bf16 v[80:83], v[152:155], v[160:163], v[80:83]
    v_mfma_f32_16x16x32_bf16 v[56:59], v[156:159], v[112:115], v[56:59]
    v_mfma_f32_16x16x32_bf16 v[60:63], v[156:159], v[116:119], v[60:63]
    v_mfma_f32_16x16x32_bf16 v[64:67], v[156:159], v[120:123], v[64:67]
    v_mfma_f32_16x16x32_bf16 v[68:71], v[156:159], v[124:127], v[68:71]
    v_mfma_f32_16x16x32_bf16 v[72:75], v[156:159], v[128:131], v[72:75]
    v_mfma_f32_16x16x32_bf16 v[84:87], v[156:159], v[160:163], v[84:87]
    s_waitcnt lgkmcnt(0)
    ds_read_b64_tr_b16 v[148:149], v169 offset:4096
    ds_read_b64_tr_b16 v[150:151], v169 offset:4608
    ds_read_b64_tr_b16 v[152:153], v169 offset:12288
    ds_read_b64_tr_b16 v[154:155], v169 offset:12800
    ds_read_b64_tr_b16 v[156:157], v169 offset:20480
    ds_read_b64_tr_b16 v[158:159], v169 offset:20992
    ds_read_b128 v[112:115], v166 offset:2048
    ds_read_b128 v[116:119], v166 offset:4096
    ds_read_b128 v[120:123], v166 offset:6144
    ds_read_b128 v[124:127], v166 offset:8192
    ds_read_b128 v[128:131], v166 offset:0
    v_mfma_f32_16x16x32_bf16 v[16:19], v[136:139], v[88:91], v[16:19]
    v_mfma_f32_16x16x32_bf16 v[20:23], v[136:139], v[92:95], v[20:23]
    v_mfma_f32_16x16x32_bf16 v[24:27], v[136:139], v[96:99], v[24:27]
    v_mfma_f32_16x16x32_bf16 v[28:31], v[136:139], v[100:103], v[28:31]
    v_mfma_f32_16x16x32_bf16 v[76:79], v[136:139], v[160:163], v[76:79]
    v_mfma_f32_16x16x32_bf16 v[36:39], v[140:143], v[88:91], v[36:39]
    v_mfma_f32_16x16x32_bf16 v[40:43], v[140:143], v[92:95], v[40:43]
    v_mfma_f32_16x16x32_bf16 v[44:47], v[140:143], v[96:99], v[44:47]
    v_mfma_f32_16x16x32_bf16 v[48:51], v[140:143], v[100:103], v[48:51]
    v_mfma_f32_16x16x32_bf16 v[52:55], v[140:143], v[104:107], v[52:55]
    v_mfma_f32_16x16x32_bf16 v[80:83], v[140:143], v[160:163], v[80:83]
    v_mfma_f32_16x16x32_bf16 v[56:59], v[144:147], v[88:91], v[56:59]
    v_mfma_f32_16x16x32_bf16 v[60:63], v[144:147], v[92:95], v[60:63]
    v_mfma_f32_16x16x32_bf16 v[64:67], v[144:147], v[96:99], v[64:67]
    v_mfma_f32_16x16x32_bf16 v[68:71], v[144:147], v[100:103], v[68:71]
    v_mfma_f32_16x16x32_bf16 v[72:75], v[144:147], v[104:107], v[72:75]
    v_mfma_f32_16x16x32_bf16 v[84:87], v[144:147], v[160:163], v[84:87]
    s_waitcnt lgkmcnt(0)
    s_barrier
    ds_read_b64_tr_b16 v[136:137], v169 offset:34816
    ds_read_b64_tr_b16 v[138:139], v169 offset:35328
    ds_read_b64_tr_b16 v[140:141], v169 offset:43008
    ds_read_b64_tr_b16 v[142:143], v169 offset:43520
    ds_read_b64_tr_b16 v[144:145], v169 offset:51200
    ds_read_b64_tr_b16 v[146:147], v169 offset:51712
    ds_read_b128 v[88:91], v165 offset:36864
    ds_read_b128 v[92:95], v165 offset:38912
    ds_read_b128 v[96:99], v165 offset:40960
    ds_read_b128 v[100:103], v165 offset:43008
    ds_read_b128 v[104:107], v165 offset:34816
    v_mfma_f32_16x16x32_bf16 v[16:19], v[148:151], v[112:115], v[16:19]
    v_mfma_f32_16x16x32_bf16 v[20:23], v[148:151], v[116:119], v[20:23]
    v_mfma_f32_16x16x32_bf16 v[24:27], v[148:151], v[120:123], v[24:27]
    v_mfma_f32_16x16x32_bf16 v[28:31], v[148:151], v[124:127], v[28:31]
    v_mfma_f32_16x16x32_bf16 v[76:79], v[148:151], v[160:163], v[76:79]
    v_mfma_f32_16x16x32_bf16 v[36:39], v[152:155], v[112:115], v[36:39]
    v_mfma_f32_16x16x32_bf16 v[40:43], v[152:155], v[116:119], v[40:43]
    v_mfma_f32_16x16x32_bf16 v[44:47], v[152:155], v[120:123], v[44:47]
    v_mfma_f32_16x16x32_bf16 v[48:51], v[152:155], v[124:127], v[48:51]
    v_mfma_f32_16x16x32_bf16 v[52:55], v[152:155], v[128:131], v[52:55]
    v_mfma_f32_16x16x32_bf16 v[80:83], v[152:155], v[160:163], v[80:83]
    v_mfma_f32_16x16x32_bf16 v[56:59], v[156:159], v[112:115], v[56:59]
    v_mfma_f32_16x16x32_bf16 v[60:63], v[156:159], v[116:119], v[60:63]
    v_mfma_f32_16x16x32_bf16 v[64:67], v[156:159], v[120:123], v[64:67]
    v_mfma_f32_16x16x32_bf16 v[68:71], v[156:159], v[124:127], v[68:71]
    v_mfma_f32_16x16x32_bf16 v[72:75], v[156:159], v[128:131], v[72:75]
    v_mfma_f32_16x16x32_bf16 v[84:87], v[156:159], v[160:163], v[84:87]
    s_waitcnt lgkmcnt(0)
    ds_read_b64_tr_b16 v[148:149], v169 offset:38912
    ds_read_b64_tr_b16 v[150:151], v169 offset:39424
    ds_read_b64_tr_b16 v[152:153], v169 offset:47104
    ds_read_b64_tr_b16 v[154:155], v169 offset:47616
    ds_read_b64_tr_b16 v[156:157], v169 offset:55296
    ds_read_b64_tr_b16 v[158:159], v169 offset:55808
    ds_read_b128 v[112:115], v166 offset:36864
    ds_read_b128 v[116:119], v166 offset:38912
    ds_read_b128 v[120:123], v166 offset:40960
    ds_read_b128 v[124:127], v166 offset:43008
    ds_read_b128 v[128:131], v166 offset:34816
    v_mfma_f32_16x16x32_bf16 v[16:19], v[136:139], v[88:91], v[16:19]
    v_mfma_f32_16x16x32_bf16 v[20:23], v[136:139], v[92:95], v[20:23]
    v_mfma_f32_16x16x32_bf16 v[24:27], v[136:139], v[96:99], v[24:27]
    v_mfma_f32_16x16x32_bf16 v[28:31], v[136:139], v[100:103], v[28:31]
    v_mfma_f32_16x16x32_bf16 v[76:79], v[136:139], v[160:163], v[76:79]
    v_mfma_f32_16x16x32_bf16 v[36:39], v[140:143], v[88:91], v[36:39]
    v_mfma_f32_16x16x32_bf16 v[40:43], v[140:143], v[92:95], v[40:43]
    v_mfma_f32_16x16x32_bf16 v[44:47], v[140:143], v[96:99], v[44:47]
    v_mfma_f32_16x16x32_bf16 v[48:51], v[140:143], v[100:103], v[48:51]
    v_mfma_f32_16x16x32_bf16 v[52:55], v[140:143], v[104:107], v[52:55]
    v_mfma_f32_16x16x32_bf16 v[80:83], v[140:143], v[160:163], v[80:83]
    v_mfma_f32_16x16x32_bf16 v[56:59], v[144:147], v[88:91], v[56:59]
    v_mfma_f32_16x16x32_bf16 v[60:63], v[144:147], v[92:95], v[60:63]
    v_mfma_f32_16x16x32_bf16 v[64:67], v[144:147], v[96:99], v[64:67]
    v_mfma_f32_16x16x32_bf16 v[68:71], v[144:147], v[100:103], v[68:71]
    v_mfma_f32_16x16x32_bf16 v[72:75], v[144:147], v[104:107], v[72:75]
    v_mfma_f32_16x16x32_bf16 v[84:87], v[144:147], v[160:163], v[84:87]
    s_waitcnt lgkmcnt(0)
    v_mfma_f32_16x16x32_bf16 v[16:19], v[148:151], v[112:115], v[16:19]
    v_mfma_f32_16x16x32_bf16 v[20:23], v[148:151], v[116:119], v[20:23]
    v_mfma_f32_16x16x32_bf16 v[24:27], v[148:151], v[120:123], v[24:27]
    v_mfma_f32_16x16x32_bf16 v[28:31], v[148:151], v[124:127], v[28:31]
    v_mfma_f32_16x16x32_bf16 v[76:79], v[148:151], v[160:163], v[76:79]
    v_mfma_f32_16x16x32_bf16 v[36:39], v[152:155], v[112:115], v[36:39]
    v_mfma_f32_16x16x32_bf16 v[40:43], v[152:155], v[116:119], v[40:43]
    v_mfma_f32_16x16x32_bf16 v[44:47], v[152:155], v[120:123], v[44:47]
    v_mfma_f32_16x16x32_bf16 v[48:51], v[152:155], v[124:127], v[48:51]
    v_mfma_f32_16x16x32_bf16 v[52:55], v[152:155], v[128:131], v[52:55]
    v_mfma_f32_16x16x32_bf16 v[80:83], v[152:155], v[160:163], v[80:83]
    v_mfma_f32_16x16x32_bf16 v[56:59], v[156:159], v[112:115], v[56:59]
    v_mfma_f32_16x16x32_bf16 v[60:63], v[156:159], v[116:119], v[60:63]
    v_mfma_f32_16x16x32_bf16 v[64:67], v[156:159], v[120:123], v[64:67]
    v_mfma_f32_16x16x32_bf16 v[68:71], v[156:159], v[124:127], v[68:71]
    v_mfma_f32_16x16x32_bf16 v[72:75], v[156:159], v[128:131], v[72:75]
    v_mfma_f32_16x16x32_bf16 v[84:87], v[156:159], v[160:163], v[84:87]
    s_mov_b32 s52, 0xffff0000
    s_mov_b32 s53, 0x3b000000
    s_mov_b32 s54, 0x3727c5ac
    v_lshlrev_b32 v13, 3, v10
    s_barrier
    ds_read_b64 v[90:91], v13 offset:0
    ds_read_b64 v[92:93], v13 offset:128
    ds_read_b64 v[94:95], v13 offset:256
    ds_read_b64 v[96:97], v13 offset:384
    ds_read_b64 v[98:99], v13 offset:512
    v_mul_u32_u24 v14, 112, v10
    v_lshl_add_u32 v14, v12, 3, v14
    s_mul_i32 s34, s30, 8960
    v_add_u32 v14, s34, v14
    s_waitcnt lgkmcnt(0)
    v_pk_fma_f32 v[16:17], v[90:91], v[76:77], v[16:17] op_sel_hi:[0,1,1] neg_lo:[1,0,0] neg_hi:[1,0,0]
    v_pk_fma_f32 v[18:19], v[90:91], v[78:79], v[18:19] op_sel_hi:[0,1,1] neg_lo:[1,0,0] neg_hi:[1,0,0]
    v_pk_mul_f32 v[16:17], v[16:17], v[90:91] op_sel:[0,1] op_sel_hi:[1,1]
    v_pk_mul_f32 v[18:19], v[18:19], v[90:91] op_sel:[0,1] op_sel_hi:[1,1]
    v_cvt_pk_bf16_f32 v16, v16, v17
    v_cvt_pk_bf16_f32 v17, v18, v19
    ds_write_b64 v14, v[16:17] offset:2816
    v_pk_fma_f32 v[20:21], v[92:93], v[76:77], v[20:21] op_sel_hi:[0,1,1] neg_lo:[1,0,0] neg_hi:[1,0,0]
    v_pk_fma_f32 v[22:23], v[92:93], v[78:79], v[22:23] op_sel_hi:[0,1,1] neg_lo:[1,0,0] neg_hi:[1,0,0]
    v_pk_mul_f32 v[20:21], v[20:21], v[92:93] op_sel:[0,1] op_sel_hi:[1,1]
    v_pk_mul_f32 v[22:23], v[22:23], v[92:93] op_sel:[0,1] op_sel_hi:[1,1]
    v_cvt_pk_bf16_f32 v20, v20, v21
    v_cvt_pk_bf16_f32 v21, v22, v23
    ds_write_b64 v14, v[20:21] offset:4608
    v_pk_fma_f32 v[24:25], v[94:95], v[76:77], v[24:25] op_sel_hi:[0,1,1] neg_lo:[1,0,0] neg_hi:[1,0,0]
    v_pk_fma_f32 v[26:27], v[94:95], v[78:79], v[26:27] op_sel_hi:[0,1,1] neg_lo:[1,0,0] neg_hi:[1,0,0]
    v_pk_mul_f32 v[24:25], v[24:25], v[94:95] op_sel:[0,1] op_sel_hi:[1,1]
    v_pk_mul_f32 v[26:27], v[26:27], v[94:95] op_sel:[0,1] op_sel_hi:[1,1]
    v_cvt_pk_bf16_f32 v24, v24, v25
    v_cvt_pk_bf16_f32 v25, v26, v27
    ds_write_b64 v14, v[24:25] offset:6400
    v_pk_fma_f32 v[28:29], v[96:97], v[76:77], v[28:29] op_sel_hi:[0,1,1] neg_lo:[1,0,0] neg_hi:[1,0,0]
    v_pk_fma_f32 v[30:31], v[96:97], v[78:79], v[30:31] op_sel_hi:[0,1,1] neg_lo:[1,0,0] neg_hi:[1,0,0]
    v_pk_mul_f32 v[28:29], v[28:29], v[96:97] op_sel:[0,1] op_sel_hi:[1,1]
    v_pk_mul_f32 v[30:31], v[30:31], v[96:97] op_sel:[0,1] op_sel_hi:[1,1]
    v_cvt_pk_bf16_f32 v28, v28, v29
    v_cvt_pk_bf16_f32 v29, v30, v31
    ds_write_b64 v14, v[28:29] offset:8192
    v_pk_fma_f32 v[36:37], v[90:91], v[80:81], v[36:37] op_sel_hi:[0,1,1] neg_lo:[1,0,0] neg_hi:[1,0,0]
    v_pk_fma_f32 v[38:39], v[90:91], v[82:83], v[38:39] op_sel_hi:[0,1,1] neg_lo:[1,0,0] neg_hi:[1,0,0]
    v_pk_mul_f32 v[36:37], v[36:37], v[90:91] op_sel:[0,1] op_sel_hi:[1,1]
    v_pk_mul_f32 v[38:39], v[38:39], v[90:91] op_sel:[0,1] op_sel_hi:[1,1]
    v_cvt_pk_bf16_f32 v36, v36, v37
    v_cvt_pk_bf16_f32 v37, v38, v39
    ds_write_b64 v14, v[36:37] offset:2848
    v_pk_fma_f32 v[40:41], v[92:93], v[80:81], v[40:41] op_sel_hi:[0,1,1] neg_lo:[1,0,0] neg_hi:[1,0,0]
    v_pk_fma_f32 v[42:43], v[92:93], v[82:83], v[42:43] op_sel_hi:[0,1,1] neg_lo:[1,0,0] neg_hi:[1,0,0]
    v_pk_mul_f32 v[40:41], v[40:41], v[92:93] op_sel:[0,1] op_sel_hi:[1,1]
    v_pk_mul_f32 v[42:43], v[42:43], v[92:93] op_sel:[0,1] op_sel_hi:[1,1]
    v_cvt_pk_bf16_f32 v40, v40, v41
    v_cvt_pk_bf16_f32 v41, v42, v43
    ds_write_b64 v14, v[40:41] offset:4640
    v_pk_fma_f32 v[44:45], v[94:95], v[80:81], v[44:45] op_sel_hi:[0,1,1] neg_lo:[1,0,0] neg_hi:[1,0,0]
    v_pk_fma_f32 v[46:47], v[94:95], v[82:83], v[46:47] op_sel_hi:[0,1,1] neg_lo:[1,0,0] neg_hi:[1,0,0]
    v_pk_mul_f32 v[44:45], v[44:45], v[94:95] op_sel:[0,1] op_sel_hi:[1,1]
    v_pk_mul_f32 v[46:47], v[46:47], v[94:95] op_sel:[0,1] op_sel_hi:[1,1]
    v_cvt_pk_bf16_f32 v44, v44, v45
    v_cvt_pk_bf16_f32 v45, v46, v47
    ds_write_b64 v14, v[44:45] offset:6432
    v_pk_fma_f32 v[48:49], v[96:97], v[80:81], v[48:49] op_sel_hi:[0,1,1] neg_lo:[1,0,0] neg_hi:[1,0,0]
    v_pk_fma_f32 v[50:51], v[96:97], v[82:83], v[50:51] op_sel_hi:[0,1,1] neg_lo:[1,0,0] neg_hi:[1,0,0]
    v_pk_mul_f32 v[48:49], v[48:49], v[96:97] op_sel:[0,1] op_sel_hi:[1,1]
    v_pk_mul_f32 v[50:51], v[50:51], v[96:97] op_sel:[0,1] op_sel_hi:[1,1]
    v_cvt_pk_bf16_f32 v48, v48, v49
    v_cvt_pk_bf16_f32 v49, v50, v51
    ds_write_b64 v14, v[48:49] offset:8224
    v_pk_fma_f32 v[52:53], v[98:99], v[80:81], v[52:53] op_sel_hi:[0,1,1] neg_lo:[1,0,0] neg_hi:[1,0,0]
    v_pk_fma_f32 v[54:55], v[98:99], v[82:83], v[54:55] op_sel_hi:[0,1,1] neg_lo:[1,0,0] neg_hi:[1,0,0]
    v_pk_mul_f32 v[52:53], v[52:53], v[98:99] op_sel:[0,1] op_sel_hi:[1,1]
    v_pk_mul_f32 v[54:55], v[54:55], v[98:99] op_sel:[0,1] op_sel_hi:[1,1]
    v_cvt_pk_bf16_f32 v52, v52, v53
    v_cvt_pk_bf16_f32 v53, v54, v55
    ds_write_b64 v14, v[52:53] offset:1056
    v_pk_fma_f32 v[56:57], v[90:91], v[84:85], v[56:57] op_sel_hi:[0,1,1] neg_lo:[1,0,0] neg_hi:[1,0,0]
    v_pk_fma_f32 v[58:59], v[90:91], v[86:87], v[58:59] op_sel_hi:[0,1,1] neg_lo:[1,0,0] neg_hi:[1,0,0]
    v_pk_mul_f32 v[56:57], v[56:57], v[90:91] op_sel:[0,1] op_sel_hi:[1,1]
    v_pk_mul_f32 v[58:59], v[58:59], v[90:91] op_sel:[0,1] op_sel_hi:[1,1]
    v_cvt_pk_bf16_f32 v56, v56, v57
    v_cvt_pk_bf16_f32 v57, v58, v59
    ds_write_b64 v14, v[56:57] offset:2880
    v_pk_fma_f32 v[60:61], v[92:93], v[84:85], v[60:61] op_sel_hi:[0,1,1] neg_lo:[1,0,0] neg_hi:[1,0,0]
    v_pk_fma_f32 v[62:63], v[92:93], v[86:87], v[62:63] op_sel_hi:[0,1,1] neg_lo:[1,0,0] neg_hi:[1,0,0]
    v_pk_mul_f32 v[60:61], v[60:61], v[92:93] op_sel:[0,1] op_sel_hi:[1,1]
    v_pk_mul_f32 v[62:63], v[62:63], v[92:93] op_sel:[0,1] op_sel_hi:[1,1]
    v_cvt_pk_bf16_f32 v60, v60, v61
    v_cvt_pk_bf16_f32 v61, v62, v63
    ds_write_b64 v14, v[60:61] offset:4672
    v_pk_fma_f32 v[64:65], v[94:95], v[84:85], v[64:65] op_sel_hi:[0,1,1] neg_lo:[1,0,0] neg_hi:[1,0,0]
    v_pk_fma_f32 v[66:67], v[94:95], v[86:87], v[66:67] op_sel_hi:[0,1,1] neg_lo:[1,0,0] neg_hi:[1,0,0]
    v_pk_mul_f32 v[64:65], v[64:65], v[94:95] op_sel:[0,1] op_sel_hi:[1,1]
    v_pk_mul_f32 v[66:67], v[66:67], v[94:95] op_sel:[0,1] op_sel_hi:[1,1]
    v_cvt_pk_bf16_f32 v64, v64, v65
    v_cvt_pk_bf16_f32 v65, v66, v67
    ds_write_b64 v14, v[64:65] offset:6464
    v_pk_fma_f32 v[68:69], v[96:97], v[84:85], v[68:69] op_sel_hi:[0,1,1] neg_lo:[1,0,0] neg_hi:[1,0,0]
    v_pk_fma_f32 v[70:71], v[96:97], v[86:87], v[70:71] op_sel_hi:[0,1,1] neg_lo:[1,0,0] neg_hi:[1,0,0]
    v_pk_mul_f32 v[68:69], v[68:69], v[96:97] op_sel:[0,1] op_sel_hi:[1,1]
    v_pk_mul_f32 v[70:71], v[70:71], v[96:97] op_sel:[0,1] op_sel_hi:[1,1]
    v_cvt_pk_bf16_f32 v68, v68, v69
    v_cvt_pk_bf16_f32 v69, v70, v71
    ds_write_b64 v14, v[68:69] offset:8256
    v_pk_fma_f32 v[72:73], v[98:99], v[84:85], v[72:73] op_sel_hi:[0,1,1] neg_lo:[1,0,0] neg_hi:[1,0,0]
    v_pk_fma_f32 v[74:75], v[98:99], v[86:87], v[74:75] op_sel_hi:[0,1,1] neg_lo:[1,0,0] neg_hi:[1,0,0]
    v_pk_mul_f32 v[72:73], v[72:73], v[98:99] op_sel:[0,1] op_sel_hi:[1,1]
    v_pk_mul_f32 v[74:75], v[74:75], v[98:99] op_sel:[0,1] op_sel_hi:[1,1]
    v_cvt_pk_bf16_f32 v72, v72, v73
    v_cvt_pk_bf16_f32 v73, v74, v75
    ds_write_b64 v14, v[72:73] offset:1088
L_k1l2_attn:
    s_waitcnt lgkmcnt(0)
    s_barrier
    s_lshr_b32 s34, s30, 2
    s_lshl_b32 s34, s34, 5
    v_and_b32 v2, 31, v1
    v_add_u32 v2, s34, v2
    v_lshrrev_b32 v8, 5, v1
    v_add_u32 v3, s31, v2
    v_lshlrev_b32 v9, 3, v8
    v_sub_u32 v7, v3, v9
    v_sub_u32 v4, v2, v9
    v_add_u32 v4, 10, v4
    v_mul_u32_u24 v4, 112, v4
    s_and_b32 s36, s30, 3
    s_mul_i32 s34, s36, 8960
    v_add_u32 v4, s34, v4
    v_add_u32 v6, 16, v2
    v_mul_u32_u24 v6, 112, v6
    v_add_u32 v6, s34, v6
    ds_read_b128 v[16:19], v6 offset:1024
    ds_read_b128 v[20:23], v6 offset:1040
    ds_read_b128 v[24:27], v4 offset:1728
    ds_read_b128 v[28:31], v4 offset:1744
    ds_read_b128 v[32:35], v4 offset:1504
    ds_read_b128 v[36:39], v4 offset:1520
    ds_read_b128 v[40:43], v4 offset:1280
    ds_read_b128 v[44:47], v4 offset:1296
    ds_read_b128 v[48:51], v4 offset:1056
    ds_read_b128 v[52:55], v4 offset:1072
    ds_read_b128 v[56:59], v4 offset:1760
    ds_read_b128 v[60:63], v4 offset:1776
    ds_read_b128 v[64:67], v4 offset:1536
    ds_read_b128 v[68:71], v4 offset:1552
    s_waitcnt lgkmcnt(4)
    ds_read_b128 v[72:75], v4 offset:1312
    ds_read_b128 v[76:79], v4 offset:1328
    ds_read_b128 v[80:83], v4 offset:1088
    ds_read_b128 v[84:87], v4 offset:1104
    v_dot2_f32_bf16 v88, v16, v24, 0
    v_dot2_f32_bf16 v89, v16, v32, 0
    v_dot2_f32_bf16 v90, v16, v40, 0
    v_dot2_f32_bf16 v91, v16, v48, 0
    v_dot2_f32_bf16 v88, v17, v25, v88
    v_dot2_f32_bf16 v89, v17, v33, v89
    v_dot2_f32_bf16 v90, v17, v41, v90
    v_dot2_f32_bf16 v91, v17, v49, v91
    v_dot2_f32_bf16 v88, v18, v26, v88
    v_dot2_f32_bf16 v89, v18, v34, v89
    v_dot2_f32_bf16 v90, v18, v42, v90
    v_dot2_f32_bf16 v91, v18, v50, v91
    v_dot2_f32_bf16 v88, v19, v27, v88
    v_dot2_f32_bf16 v89, v19, v35, v89
    v_dot2_f32_bf16 v90, v19, v43, v90
    v_dot2_f32_bf16 v91, v19, v51, v91
    v_dot2_f32_bf16 v88, v20, v28, v88
    v_dot2_f32_bf16 v89, v20, v36, v89
    v_dot2_f32_bf16 v90, v20, v44, v90
    v_dot2_f32_bf16 v91, v20, v52, v91
    v_dot2_f32_bf16 v88, v21, v29, v88
    v_dot2_f32_bf16 v89, v21, v37, v89
    v_dot2_f32_bf16 v90, v21, v45, v90
    v_dot2_f32_bf16 v91, v21, v53, v91
    v_dot2_f32_bf16 v88, v22, v30, v88
    v_dot2_f32_bf16 v89, v22, v38, v89
    v_dot2_f32_bf16 v90, v22, v46, v90
    v_dot2_f32_bf16 v91, v22, v54, v91
    v_dot2_f32_bf16 v88, v23, v31, v88
    v_dot2_f32_bf16 v89, v23, v39, v89
    v_dot2_f32_bf16 v90, v23, v47, v90
    v_dot2_f32_bf16 v91, v23, v55, v91
    s_nop 0
    v_cvt_pk_bf16_f32 v92, v88, v89
    s_nop 0
    v_cvt_pk_bf16_f32 v93, v90, v91
    v_lshlrev_b32 v88, 16, v92
    v_and_b32 v89, s52, v92
    v_lshlrev_b32 v90, 16, v93
    v_and_b32 v91, s52, v93
    v_mov_b32 v94, 0xcf6e6b28
    v_cmp_le_i32 vcc, 0, v7
    s_nop 1
    v_cndmask_b32 v88, v94, v88, vcc
    v_cmp_le_i32 vcc, 2, v7
    s_nop 1
    v_cndmask_b32 v89, v94, v89, vcc
    v_cmp_le_i32 vcc, 4, v7
    s_nop 1
    v_cndmask_b32 v90, v94, v90, vcc
    v_cmp_le_i32 vcc, 6, v7
    s_nop 1
    v_cndmask_b32 v91, v94, v91, vcc
    v_max3_f32 v95, v88, v89, v90
    v_max_f32 v95, v95, v91
    v_mov_b32 v96, v95
    s_nop 1
    v_permlane32_swap_b32 v95, v96
    v_max_f32 v95, v95, v96
    s_mov_b32 s34, 0x3eb8aa3b
    v_sub_f32 v88, v88, v95
    v_sub_f32 v89, v89, v95
    v_sub_f32 v90, v90, v95
    v_sub_f32 v91, v91, v95
    v_mul_f32 v88, s34, v88
    v_mul_f32 v89, s34, v89
    v_mul_f32 v90, s34, v90
    v_mul_f32 v91, s34, v91
    v_exp_f32 v88, v88
    v_exp_f32 v89, v89
    v_exp_f32 v90, v90
    v_exp_f32 v91, v91
    v_add_f32 v95, v88, v89
    v_add_f32 v96, v90, v91
    v_add_f32 v95, v95, v96
    v_mov_b32 v96, v95
    s_nop 1
    v_permlane32_swap_b32 v95, v96
    v_add_f32 v95, v95, v96
    v_rcp_f32 v95, v95
    s_nop 0
    v_mul_f32 v88, v88, v95
    v_mul_f32 v89, v89, v95
    v_mul_f32 v90, v90, v95
    v_mul_f32 v91, v91, v95
    v_cvt_pk_bf16_f32 v92, v88, v89
    v_cvt_pk_bf16_f32 v93, v90, v91
    s_mov_b32 s38, 0x05040100
    s_mov_b32 s37, 0x07060302
    s_waitcnt lgkmcnt(0)
    v_perm_b32 v40, v64, v56, s38
    v_perm_b32 v41, v64, v56, s37
    v_perm_b32 v42, v65, v57, s38
    v_perm_b32 v43, v65, v57, s37
    v_perm_b32 v44, v66, v58, s38
    v_perm_b32 v45, v66, v58, s37
    v_perm_b32 v46, v67, v59, s38
    v_perm_b32 v47, v67, v59, s37
    v_perm_b32 v48, v68, v60, s38
    v_perm_b32 v49, v68, v60, s37
    v_perm_b32 v50, v69, v61, s38
    v_perm_b32 v51, v69, v61, s37
    v_perm_b32 v52, v70, v62, s38
    v_perm_b32 v53, v70, v62, s37
    v_perm_b32 v54, v71, v63, s38
    v_perm_b32 v55, v71, v63, s37
    v_dot2_f32_bf16 v24, v40, v92, 0
    v_dot2_f32_bf16 v25, v41, v92, 0
    v_dot2_f32_bf16 v26, v42, v92, 0
    v_dot2_f32_bf16 v27, v43, v92, 0
    v_dot2_f32_bf16 v28, v44, v92, 0
    v_dot2_f32_bf16 v29, v45, v92, 0
    v_dot2_f32_bf16 v30, v46, v92, 0
    v_dot2_f32_bf16 v31, v47, v92, 0
    v_dot2_f32_bf16 v32, v48, v92, 0
    v_dot2_f32_bf16 v33, v49, v92, 0
    v_dot2_f32_bf16 v34, v50, v92, 0
    v_dot2_f32_bf16 v35, v51, v92, 0
    v_dot2_f32_bf16 v36, v52, v92, 0
    v_dot2_f32_bf16 v37, v53, v92, 0
    v_dot2_f32_bf16 v38, v54, v92, 0
    v_dot2_f32_bf16 v39, v55, v92, 0
    v_perm_b32 v40, v80, v72, s38
    v_perm_b32 v41, v80, v72, s37
    v_perm_b32 v42, v81, v73, s38
    v_perm_b32 v43, v81, v73, s37
    v_perm_b32 v44, v82, v74, s38
    v_perm_b32 v45, v82, v74, s37
    v_perm_b32 v46, v83, v75, s38
    v_perm_b32 v47, v83, v75, s37
    v_perm_b32 v48, v84, v76, s38
    v_perm_b32 v49, v84, v76, s37
    v_perm_b32 v50, v85, v77, s38
    v_perm_b32 v51, v85, v77, s37
    v_perm_b32 v52, v86, v78, s38
    v_perm_b32 v53, v86, v78, s37
    v_perm_b32 v54, v87, v79, s38
    v_perm_b32 v55, v87, v79, s37
    v_dot2_f32_bf16 v24, v40, v93, v24
    v_dot2_f32_bf16 v25, v41, v93, v25
    v_dot2_f32_bf16 v26, v42, v93, v26
    v_dot2_f32_bf16 v27, v43, v93, v27
    v_dot2_f32_bf16 v28, v44, v93, v28
    v_dot2_f32_bf16 v29, v45, v93, v29
    v_dot2_f32_bf16 v30, v46, v93, v30
    v_dot2_f32_bf16 v31, v47, v93, v31
    v_dot2_f32_bf16 v32, v48, v93, v32
    v_dot2_f32_bf16 v33, v49, v93, v33
    v_dot2_f32_bf16 v34, v50, v93, v34
    v_dot2_f32_bf16 v35, v51, v93, v35
    v_dot2_f32_bf16 v36, v52, v93, v36
    v_dot2_f32_bf16 v37, v53, v93, v37
    v_dot2_f32_bf16 v38, v54, v93, v38
    v_dot2_f32_bf16 v39, v55, v93, v39
    v_permlane32_swap_b32 v24, v32
    v_permlane32_swap_b32 v25, v33
    v_permlane32_swap_b32 v26, v34
    v_permlane32_swap_b32 v27, v35
    v_permlane32_swap_b32 v28, v36
    v_permlane32_swap_b32 v29, v37
    v_permlane32_swap_b32 v30, v38
    v_permlane32_swap_b32 v31, v39
    v_add_f32 v24, v24, v32
    v_add_f32 v25, v25, v33
    v_add_f32 v26, v26, v34
    v_add_f32 v27, v27, v35
    v_add_f32 v28, v28, v36
    v_add_f32 v29, v29, v37
    v_add_f32 v30, v30, v38
    v_add_f32 v31, v31, v39
    v_cvt_pk_bf16_f32 v56, v24, v25
    v_cvt_pk_bf16_f32 v57, v26, v27
    v_cvt_pk_bf16_f32 v58, v28, v29
    v_cvt_pk_bf16_f32 v59, v30, v31
    v_lshlrev_b32 v5, 10, v3
    v_lshl_add_u32 v5, v8, 4, v5
    s_lshl_b32 s34, s29, 7
    s_lshl_b32 s36, s36, 5
    s_add_u32 s34, s34, s36
    v_add_u32 v5, s34, v5
    buffer_store_dwordx4 v[56:59], v5, s[20:23], 0 offen
L_k1l2_done:
    s_endpgm
.globl k2l2_kernel
.p2align 8
.type k2l2_kernel,@function
k2l2_kernel:
    s_cmp_ge_u32 s2, 256
    s_cbranch_scc1 L_k2l2_done
    s_load_dwordx2 s[4:5], s[0:1], 80
    s_load_dwordx2 s[6:7], s[0:1], 16
    s_load_dwordx2 s[8:9], s[0:1], 80
    s_load_dwordx2 s[10:11], s[0:1], 32
    s_and_b32 s36, s2, 7
    s_lshr_b32 s37, s2, 3
    s_lshl_b32 s36, s36, 2
    s_lshr_b32 s38, s37, 3
    s_add_u32 s36, s36, s38
    s_and_b32 s37, s37, 7
    s_lshl_b32 s36, s36, 6
    s_lshl_b32 s41, s37, 7
    v_and_b32 v1, 63, v0
    v_lshrrev_b32 v2, 6, v0
    s_nop 0
    v_readfirstlane_b32 s39, v2
    v_lshrrev_b32 v10, 3, v1
    v_and_b32 v11, 7, v1
    v_lshrrev_b32 v61, 4, v1
    s_lshl_b32 s40, s39, 4
    s_add_u32 s40, s40, s36
    s_cmp_lt_u32 s39, 4
    s_cbranch_scc1 L_k2l2_comp
    s_sub_u32 s39, s39, 4
    s_sub_u32 s40, s40, 64
    v_add_u32 v4, s40, v10
    v_lshlrev_b32 v4, 10, v4
    v_xor_b32 v5, v11, v61
    v_lshl_add_u32 v2, v5, 4, v4
    v_xor_b32 v5, 4, v5
    v_lshl_add_u32 v3, v5, 4, v4
    v_add_u32 v3, 8192, v3
    v_bfe_u32 v4, v10, 1, 1
    s_and_b32 s42, s39, 1
    s_lshl_b32 s42, s42, 1
    v_or_b32 v4, s42, v4
    v_lshrrev_b32 v5, 1, v11
    v_xor_b32 v4, v4, v5
    v_lshlrev_b32 v6, 10, v10
    v_lshl_add_u32 v6, v4, 5, v6
    v_and_b32 v5, 1, v11
    v_lshl_add_u32 v6, v5, 4, v6
    v_add_u32 v6, s41, v6
    s_lshl_b32 s43, s39, 13
    s_lshl_b32 s44, s39, 10
    s_lshl_b32 s45, s39, 11
    s_waitcnt lgkmcnt(0)
    s_mov_b32 s12, s8
    s_and_b32 s13, s9, 0xffff
    s_mov_b32 s14, 2097152
    s_mov_b32 s15, 0x00020000
    s_mov_b32 s16, s6
    s_and_b32 s17, s7, 0xffff
    s_mov_b32 s18, 524288
    s_mov_b32 s19, 0x00020000
    s_mov_b32 s46, 0
    s_add_u32 m0, s45, 0
    s_nop 0
    buffer_load_dwordx4 v2, s[12:15], s46 offen lds
    s_add_u32 m0, s45, 1024
    s_nop 0
    buffer_load_dwordx4 v3, s[12:15], s46 offen lds
    s_add_u32 s47, s43, 0
    s_add_u32 m0, s44, 8192
    s_nop 0
    buffer_load_dwordx4 v6, s[16:19], s47 offen lds
    s_add_u32 s47, s43, 32768
    s_add_u32 m0, s44, 12288
    s_nop 0
    buffer_load_dwordx4 v6, s[16:19], s47 offen lds
    s_mov_b32 s46, 128
    s_add_u32 m0, s45, 16384
    s_nop 0
    buffer_load_dwordx4 v2, s[12:15], s46 offen lds
    s_add_u32 m0, s45, 17408
    s_nop 0
    buffer_load_dwordx4 v3, s[12:15], s46 offen lds
    s_add_u32 s47, s43, 65536
    s_add_u32 m0, s44, 24576
    s_nop 0
    buffer_load_dwordx4 v6, s[16:19], s47 offen lds
    s_add_u32 s47, s43, 98304
    s_add_u32 m0, s44, 28672
    s_nop 0
    buffer_load_dwordx4 v6, s[16:19], s47 offen lds
    s_mov_b32 s46, 256
    s_add_u32 m0, s45, 32768
    s_nop 0
    buffer_load_dwordx4 v2, s[12:15], s46 offen lds
    s_add_u32 m0, s45, 33792
    s_nop 0
    buffer_load_dwordx4 v3, s[12:15], s46 offen lds
    s_add_u32 s47, s43, 131072
    s_add_u32 m0, s44, 40960
    s_nop 0
    buffer_load_dwordx4 v6, s[16:19], s47 offen lds
    s_add_u32 s47, s43, 163840
    s_add_u32 m0, s44, 45056
    s_nop 0
    buffer_load_dwordx4 v6, s[16:19], s47 offen lds
    s_waitcnt vmcnt(8)
    s_barrier
    s_mov_b32 s46, 384
    s_add_u32 m0, s45, 49152
    s_nop 0
    buffer_load_dwordx4 v2, s[12:15], s46 offen lds
    s_add_u32 m0, s45, 50176
    s_nop 0
    buffer_load_dwordx4 v3, s[12:15], s46 offen lds
    s_add_u32 s47, s43, 196608
    s_add_u32 m0, s44, 57344
    s_nop 0
    buffer_load_dwordx4 v6, s[16:19], s47 offen lds
    s_add_u32 s47, s43, 229376
    s_add_u32 m0, s44, 61440
    s_nop 0
    buffer_load_dwordx4 v6, s[16:19], s47 offen lds
    s_waitcnt vmcnt(8)
    s_barrier
    s_mov_b32 s46, 512
    s_add_u32 m0, s45, 65536
    s_nop 0
    buffer_load_dwordx4 v2, s[12:15], s46 offen lds
    s_add_u32 m0, s45, 66560
    s_nop 0
    buffer_load_dwordx4 v3, s[12:15], s46 offen lds
    s_add_u32 s47, s43, 262144
    s_add_u32 m0, s44, 73728
    s_nop 0
    buffer_load_dwordx4 v6, s[16:19], s47 offen lds
    s_add_u32 s47, s43, 294912
    s_add_u32 m0, s44, 77824
    s_nop 0
    buffer_load_dwordx4 v6, s[16:19], s47 offen lds
    s_waitcnt vmcnt(8)
    s_barrier
    s_mov_b32 s46, 640
    s_add_u32 m0, s45, 81920
    s_nop 0
    buffer_load_dwordx4 v2, s[12:15], s46 offen lds
    s_add_u32 m0, s45, 82944
    s_nop 0
    buffer_load_dwordx4 v3, s[12:15], s46 offen lds
    s_add_u32 s47, s43, 327680
    s_add_u32 m0, s44, 90112
    s_nop 0
    buffer_load_dwordx4 v6, s[16:19], s47 offen lds
    s_add_u32 s47, s43, 360448
    s_add_u32 m0, s44, 94208
    s_nop 0
    buffer_load_dwordx4 v6, s[16:19], s47 offen lds
    s_waitcnt vmcnt(8)
    s_barrier
    s_mov_b32 s46, 768
    s_add_u32 m0, s45, 98304
    s_nop 0
    buffer_load_dwordx4 v2, s[12:15], s46 offen lds
    s_add_u32 m0, s45, 99328
    s_nop 0
    buffer_load_dwordx4 v3, s[12:15], s46 offen lds
    s_add_u32 s47, s43, 393216
    s_add_u32 m0, s44, 106496
    s_nop 0
    buffer_load_dwordx4 v6, s[16:19], s47 offen lds
    s_add_u32 s47, s43, 425984
    s_add_u32 m0, s44, 110592
    s_nop 0
    buffer_load_dwordx4 v6, s[16:19], s47 offen lds
    s_waitcnt vmcnt(8)
    s_barrier
    s_mov_b32 s46, 896
    s_add_u32 m0, s45, 114688
    s_nop 0
    buffer_load_dwordx4 v2, s[12:15], s46 offen lds
    s_add_u32 m0, s45, 115712
    s_nop 0
    buffer_load_dwordx4 v3, s[12:15], s46 offen lds
    s_add_u32 s47, s43, 458752
    s_add_u32 m0, s44, 122880
    s_nop 0
    buffer_load_dwordx4 v6, s[16:19], s47 offen lds
    s_add_u32 s47, s43, 491520
    s_add_u32 m0, s44, 126976
    s_nop 0
    buffer_load_dwordx4 v6, s[16:19], s47 offen lds
    s_waitcnt vmcnt(8)
    s_barrier
    s_waitcnt vmcnt(4)
    s_barrier
    s_waitcnt vmcnt(0)
    s_barrier
    s_endpgm
L_k2l2_comp:
    s_lshl_b32 s45, s39, 11
    s_waitcnt lgkmcnt(0)
    s_add_u32 s20, s4, 4194304
    s_addc_u32 s21, s5, 0
    s_and_b32 s21, s21, 0xffff
    s_mov_b32 s22, 2097152
    s_mov_b32 s23, 0x00020000
    s_add_u32 s24, s8, 6291456
    s_addc_u32 s25, s9, 0
    s_and_b32 s25, s25, 0xffff
    s_mov_b32 s26, 2097152
    s_mov_b32 s27, 0x00020000
    s_add_u32 s28, s8, 8421376
    s_addc_u32 s29, s9, 0
    s_and_b32 s29, s29, 0xffff
    s_mov_b32 s30, 32768
    s_mov_b32 s31, 0x00020000
    s_mov_b32 s32, s10
    s_and_b32 s33, s11, 0xffff
    s_mov_b32 s34, 1024
    s_mov_b32 s35, 0x00020000
    v_and_b32 v60, 15, v1
    v_add_u32 v62, s40, v60
    v_lshlrev_b32 v9, 10, v62
    v_lshl_add_u32 v9, v61, 3, v9
    v_add_u32 v9, s41, v9
    v_lshlrev_b32 v10, 3, v61
    v_add_u32 v10, s41, v10
    buffer_load_dwordx2 v[44:45], v9, s[20:23], 0 offen offset:0
    buffer_load_dwordx2 v[46:47], v9, s[20:23], 0 offen offset:32
    buffer_load_dwordx2 v[48:49], v9, s[20:23], 0 offen offset:64
    buffer_load_dwordx2 v[50:51], v9, s[20:23], 0 offen offset:96
    buffer_load_dwordx2 v[52:53], v10, s[32:35], 0 offen offset:0
    buffer_load_dwordx2 v[54:55], v10, s[32:35], 0 offen offset:32
    buffer_load_dwordx2 v[56:57], v10, s[32:35], 0 offen offset:64
    buffer_load_dwordx2 v[58:59], v10, s[32:35], 0 offen offset:96
    v_lshrrev_b32 v4, 1, v60
    v_xor_b32 v4, v4, v61
    v_lshlrev_b32 v2, 7, v60
    v_lshl_add_u32 v2, v4, 4, v2
    v_add_u32 v2, s45, v2
    v_xor_b32 v3, 64, v2
    v_bfe_u32 v8, v1, 2, 2
    v_lshl_add_u32 v11, v61, 3, v8
    v_lshlrev_b32 v11, 7, v11
    v_and_b32 v5, 3, v1
    v_lshl_add_u32 v11, v5, 3, v11
    v_add_u32 v11, 8192, v11
    v_lshrrev_b32 v8, 1, v8
    v_and_b32 v5, 1, v61
    v_lshl_or_b32 v8, v5, 1, v8
    v_xor_b32 v4, 0, v8
    v_lshl_add_u32 v4, v4, 5, v11
    v_xor_b32 v5, 1, v8
    v_lshl_add_u32 v5, v5, 5, v11
    v_xor_b32 v6, 2, v8
    v_lshl_add_u32 v6, v6, 5, v11
    v_xor_b32 v7, 3, v8
    v_lshl_add_u32 v7, v7, 5, v11
    v_add_u32 v28, 65536, v2
    v_add_u32 v29, 65536, v3
    v_add_u32 v30, 65536, v4
    v_add_u32 v31, 65536, v5
    v_add_u32 v32, 65536, v6
    v_add_u32 v33, 65536, v7
    v_mov_b32 v12, 0
    v_mov_b32 v13, 0
    v_mov_b32 v14, 0
    v_mov_b32 v15, 0
    v_mov_b32 v16, 0
    v_mov_b32 v17, 0
    v_mov_b32 v18, 0
    v_mov_b32 v19, 0
    v_mov_b32 v20, 0
    v_mov_b32 v21, 0
    v_mov_b32 v22, 0
    v_mov_b32 v23, 0
    v_mov_b32 v24, 0
    v_mov_b32 v25, 0
    v_mov_b32 v26, 0
    v_mov_b32 v27, 0
    s_barrier
    ds_read_b64_tr_b16 v[64:65], v4 offset:0
    ds_read_b64_tr_b16 v[66:67], v4 offset:512
    ds_read_b64_tr_b16 v[68:69], v5 offset:0
    ds_read_b64_tr_b16 v[70:71], v5 offset:512
    ds_read_b64_tr_b16 v[72:73], v6 offset:0
    ds_read_b64_tr_b16 v[74:75], v6 offset:512
    ds_read_b64_tr_b16 v[76:77], v7 offset:0
    ds_read_b64_tr_b16 v[78:79], v7 offset:512
    ds_read_b128 v[80:83], v2 offset:0
    s_waitcnt lgkmcnt(0)
    ds_read_b64_tr_b16 v[84:85], v4 offset:4096
    ds_read_b64_tr_b16 v[86:87], v4 offset:4608
    ds_read_b64_tr_b16 v[88:89], v5 offset:4096
    ds_read_b64_tr_b16 v[90:91], v5 offset:4608
    ds_read_b64_tr_b16 v[92:93], v6 offset:4096
    ds_read_b64_tr_b16 v[94:95], v6 offset:4608
    ds_read_b64_tr_b16 v[96:97], v7 offset:4096
    ds_read_b64_tr_b16 v[98:99], v7 offset:4608
    ds_read_b128 v[100:103], v3 offset:0
    v_mfma_f32_16x16x32_bf16 v[12:15], v[64:67], v[80:83], v[12:15]
    v_mfma_f32_16x16x32_bf16 v[16:19], v[68:71], v[80:83], v[16:19]
    v_mfma_f32_16x16x32_bf16 v[20:23], v[72:75], v[80:83], v[20:23]
    v_mfma_f32_16x16x32_bf16 v[24:27], v[76:79], v[80:83], v[24:27]
    s_barrier
    s_waitcnt lgkmcnt(0)
    ds_read_b64_tr_b16 v[64:65], v4 offset:16384
    ds_read_b64_tr_b16 v[66:67], v4 offset:16896
    ds_read_b64_tr_b16 v[68:69], v5 offset:16384
    ds_read_b64_tr_b16 v[70:71], v5 offset:16896
    ds_read_b64_tr_b16 v[72:73], v6 offset:16384
    ds_read_b64_tr_b16 v[74:75], v6 offset:16896
    ds_read_b64_tr_b16 v[76:77], v7 offset:16384
    ds_read_b64_tr_b16 v[78:79], v7 offset:16896
    ds_read_b128 v[80:83], v2 offset:16384
    v_mfma_f32_16x16x32_bf16 v[12:15], v[84:87], v[100:103], v[12:15]
    v_mfma_f32_16x16x32_bf16 v[16:19], v[88:91], v[100:103], v[16:19]
    v_mfma_f32_16x16x32_bf16 v[20:23], v[92:95], v[100:103], v[20:23]
    v_mfma_f32_16x16x32_bf16 v[24:27], v[96:99], v[100:103], v[24:27]
    s_waitcnt lgkmcnt(0)
    ds_read_b64_tr_b16 v[84:85], v4 offset:20480
    ds_read_b64_tr_b16 v[86:87], v4 offset:20992
    ds_read_b64_tr_b16 v[88:89], v5 offset:20480
    ds_read_b64_tr_b16 v[90:91], v5 offset:20992
    ds_read_b64_tr_b16 v[92:93], v6 offset:20480
    ds_read_b64_tr_b16 v[94:95], v6 offset:20992
    ds_read_b64_tr_b16 v[96:97], v7 offset:20480
    ds_read_b64_tr_b16 v[98:99], v7 offset:20992
    ds_read_b128 v[100:103], v3 offset:16384
    v_mfma_f32_16x16x32_bf16 v[12:15], v[64:67], v[80:83], v[12:15]
    v_mfma_f32_16x16x32_bf16 v[16:19], v[68:71], v[80:83], v[16:19]
    v_mfma_f32_16x16x32_bf16 v[20:23], v[72:75], v[80:83], v[20:23]
    v_mfma_f32_16x16x32_bf16 v[24:27], v[76:79], v[80:83], v[24:27]
    s_barrier
    s_waitcnt lgkmcnt(0)
    ds_read_b64_tr_b16 v[64:65], v4 offset:32768
    ds_read_b64_tr_b16 v[66:67], v4 offset:33280
    ds_read_b64_tr_b16 v[68:69], v5 offset:32768
    ds_read_b64_tr_b16 v[70:71], v5 offset:33280
    ds_read_b64_tr_b16 v[72:73], v6 offset:32768
    ds_read_b64_tr_b16 v[74:75], v6 offset:33280
    ds_read_b64_tr_b16 v[76:77], v7 offset:32768
    ds_read_b64_tr_b16 v[78:79], v7 offset:33280
    ds_read_b128 v[80:83], v2 offset:32768
    v_mfma_f32_16x16x32_bf16 v[12:15], v[84:87], v[100:103], v[12:15]
    v_mfma_f32_16x16x32_bf16 v[16:19], v[88:91], v[100:103], v[16:19]
    v_mfma_f32_16x16x32_bf16 v[20:23], v[92:95], v[100:103], v[20:23]
    v_mfma_f32_16x16x32_bf16 v[24:27], v[96:99], v[100:103], v[24:27]
    s_waitcnt lgkmcnt(0)
    ds_read_b64_tr_b16 v[84:85], v4 offset:36864
    ds_read_b64_tr_b16 v[86:87], v4 offset:37376
    ds_read_b64_tr_b16 v[88:89], v5 offset:36864
    ds_read_b64_tr_b16 v[90:91], v5 offset:37376
    ds_read_b64_tr_b16 v[92:93], v6 offset:36864
    ds_read_b64_tr_b16 v[94:95], v6 offset:37376
    ds_read_b64_tr_b16 v[96:97], v7 offset:36864
    ds_read_b64_tr_b16 v[98:99], v7 offset:37376
    ds_read_b128 v[100:103], v3 offset:32768
    v_mfma_f32_16x16x32_bf16 v[12:15], v[64:67], v[80:83], v[12:15]
    v_mfma_f32_16x16x32_bf16 v[16:19], v[68:71], v[80:83], v[16:19]
    v_mfma_f32_16x16x32_bf16 v[20:23], v[72:75], v[80:83], v[20:23]
    v_mfma_f32_16x16x32_bf16 v[24:27], v[76:79], v[80:83], v[24:27]
    s_barrier
    s_waitcnt lgkmcnt(0)
    ds_read_b64_tr_b16 v[64:65], v4 offset:49152
    ds_read_b64_tr_b16 v[66:67], v4 offset:49664
    ds_read_b64_tr_b16 v[68:69], v5 offset:49152
    ds_read_b64_tr_b16 v[70:71], v5 offset:49664
    ds_read_b64_tr_b16 v[72:73], v6 offset:49152
    ds_read_b64_tr_b16 v[74:75], v6 offset:49664
    ds_read_b64_tr_b16 v[76:77], v7 offset:49152
    ds_read_b64_tr_b16 v[78:79], v7 offset:49664
    ds_read_b128 v[80:83], v2 offset:49152
    v_mfma_f32_16x16x32_bf16 v[12:15], v[84:87], v[100:103], v[12:15]
    v_mfma_f32_16x16x32_bf16 v[16:19], v[88:91], v[100:103], v[16:19]
    v_mfma_f32_16x16x32_bf16 v[20:23], v[92:95], v[100:103], v[20:23]
    v_mfma_f32_16x16x32_bf16 v[24:27], v[96:99], v[100:103], v[24:27]
    s_waitcnt lgkmcnt(0)
    ds_read_b64_tr_b16 v[84:85], v4 offset:53248
    ds_read_b64_tr_b16 v[86:87], v4 offset:53760
    ds_read_b64_tr_b16 v[88:89], v5 offset:53248
    ds_read_b64_tr_b16 v[90:91], v5 offset:53760
    ds_read_b64_tr_b16 v[92:93], v6 offset:53248
    ds_read_b64_tr_b16 v[94:95], v6 offset:53760
    ds_read_b64_tr_b16 v[96:97], v7 offset:53248
    ds_read_b64_tr_b16 v[98:99], v7 offset:53760
    ds_read_b128 v[100:103], v3 offset:49152
    v_mfma_f32_16x16x32_bf16 v[12:15], v[64:67], v[80:83], v[12:15]
    v_mfma_f32_16x16x32_bf16 v[16:19], v[68:71], v[80:83], v[16:19]
    v_mfma_f32_16x16x32_bf16 v[20:23], v[72:75], v[80:83], v[20:23]
    v_mfma_f32_16x16x32_bf16 v[24:27], v[76:79], v[80:83], v[24:27]
    s_barrier
    s_waitcnt lgkmcnt(0)
    ds_read_b64_tr_b16 v[64:65], v30 offset:0
    ds_read_b64_tr_b16 v[66:67], v30 offset:512
    ds_read_b64_tr_b16 v[68:69], v31 offset:0
    ds_read_b64_tr_b16 v[70:71], v31 offset:512
    ds_read_b64_tr_b16 v[72:73], v32 offset:0
    ds_read_b64_tr_b16 v[74:75], v32 offset:512
    ds_read_b64_tr_b16 v[76:77], v33 offset:0
    ds_read_b64_tr_b16 v[78:79], v33 offset:512
    ds_read_b128 v[80:83], v28 offset:0
    v_mfma_f32_16x16x32_bf16 v[12:15], v[84:87], v[100:103], v[12:15]
    v_mfma_f32_16x16x32_bf16 v[16:19], v[88:91], v[100:103], v[16:19]
    v_mfma_f32_16x16x32_bf16 v[20:23], v[92:95], v[100:103], v[20:23]
    v_mfma_f32_16x16x32_bf16 v[24:27], v[96:99], v[100:103], v[24:27]
    s_waitcnt lgkmcnt(0)
    ds_read_b64_tr_b16 v[84:85], v30 offset:4096
    ds_read_b64_tr_b16 v[86:87], v30 offset:4608
    ds_read_b64_tr_b16 v[88:89], v31 offset:4096
    ds_read_b64_tr_b16 v[90:91], v31 offset:4608
    ds_read_b64_tr_b16 v[92:93], v32 offset:4096
    ds_read_b64_tr_b16 v[94:95], v32 offset:4608
    ds_read_b64_tr_b16 v[96:97], v33 offset:4096
    ds_read_b64_tr_b16 v[98:99], v33 offset:4608
    ds_read_b128 v[100:103], v29 offset:0
    v_mfma_f32_16x16x32_bf16 v[12:15], v[64:67], v[80:83], v[12:15]
    v_mfma_f32_16x16x32_bf16 v[16:19], v[68:71], v[80:83], v[16:19]
    v_mfma_f32_16x16x32_bf16 v[20:23], v[72:75], v[80:83], v[20:23]
    v_mfma_f32_16x16x32_bf16 v[24:27], v[76:79], v[80:83], v[24:27]
    s_barrier
    s_waitcnt lgkmcnt(0)
    ds_read_b64_tr_b16 v[64:65], v30 offset:16384
    ds_read_b64_tr_b16 v[66:67], v30 offset:16896
    ds_read_b64_tr_b16 v[68:69], v31 offset:16384
    ds_read_b64_tr_b16 v[70:71], v31 offset:16896
    ds_read_b64_tr_b16 v[72:73], v32 offset:16384
    ds_read_b64_tr_b16 v[74:75], v32 offset:16896
    ds_read_b64_tr_b16 v[76:77], v33 offset:16384
    ds_read_b64_tr_b16 v[78:79], v33 offset:16896
    ds_read_b128 v[80:83], v28 offset:16384
    v_mfma_f32_16x16x32_bf16 v[12:15], v[84:87], v[100:103], v[12:15]
    v_mfma_f32_16x16x32_bf16 v[16:19], v[88:91], v[100:103], v[16:19]
    v_mfma_f32_16x16x32_bf16 v[20:23], v[92:95], v[100:103], v[20:23]
    v_mfma_f32_16x16x32_bf16 v[24:27], v[96:99], v[100:103], v[24:27]
    s_waitcnt lgkmcnt(0)
    ds_read_b64_tr_b16 v[84:85], v30 offset:20480
    ds_read_b64_tr_b16 v[86:87], v30 offset:20992
    ds_read_b64_tr_b16 v[88:89], v31 offset:20480
    ds_read_b64_tr_b16 v[90:91], v31 offset:20992
    ds_read_b64_tr_b16 v[92:93], v32 offset:20480
    ds_read_b64_tr_b16 v[94:95], v32 offset:20992
    ds_read_b64_tr_b16 v[96:97], v33 offset:20480
    ds_read_b64_tr_b16 v[98:99], v33 offset:20992
    ds_read_b128 v[100:103], v29 offset:16384
    v_mfma_f32_16x16x32_bf16 v[12:15], v[64:67], v[80:83], v[12:15]
    v_mfma_f32_16x16x32_bf16 v[16:19], v[68:71], v[80:83], v[16:19]
    v_mfma_f32_16x16x32_bf16 v[20:23], v[72:75], v[80:83], v[20:23]
    v_mfma_f32_16x16x32_bf16 v[24:27], v[76:79], v[80:83], v[24:27]
    s_barrier
    s_waitcnt lgkmcnt(0)
    ds_read_b64_tr_b16 v[64:65], v30 offset:32768
    ds_read_b64_tr_b16 v[66:67], v30 offset:33280
    ds_read_b64_tr_b16 v[68:69], v31 offset:32768
    ds_read_b64_tr_b16 v[70:71], v31 offset:33280
    ds_read_b64_tr_b16 v[72:73], v32 offset:32768
    ds_read_b64_tr_b16 v[74:75], v32 offset:33280
    ds_read_b64_tr_b16 v[76:77], v33 offset:32768
    ds_read_b64_tr_b16 v[78:79], v33 offset:33280
    ds_read_b128 v[80:83], v28 offset:32768
    v_mfma_f32_16x16x32_bf16 v[12:15], v[84:87], v[100:103], v[12:15]
    v_mfma_f32_16x16x32_bf16 v[16:19], v[88:91], v[100:103], v[16:19]
    v_mfma_f32_16x16x32_bf16 v[20:23], v[92:95], v[100:103], v[20:23]
    v_mfma_f32_16x16x32_bf16 v[24:27], v[96:99], v[100:103], v[24:27]
    s_waitcnt lgkmcnt(0)
    ds_read_b64_tr_b16 v[84:85], v30 offset:36864
    ds_read_b64_tr_b16 v[86:87], v30 offset:37376
    ds_read_b64_tr_b16 v[88:89], v31 offset:36864
    ds_read_b64_tr_b16 v[90:91], v31 offset:37376
    ds_read_b64_tr_b16 v[92:93], v32 offset:36864
    ds_read_b64_tr_b16 v[94:95], v32 offset:37376
    ds_read_b64_tr_b16 v[96:97], v33 offset:36864
    ds_read_b64_tr_b16 v[98:99], v33 offset:37376
    ds_read_b128 v[100:103], v29 offset:32768
    v_mfma_f32_16x16x32_bf16 v[12:15], v[64:67], v[80:83], v[12:15]
    v_mfma_f32_16x16x32_bf16 v[16:19], v[68:71], v[80:83], v[16:19]
    v_mfma_f32_16x16x32_bf16 v[20:23], v[72:75], v[80:83], v[20:23]
    v_mfma_f32_16x16x32_bf16 v[24:27], v[76:79], v[80:83], v[24:27]
    s_barrier
    s_waitcnt lgkmcnt(0)
    ds_read_b64_tr_b16 v[64:65], v30 offset:49152
    ds_read_b64_tr_b16 v[66:67], v30 offset:49664
    ds_read_b64_tr_b16 v[68:69], v31 offset:49152
    ds_read_b64_tr_b16 v[70:71], v31 offset:49664
    ds_read_b64_tr_b16 v[72:73], v32 offset:49152
    ds_read_b64_tr_b16 v[74:75], v32 offset:49664
    ds_read_b64_tr_b16 v[76:77], v33 offset:49152
    ds_read_b64_tr_b16 v[78:79], v33 offset:49664
    ds_read_b128 v[80:83], v28 offset:49152
    v_mfma_f32_16x16x32_bf16 v[12:15], v[84:87], v[100:103], v[12:15]
    v_mfma_f32_16x16x32_bf16 v[16:19], v[88:91], v[100:103], v[16:19]
    v_mfma_f32_16x16x32_bf16 v[20:23], v[92:95], v[100:103], v[20:23]
    v_mfma_f32_16x16x32_bf16 v[24:27], v[96:99], v[100:103], v[24:27]
    s_waitcnt lgkmcnt(0)
    ds_read_b64_tr_b16 v[84:85], v30 offset:53248
    ds_read_b64_tr_b16 v[86:87], v30 offset:53760
    ds_read_b64_tr_b16 v[88:89], v31 offset:53248
    ds_read_b64_tr_b16 v[90:91], v31 offset:53760
    ds_read_b64_tr_b16 v[92:93], v32 offset:53248
    ds_read_b64_tr_b16 v[94:95], v32 offset:53760
    ds_read_b64_tr_b16 v[96:97], v33 offset:53248
    ds_read_b64_tr_b16 v[98:99], v33 offset:53760
    ds_read_b128 v[100:103], v29 offset:49152
    v_mfma_f32_16x16x32_bf16 v[12:15], v[64:67], v[80:83], v[12:15]
    v_mfma_f32_16x16x32_bf16 v[16:19], v[68:71], v[80:83], v[16:19]
    v_mfma_f32_16x16x32_bf16 v[20:23], v[72:75], v[80:83], v[20:23]
    v_mfma_f32_16x16x32_bf16 v[24:27], v[76:79], v[80:83], v[24:27]
    s_waitcnt lgkmcnt(0)
    v_mfma_f32_16x16x32_bf16 v[12:15], v[84:87], v[100:103], v[12:15]
    v_mfma_f32_16x16x32_bf16 v[16:19], v[88:91], v[100:103], v[16:19]
    v_mfma_f32_16x16x32_bf16 v[20:23], v[92:95], v[100:103], v[20:23]
    v_mfma_f32_16x16x32_bf16 v[24:27], v[96:99], v[100:103], v[24:27]
    s_mov_b32 s46, 0xffff0000
    v_mov_b32 v63, 0x3f803f80
    v_mov_b32 v108, 0
    v_mov_b32 v109, 0
    v_mov_b32 v110, 0
    s_waitcnt vmcnt(0)
    v_cvt_pk_bf16_f32 v120, v12, v13
    v_lshlrev_b32 v121, 16, v120
    v_and_b32 v122, s46, v120
    v_lshlrev_b32 v123, 16, v44
    v_and_b32 v124, s46, v44
    v_add_f32 v121, v121, v123
    v_add_f32 v122, v122, v124
    v_cvt_pk_bf16_f32 v112, v121, v122
    v_dot2c_f32_bf16 v108, v112, v63
    v_dot2c_f32_bf16 v109, v112, v112
    v_dot2c_f32_bf16 v110, v112, v52
    v_cvt_pk_bf16_f32 v120, v14, v15
    v_lshlrev_b32 v121, 16, v120
    v_and_b32 v122, s46, v120
    v_lshlrev_b32 v123, 16, v45
    v_and_b32 v124, s46, v45
    v_add_f32 v121, v121, v123
    v_add_f32 v122, v122, v124
    v_cvt_pk_bf16_f32 v113, v121, v122
    v_dot2c_f32_bf16 v108, v113, v63
    v_dot2c_f32_bf16 v109, v113, v113
    v_dot2c_f32_bf16 v110, v113, v53
    buffer_store_dwordx2 v[112:113], v9, s[24:27], 0 offen offset:0
    v_cvt_pk_bf16_f32 v120, v16, v17
    v_lshlrev_b32 v121, 16, v120
    v_and_b32 v122, s46, v120
    v_lshlrev_b32 v123, 16, v46
    v_and_b32 v124, s46, v46
    v_add_f32 v121, v121, v123
    v_add_f32 v122, v122, v124
    v_cvt_pk_bf16_f32 v114, v121, v122
    v_dot2c_f32_bf16 v108, v114, v63
    v_dot2c_f32_bf16 v109, v114, v114
    v_dot2c_f32_bf16 v110, v114, v54
    v_cvt_pk_bf16_f32 v120, v18, v19
    v_lshlrev_b32 v121, 16, v120
    v_and_b32 v122, s46, v120
    v_lshlrev_b32 v123, 16, v47
    v_and_b32 v124, s46, v47
    v_add_f32 v121, v121, v123
    v_add_f32 v122, v122, v124
    v_cvt_pk_bf16_f32 v115, v121, v122
    v_dot2c_f32_bf16 v108, v115, v63
    v_dot2c_f32_bf16 v109, v115, v115
    v_dot2c_f32_bf16 v110, v115, v55
    buffer_store_dwordx2 v[114:115], v9, s[24:27], 0 offen offset:32
    v_cvt_pk_bf16_f32 v120, v20, v21
    v_lshlrev_b32 v121, 16, v120
    v_and_b32 v122, s46, v120
    v_lshlrev_b32 v123, 16, v48
    v_and_b32 v124, s46, v48
    v_add_f32 v121, v121, v123
    v_add_f32 v122, v122, v124
    v_cvt_pk_bf16_f32 v116, v121, v122
    v_dot2c_f32_bf16 v108, v116, v63
    v_dot2c_f32_bf16 v109, v116, v116
    v_dot2c_f32_bf16 v110, v116, v56
    v_cvt_pk_bf16_f32 v120, v22, v23
    v_lshlrev_b32 v121, 16, v120
    v_and_b32 v122, s46, v120
    v_lshlrev_b32 v123, 16, v49
    v_and_b32 v124, s46, v49
    v_add_f32 v121, v121, v123
    v_add_f32 v122, v122, v124
    v_cvt_pk_bf16_f32 v117, v121, v122
    v_dot2c_f32_bf16 v108, v117, v63
    v_dot2c_f32_bf16 v109, v117, v117
    v_dot2c_f32_bf16 v110, v117, v57
    buffer_store_dwordx2 v[116:117], v9, s[24:27], 0 offen offset:64
    v_cvt_pk_bf16_f32 v120, v24, v25
    v_lshlrev_b32 v121, 16, v120
    v_and_b32 v122, s46, v120
    v_lshlrev_b32 v123, 16, v50
    v_and_b32 v124, s46, v50
    v_add_f32 v121, v121, v123
    v_add_f32 v122, v122, v124
    v_cvt_pk_bf16_f32 v118, v121, v122
    v_dot2c_f32_bf16 v108, v118, v63
    v_dot2c_f32_bf16 v109, v118, v118
    v_dot2c_f32_bf16 v110, v118, v58
    v_cvt_pk_bf16_f32 v120, v26, v27
    v_lshlrev_b32 v121, 16, v120
    v_and_b32 v122, s46, v120
    v_lshlrev_b32 v123, 16, v51
    v_and_b32 v124, s46, v51
    v_add_f32 v121, v121, v123
    v_add_f32 v122, v122, v124
    v_cvt_pk_bf16_f32 v119, v121, v122
    v_dot2c_f32_bf16 v108, v119, v63
    v_dot2c_f32_bf16 v109, v119, v119
    v_dot2c_f32_bf16 v110, v119, v59
    buffer_store_dwordx2 v[118:119], v9, s[24:27], 0 offen offset:96
    v_mov_b32 v125, v108
    s_nop 1
    v_permlane16_swap_b32 v108, v125
    v_add_f32 v108, v108, v125
    v_mov_b32 v125, v108
    s_nop 1
    v_permlane32_swap_b32 v108, v125
    v_add_f32 v108, v108, v125
    v_mov_b32 v126, v109
    s_nop 1
    v_permlane16_swap_b32 v109, v126
    v_add_f32 v109, v109, v126
    v_mov_b32 v126, v109
    s_nop 1
    v_permlane32_swap_b32 v109, v126
    v_add_f32 v109, v109, v126
    v_mov_b32 v127, v110
    s_nop 1
    v_permlane16_swap_b32 v110, v127
    v_add_f32 v110, v110, v127
    v_mov_b32 v127, v110
    s_nop 1
    v_permlane32_swap_b32 v110, v127
    v_add_f32 v110, v110, v127
    v_mov_b32 v111, 0
    v_cmp_eq_u32 vcc, 1, v61
    s_nop 1
    v_cndmask_b32 v108, v108, v109, vcc
    v_cmp_eq_u32 vcc, 2, v61
    s_nop 1
    v_cndmask_b32 v108, v108, v110, vcc
    v_cmp_eq_u32 vcc, 3, v61
    s_nop 1
    v_cndmask_b32 v108, v108, v111, vcc
    v_lshlrev_b32 v120, 4, v62
    v_lshl_add_u32 v120, v61, 2, v120
    buffer_atomic_add_f32 v108, v120, s[28:31], 0 offen
L_k2l2_done:
    s_endpgm
.globl k4l2_kernel
.p2align 8
.type k4l2_kernel,@function
k4l2_kernel:
    s_cmp_ge_u32 s2, 184
    s_cbranch_scc1 L_k4l2_done
    s_load_dwordx2 s[4:5], s[0:1], 80
    s_load_dwordx2 s[6:7], s[0:1], 40
    s_load_dwordx2 s[8:9], s[0:1], 48
    s_load_dwordx2 s[10:11], s[0:1], 32
    s_load_dwordx2 s[70:71], s[0:1], 64
    s_load_dwordx2 s[66:67], s[0:1], 56
    v_and_b32 v1, 63, v0
    v_lshrrev_b32 v2, 6, v0
    s_nop 0
    v_readfirstlane_b32 s68, v2
    s_mov_b32 s72, 0xffff0000
    s_mov_b32 s73, 0x3b000000
    s_mov_b32 s74, 0x3727c5ac
    v_lshlrev_b32 v3, 4, v0
    s_waitcnt lgkmcnt(0)
    s_add_u32 s12, s4, 6291456
    s_addc_u32 s13, s5, 0
    s_and_b32 s13, s13, 0xffff
    s_mov_b32 s14, 2097152
    s_mov_b32 s15, 0x00020000
    s_add_u32 s24, s4, 8421376
    s_addc_u32 s25, s5, 0
    s_and_b32 s25, s25, 0xffff
    s_mov_b32 s26, 32768
    s_mov_b32 s27, 0x00020000
    s_cmp_ge_u32 s2, 56
    s_cbranch_scc1 L_k4l2_ln
    s_and_b32 s69, s2, 7
    s_mul_i32 s69, s69, 7
    s_lshr_b32 s75, s2, 3
    s_add_u32 s69, s69, s75
    s_cmp_lt_u32 s68, 4
    s_cbranch_scc1 L_k4l2_comp
    s_sub_u32 s68, s68, 4
    s_mov_b32 s16, s6
    s_and_b32 s17, s7, 0xffff
    s_mov_b32 s18, 1835008
    s_mov_b32 s19, 0x00020000
    s_mov_b32 s20, s8
    s_and_b32 s21, s9, 0xffff
    s_mov_b32 s22, 1835008
    s_mov_b32 s23, 0x00020000
    s_mov_b32 s44, s66
    s_and_b32 s45, s67, 0xffff
    s_mov_b32 s46, 1835008
    s_mov_b32 s47, 0x00020000
    s_barrier
    v_lshrrev_b32 v5, 2, v1
    v_mul_u32_u24 v6, 3584, v5
    v_lshrrev_b32 v7, 5, v1
    v_lshlrev_b32 v7, 1, v7
    v_and_b32 v8, 3, v1
    v_xor_b32 v7, v7, v8
    v_lshl_add_u32 v6, v7, 4, v6
    s_lshl_b32 s75, s69, 6
    v_add_u32 v6, s75, v6
    s_mul_i32 s76, s68, 458752
    s_lshl_b32 s77, s68, 13
    s_add_u32 s40, s76, 0
    s_add_u32 m0, s77, 0
    s_nop 0
    buffer_load_dwordx4 v6, s[16:19], s40 offen lds
    s_add_u32 s40, s76, 57344
    s_add_u32 m0, s77, 1024
    s_nop 0
    buffer_load_dwordx4 v6, s[16:19], s40 offen lds
    s_add_u32 s40, s76, 114688
    s_add_u32 m0, s77, 2048
    s_nop 0
    buffer_load_dwordx4 v6, s[16:19], s40 offen lds
    s_add_u32 s40, s76, 172032
    s_add_u32 m0, s77, 3072
    s_nop 0
    buffer_load_dwordx4 v6, s[16:19], s40 offen lds
    s_add_u32 s40, s76, 229376
    s_add_u32 m0, s77, 4096
    s_nop 0
    buffer_load_dwordx4 v6, s[16:19], s40 offen lds
    s_add_u32 s40, s76, 286720
    s_add_u32 m0, s77, 5120
    s_nop 0
    buffer_load_dwordx4 v6, s[16:19], s40 offen lds
    s_add_u32 s40, s76, 344064
    s_add_u32 m0, s77, 6144
    s_nop 0
    buffer_load_dwordx4 v6, s[16:19], s40 offen lds
    s_add_u32 s40, s76, 401408
    s_add_u32 m0, s77, 7168
    s_nop 0
    buffer_load_dwordx4 v6, s[16:19], s40 offen lds
    s_add_u32 s40, s76, 0
    s_add_u32 m0, s77, 32768
    s_nop 0
    buffer_load_dwordx4 v6, s[20:23], s40 offen lds
    s_add_u32 s40, s76, 57344
    s_add_u32 m0, s77, 33792
    s_nop 0
    buffer_load_dwordx4 v6, s[20:23], s40 offen lds
    s_add_u32 s40, s76, 114688
    s_add_u32 m0, s77, 34816
    s_nop 0
    buffer_load_dwordx4 v6, s[20:23], s40 offen lds
    s_add_u32 s40, s76, 172032
    s_add_u32 m0, s77, 35840
    s_nop 0
    buffer_load_dwordx4 v6, s[20:23], s40 offen lds
    s_add_u32 s40, s76, 229376
    s_add_u32 m0, s77, 36864
    s_nop 0
    buffer_load_dwordx4 v6, s[20:23], s40 offen lds
    s_add_u32 s40, s76, 286720
    s_add_u32 m0, s77, 37888
    s_nop 0
    buffer_load_dwordx4 v6, s[20:23], s40 offen lds
    s_add_u32 s40, s76, 344064
    s_add_u32 m0, s77, 38912
    s_nop 0
    buffer_load_dwordx4 v6, s[20:23], s40 offen lds
    s_add_u32 s40, s76, 401408
    s_add_u32 m0, s77, 39936
    s_nop 0
    buffer_load_dwordx4 v6, s[20:23], s40 offen lds
    v_lshrrev_b32 v7, 1, v1
    v_and_b32 v8, 1, v1
    s_lshl_b32 s78, s69, 15
    s_lshl_b32 s79, s68, 13
    s_add_u32 s78, s78, s79
    s_and_b32 s40, s68, 1
    s_lshl_b32 s40, s40, 2
    s_or_b32 s40, s40, 0
    v_xor_b32 v9, s40, v7
    v_lshlrev_b32 v9, 5, v9
    v_lshl_add_u32 v9, v8, 4, v9
    s_add_u32 s41, s78, 0
    s_add_u32 m0, s79, 65536
    s_nop 0
    buffer_load_dwordx4 v9, s[44:47], s41 offen lds
    s_and_b32 s40, s68, 1
    s_lshl_b32 s40, s40, 2
    s_or_b32 s40, s40, 1
    v_xor_b32 v9, s40, v7
    v_lshlrev_b32 v9, 5, v9
    v_lshl_add_u32 v9, v8, 4, v9
    s_add_u32 s41, s78, 1024
    s_add_u32 m0, s79, 66560
    s_nop 0
    buffer_load_dwordx4 v9, s[44:47], s41 offen lds
    s_and_b32 s40, s68, 1
    s_lshl_b32 s40, s40, 2
    s_or_b32 s40, s40, 2
    v_xor_b32 v9, s40, v7
    v_lshlrev_b32 v9, 5, v9
    v_lshl_add_u32 v9, v8, 4, v9
    s_add_u32 s41, s78, 2048
    s_add_u32 m0, s79, 67584
    s_nop 0
    buffer_load_dwordx4 v9, s[44:47], s41 offen lds
    s_and_b32 s40, s68, 1
    s_lshl_b32 s40, s40, 2
    s_or_b32 s40, s40, 3
    v_xor_b32 v9, s40, v7
    v_lshlrev_b32 v9, 5, v9
    v_lshl_add_u32 v9, v8, 4, v9
    s_add_u32 s41, s78, 3072
    s_add_u32 m0, s79, 68608
    s_nop 0
    buffer_load_dwordx4 v9, s[44:47], s41 offen lds
    s_and_b32 s40, s68, 1
    s_lshl_b32 s40, s40, 2
    s_or_b32 s40, s40, 0
    v_xor_b32 v9, s40, v7
    v_lshlrev_b32 v9, 5, v9
    v_lshl_add_u32 v9, v8, 4, v9
    s_add_u32 s41, s78, 4096
    s_add_u32 m0, s79, 69632
    s_nop 0
    buffer_load_dwordx4 v9, s[44:47], s41 offen lds
    s_and_b32 s40, s68, 1
    s_lshl_b32 s40, s40, 2
    s_or_b32 s40, s40, 1
    v_xor_b32 v9, s40, v7
    v_lshlrev_b32 v9, 5, v9
    v_lshl_add_u32 v9, v8, 4, v9
    s_add_u32 s41, s78, 5120
    s_add_u32 m0, s79, 70656
    s_nop 0
    buffer_load_dwordx4 v9, s[44:47], s41 offen lds
    s_and_b32 s40, s68, 1
    s_lshl_b32 s40, s40, 2
    s_or_b32 s40, s40, 2
    v_xor_b32 v9, s40, v7
    v_lshlrev_b32 v9, 5, v9
    v_lshl_add_u32 v9, v8, 4, v9
    s_add_u32 s41, s78, 6144
    s_add_u32 m0, s79, 71680
    s_nop 0
    buffer_load_dwordx4 v9, s[44:47], s41 offen lds
    s_and_b32 s40, s68, 1
    s_lshl_b32 s40, s40, 2
    s_or_b32 s40, s40, 3
    v_xor_b32 v9, s40, v7
    v_lshlrev_b32 v9, 5, v9
    v_lshl_add_u32 v9, v8, 4, v9
    s_add_u32 s41, s78, 7168
    s_add_u32 m0, s79, 72704
    s_nop 0
    buffer_load_dwordx4 v9, s[44:47], s41 offen lds
    s_waitcnt vmcnt(0)
    s_barrier
    s_endpgm
L_k4l2_comp:
    s_mov_b32 s40, 0
    buffer_load_dwordx4 v[32:35], v3, s[24:27], s40 offen
    s_mov_b32 s40, 4096
    buffer_load_dwordx4 v[36:39], v3, s[24:27], s40 offen
    s_mov_b32 s40, 8192
    buffer_load_dwordx4 v[40:43], v3, s[24:27], s40 offen
    s_mov_b32 s40, 12288
    buffer_load_dwordx4 v[44:47], v3, s[24:27], s40 offen
    s_mov_b32 s40, 16384
    buffer_load_dwordx4 v[48:51], v3, s[24:27], s40 offen
    s_mov_b32 s40, 20480
    buffer_load_dwordx4 v[52:55], v3, s[24:27], s40 offen
    s_mov_b32 s40, 24576
    buffer_load_dwordx4 v[56:59], v3, s[24:27], s40 offen
    s_mov_b32 s40, 28672
    buffer_load_dwordx4 v[60:63], v3, s[24:27], s40 offen
    s_mov_b32 s28, s10
    s_and_b32 s29, s11, 0xffff
    s_mov_b32 s30, 1024
    s_mov_b32 s31, 0x00020000
    v_lshlrev_b32 v4, 4, v1
    buffer_load_dwordx4 v[64:67], v4, s[28:31], 0 offen
    s_add_u32 s32, s4, 8454144
    s_addc_u32 s33, s5, 0
    s_and_b32 s33, s33, 0xffff
    s_mov_b32 s34, 65536
    s_mov_b32 s35, 0x00020000
    s_lshl_b32 s77, s68, 13
    v_mov_b32 v5, 115840
    v_mov_b32 v6, 0
    ds_write_b32 v5, v6
    s_waitcnt lgkmcnt(0)
    s_barrier
    v_mov_b32 v8, 0x3f803f80
    v_mov_b32 v9, 0
    s_waitcnt vmcnt(0)
    v_dot2c_f32_bf16 v9, v64, v8
    v_dot2c_f32_bf16 v9, v65, v8
    v_dot2c_f32_bf16 v9, v66, v8
    v_dot2c_f32_bf16 v9, v67, v8
    s_nop 2
    v_add_f32_dpp v9, v9, v9 quad_perm:[1,0,3,2] row_mask:0xf bank_mask:0xf
    s_nop 1
    v_add_f32_dpp v9, v9, v9 quad_perm:[2,3,0,1] row_mask:0xf bank_mask:0xf
    s_nop 1
    v_add_f32_dpp v9, v9, v9 row_half_mirror row_mask:0xf bank_mask:0xf
    s_nop 1
    v_add_f32_dpp v9, v9, v9 row_mirror row_mask:0xf bank_mask:0xf
    v_mov_b32 v10, v9
    s_nop 1
    v_permlane16_swap_b32 v9, v10
    v_add_f32 v9, v9, v10
    v_mov_b32 v10, v9
    s_nop 1
    v_permlane32_swap_b32 v9, v10
    v_add_f32 v9, v9, v10
    v_mul_f32 v32, s73, v32
    v_mul_f32 v36, s73, v36
    v_mul_f32 v40, s73, v40
    v_mul_f32 v44, s73, v44
    v_mul_f32 v48, s73, v48
    v_mul_f32 v52, s73, v52
    v_mul_f32 v56, s73, v56
    v_mul_f32 v60, s73, v60
    v_mul_f32 v33, s73, v33
    v_mul_f32 v37, s73, v37
    v_mul_f32 v41, s73, v41
    v_mul_f32 v45, s73, v45
    v_mul_f32 v49, s73, v49
    v_mul_f32 v53, s73, v53
    v_mul_f32 v57, s73, v57
    v_mul_f32 v61, s73, v61
    v_fma_f32 v33, -v32, v32, v33
    v_fma_f32 v37, -v36, v36, v37
    v_fma_f32 v41, -v40, v40, v41
    v_fma_f32 v45, -v44, v44, v45
    v_fma_f32 v49, -v48, v48, v49
    v_fma_f32 v53, -v52, v52, v53
    v_fma_f32 v57, -v56, v56, v57
    v_fma_f32 v61, -v60, v60, v61
    v_max_f32 v33, 0, v33
    v_max_f32 v37, 0, v37
    v_max_f32 v41, 0, v41
    v_max_f32 v45, 0, v45
    v_max_f32 v49, 0, v49
    v_max_f32 v53, 0, v53
    v_max_f32 v57, 0, v57
    v_max_f32 v61, 0, v61
    v_cvt_pk_bf16_f32 v35, v32, v33
    v_cvt_pk_bf16_f32 v39, v36, v37
    v_cvt_pk_bf16_f32 v43, v40, v41
    v_cvt_pk_bf16_f32 v47, v44, v45
    v_cvt_pk_bf16_f32 v51, v48, v49
    v_cvt_pk_bf16_f32 v55, v52, v53
    v_cvt_pk_bf16_f32 v59, v56, v57
    v_cvt_pk_bf16_f32 v63, v60, v61
    v_lshlrev_b32 v32, 16, v35
    v_lshlrev_b32 v36, 16, v39
    v_lshlrev_b32 v40, 16, v43
    v_lshlrev_b32 v44, 16, v47
    v_lshlrev_b32 v48, 16, v51
    v_lshlrev_b32 v52, 16, v55
    v_lshlrev_b32 v56, 16, v59
    v_lshlrev_b32 v60, 16, v63
    v_and_b32 v33, s72, v35
    v_and_b32 v37, s72, v39
    v_and_b32 v41, s72, v43
    v_and_b32 v45, s72, v47
    v_and_b32 v49, s72, v51
    v_and_b32 v53, s72, v55
    v_and_b32 v57, s72, v59
    v_and_b32 v61, s72, v63
    v_add_f32 v33, s74, v33
    v_add_f32 v37, s74, v37
    v_add_f32 v41, s74, v41
    v_add_f32 v45, s74, v45
    v_add_f32 v49, s74, v49
    v_add_f32 v53, s74, v53
    v_add_f32 v57, s74, v57
    v_add_f32 v61, s74, v61
    v_cvt_pk_bf16_f32 v33, v33, v33
    v_cvt_pk_bf16_f32 v37, v37, v37
    v_cvt_pk_bf16_f32 v41, v41, v41
    v_cvt_pk_bf16_f32 v45, v45, v45
    v_cvt_pk_bf16_f32 v49, v49, v49
    v_cvt_pk_bf16_f32 v53, v53, v53
    v_cvt_pk_bf16_f32 v57, v57, v57
    v_cvt_pk_bf16_f32 v61, v61, v61
    v_lshlrev_b32 v33, 16, v33
    v_lshlrev_b32 v37, 16, v37
    v_lshlrev_b32 v41, 16, v41
    v_lshlrev_b32 v45, 16, v45
    v_lshlrev_b32 v49, 16, v49
    v_lshlrev_b32 v53, 16, v53
    v_lshlrev_b32 v57, 16, v57
    v_lshlrev_b32 v61, 16, v61
    v_sqrt_f32 v33, v33
    v_sqrt_f32 v37, v37
    v_sqrt_f32 v41, v41
    v_sqrt_f32 v45, v45
    v_sqrt_f32 v49, v49
    v_sqrt_f32 v53, v53
    v_sqrt_f32 v57, v57
    v_sqrt_f32 v61, v61
    v_cvt_pk_bf16_f32 v33, v33, v33
    v_cvt_pk_bf16_f32 v37, v37, v37
    v_cvt_pk_bf16_f32 v41, v41, v41
    v_cvt_pk_bf16_f32 v45, v45, v45
    v_cvt_pk_bf16_f32 v49, v49, v49
    v_cvt_pk_bf16_f32 v53, v53, v53
    v_cvt_pk_bf16_f32 v57, v57, v57
    v_cvt_pk_bf16_f32 v61, v61, v61
    v_lshlrev_b32 v33, 16, v33
    v_lshlrev_b32 v37, 16, v37
    v_lshlrev_b32 v41, 16, v41
    v_lshlrev_b32 v45, 16, v45
    v_lshlrev_b32 v49, 16, v49
    v_lshlrev_b32 v53, 16, v53
    v_lshlrev_b32 v57, 16, v57
    v_lshlrev_b32 v61, 16, v61
    v_rcp_f32 v33, v33
    v_rcp_f32 v37, v37
    v_rcp_f32 v41, v41
    v_rcp_f32 v45, v45
    v_rcp_f32 v49, v49
    v_rcp_f32 v53, v53
    v_rcp_f32 v57, v57
    v_rcp_f32 v61, v61
    v_fma_f32 v34, -v32, v9, v34
    v_fma_f32 v38, -v36, v9, v38
    v_fma_f32 v42, -v40, v9, v42
    v_fma_f32 v46, -v44, v9, v46
    v_fma_f32 v50, -v48, v9, v50
    v_fma_f32 v54, -v52, v9, v54
    v_fma_f32 v58, -v56, v9, v58
    v_fma_f32 v62, -v60, v9, v62
    v_mul_f32 v34, v34, v33
    v_mul_f32 v38, v38, v37
    v_mul_f32 v42, v42, v41
    v_mul_f32 v46, v46, v45
    v_mul_f32 v50, v50, v49
    v_mul_f32 v54, v54, v53
    v_mul_f32 v58, v58, v57
    v_mul_f32 v62, v62, v61
    v_cvt_pk_bf16_f32 v34, v34, v34
    v_cvt_pk_bf16_f32 v38, v38, v38
    v_cvt_pk_bf16_f32 v42, v42, v42
    v_cvt_pk_bf16_f32 v46, v46, v46
    v_cvt_pk_bf16_f32 v50, v50, v50
    v_cvt_pk_bf16_f32 v54, v54, v54
    v_cvt_pk_bf16_f32 v58, v58, v58
    v_cvt_pk_bf16_f32 v62, v62, v62
    v_lshlrev_b32 v34, 16, v34
    v_lshlrev_b32 v38, 16, v38
    v_lshlrev_b32 v42, 16, v42
    v_lshlrev_b32 v46, 16, v46
    v_lshlrev_b32 v50, 16, v50
    v_lshlrev_b32 v54, 16, v54
    v_lshlrev_b32 v58, 16, v58
    v_lshlrev_b32 v62, 16, v62
    v_ashrrev_i32 v35, 31, v34
    v_ashrrev_i32 v39, 31, v38
    v_ashrrev_i32 v43, 31, v42
    v_ashrrev_i32 v47, 31, v46
    v_ashrrev_i32 v51, 31, v50
    v_ashrrev_i32 v55, 31, v54
    v_ashrrev_i32 v59, 31, v58
    v_ashrrev_i32 v63, 31, v62
    v_or_b32 v35, 0x80000000, v35
    v_or_b32 v39, 0x80000000, v39
    v_or_b32 v43, 0x80000000, v43
    v_or_b32 v47, 0x80000000, v47
    v_or_b32 v51, 0x80000000, v51
    v_or_b32 v55, 0x80000000, v55
    v_or_b32 v59, 0x80000000, v59
    v_or_b32 v63, 0x80000000, v63
    v_xor_b32 v34, v34, v35
    v_xor_b32 v38, v38, v39
    v_xor_b32 v42, v42, v43
    v_xor_b32 v46, v46, v47
    v_xor_b32 v50, v50, v51
    v_xor_b32 v54, v54, v55
    v_xor_b32 v58, v58, v59
    v_xor_b32 v62, v62, v63
    v_sub_u32 v35, 2047, v0
    v_sub_u32 v39, 1791, v0
    v_sub_u32 v43, 1535, v0
    v_sub_u32 v47, 1279, v0
    v_sub_u32 v51, 1023, v0
    v_sub_u32 v55, 767, v0
    v_sub_u32 v59, 511, v0
    v_sub_u32 v63, 255, v0
    v_and_or_b32 v16, v34, s72, v35
    v_and_or_b32 v17, v38, s72, v39
    v_and_or_b32 v18, v42, s72, v43
    v_and_or_b32 v19, v46, s72, v47
    v_and_or_b32 v20, v50, s72, v51
    v_and_or_b32 v21, v54, s72, v55
    v_and_or_b32 v22, v58, s72, v59
    v_and_or_b32 v23, v62, s72, v63
    v_max_u32 v24, v16, v17
    v_min_u32 v17, v16, v17
    v_max_u32 v16, v18, v19
    v_min_u32 v19, v18, v19
    v_max_u32 v18, v20, v21
    v_min_u32 v21, v20, v21
    v_max_u32 v20, v22, v23
    v_min_u32 v23, v22, v23
    v_max_u32 v22, v24, v16
    v_min_u32 v16, v24, v16
    v_max_u32 v24, v17, v19
    v_min_u32 v19, v17, v19
    v_max_u32 v17, v18, v20
    v_min_u32 v20, v18, v20
    v_max_u32 v18, v21, v23
    v_min_u32 v23, v21, v23
    v_max_u32 v21, v24, v16
    v_min_u32 v16, v24, v16
    v_max_u32 v24, v18, v20
    v_min_u32 v20, v18, v20
    v_max_u32 v18, v22, v17
    v_min_u32 v17, v22, v17
    v_max_u32 v22, v19, v23
    v_min_u32 v23, v19, v23
    v_max_u32 v19, v21, v24
    v_min_u32 v24, v21, v24
    v_max_u32 v21, v16, v20
    v_min_u32 v20, v16, v20
    v_max_u32 v16, v19, v17
    v_min_u32 v17, v19, v17
    v_max_u32 v19, v22, v20
    v_min_u32 v20, v22, v20
    v_max_u32 v22, v21, v17
    v_min_u32 v17, v21, v17
    v_max_u32 v21, v19, v24
    v_min_u32 v24, v19, v24
    v_max_u32 v19, v21, v17
    v_min_u32 v17, v21, v17
    v_mov_b32 v26, 0
    v_max_u32_dpp v25, v18, v18 quad_perm:[1,0,3,2] row_mask:0xf bank_mask:0xf
    s_nop 1
    v_max_u32_dpp v25, v25, v25 quad_perm:[2,3,0,1] row_mask:0xf bank_mask:0xf
    s_nop 1
    v_max_u32_dpp v25, v25, v25 row_half_mirror row_mask:0xf bank_mask:0xf
    s_nop 1
    v_max_u32_dpp v25, v25, v25 row_mirror row_mask:0xf bank_mask:0xf
    s_nop 1
    v_max_u32_dpp v25, v25, v25 row_bcast:15 row_mask:0xa bank_mask:0xf
    s_nop 1
    v_max_u32_dpp v25, v25, v25 row_bcast:31 row_mask:0xc bank_mask:0xf
    s_nop 0
    v_readlane_b32 s50, v25, 63
    s_nop 1
    v_writelane_b32 v26, s50, 0
    v_cmp_eq_u32 vcc, s50, v18
    s_nop 1
    v_cndmask_b32 v18, v18, v16, vcc
    v_cndmask_b32 v16, v16, v22, vcc
    v_cndmask_b32 v22, v22, v19, vcc
    v_cndmask_b32 v19, v19, v17, vcc
    v_cndmask_b32 v17, v17, v24, vcc
    v_cndmask_b32 v24, v24, v20, vcc
    v_cndmask_b32 v20, v20, v23, vcc
    v_max_u32_dpp v25, v18, v18 quad_perm:[1,0,3,2] row_mask:0xf bank_mask:0xf
    s_nop 1
    v_max_u32_dpp v25, v25, v25 quad_perm:[2,3,0,1] row_mask:0xf bank_mask:0xf
    s_nop 1
    v_max_u32_dpp v25, v25, v25 row_half_mirror row_mask:0xf bank_mask:0xf
    s_nop 1
    v_max_u32_dpp v25, v25, v25 row_mirror row_mask:0xf bank_mask:0xf
    s_nop 1
    v_max_u32_dpp v25, v25, v25 row_bcast:15 row_mask:0xa bank_mask:0xf
    s_nop 1
    v_max_u32_dpp v25, v25, v25 row_bcast:31 row_mask:0xc bank_mask:0xf
    s_nop 0
    v_readlane_b32 s51, v25, 63
    s_nop 1
    v_writelane_b32 v26, s51, 1
    v_cmp_eq_u32 vcc, s51, v18
    s_nop 1
    v_cndmask_b32 v18, v18, v16, vcc
    v_cndmask_b32 v16, v16, v22, vcc
    v_cndmask_b32 v22, v22, v19, vcc
    v_cndmask_b32 v19, v19, v17, vcc
    v_cndmask_b32 v17, v17, v24, vcc
    v_cndmask_b32 v24, v24, v20, vcc
    v_max_u32_dpp v25, v18, v18 quad_perm:[1,0,3,2] row_mask:0xf bank_mask:0xf
    s_nop 1
    v_max_u32_dpp v25, v25, v25 quad_perm:[2,3,0,1] row_mask:0xf bank_mask:0xf
    s_nop 1
    v_max_u32_dpp v25, v25, v25 row_half_mirror row_mask:0xf bank_mask:0xf
    s_nop 1
    v_max_u32_dpp v25, v25, v25 row_mirror row_mask:0xf bank_mask:0xf
    s_nop 1
    v_max_u32_dpp v25, v25, v25 row_bcast:15 row_mask:0xa bank_mask:0xf
    s_nop 1
    v_max_u32_dpp v25, v25, v25 row_bcast:31 row_mask:0xc bank_mask:0xf
    s_nop 0
    v_readlane_b32 s52, v25, 63
    s_nop 1
    v_writelane_b32 v26, s52, 2
    v_cmp_eq_u32 vcc, s52, v18
    s_nop 1
    v_cndmask_b32 v18, v18, v16, vcc
    v_cndmask_b32 v16, v16, v22, vcc
    v_cndmask_b32 v22, v22, v19, vcc
    v_cndmask_b32 v19, v19, v17, vcc
    v_cndmask_b32 v17, v17, v24, vcc
    v_max_u32_dpp v25, v18, v18 quad_perm:[1,0,3,2] row_mask:0xf bank_mask:0xf
    s_nop 1
    v_max_u32_dpp v25, v25, v25 quad_perm:[2,3,0,1] row_mask:0xf bank_mask:0xf
    s_nop 1
    v_max_u32_dpp v25, v25, v25 row_half_mirror row_mask:0xf bank_mask:0xf
    s_nop 1
    v_max_u32_dpp v25, v25, v25 row_mirror row_mask:0xf bank_mask:0xf
    s_nop 1
    v_max_u32_dpp v25, v25, v25 row_bcast:15 row_mask:0xa bank_mask:0xf
    s_nop 1
    v_max_u32_dpp v25, v25, v25 row_bcast:31 row_mask:0xc bank_mask:0xf
    s_nop 0
    v_readlane_b32 s53, v25, 63
    s_nop 1
    v_writelane_b32 v26, s53, 3
    v_cmp_eq_u32 vcc, s53, v18
    s_nop 1
    v_cndmask_b32 v18, v18, v16, vcc
    v_cndmask_b32 v16, v16, v22, vcc
    v_cndmask_b32 v22, v22, v19, vcc
    v_cndmask_b32 v19, v19, v17, vcc
    v_max_u32_dpp v25, v18, v18 quad_perm:[1,0,3,2] row_mask:0xf bank_mask:0xf
    s_nop 1
    v_max_u32_dpp v25, v25, v25 quad_perm:[2,3,0,1] row_mask:0xf bank_mask:0xf
    s_nop 1
    v_max_u32_dpp v25, v25, v25 row_half_mirror row_mask:0xf bank_mask:0xf
    s_nop 1
    v_max_u32_dpp v25, v25, v25 row_mirror row_mask:0xf bank_mask:0xf
    s_nop 1
    v_max_u32_dpp v25, v25, v25 row_bcast:15 row_mask:0xa bank_mask:0xf
    s_nop 1
    v_max_u32_dpp v25, v25, v25 row_bcast:31 row_mask:0xc bank_mask:0xf
    s_nop 0
    v_readlane_b32 s54, v25, 63
    s_nop 1
    v_writelane_b32 v26, s54, 4
    v_cmp_eq_u32 vcc, s54, v18
    s_nop 1
    v_cndmask_b32 v18, v18, v16, vcc
    v_cndmask_b32 v16, v16, v22, vcc
    v_cndmask_b32 v22, v22, v19, vcc
    v_max_u32_dpp v25, v18, v18 quad_perm:[1,0,3,2] row_mask:0xf bank_mask:0xf
    s_nop 1
    v_max_u32_dpp v25, v25, v25 quad_perm:[2,3,0,1] row_mask:0xf bank_mask:0xf
    s_nop 1
    v_max_u32_dpp v25, v25, v25 row_half_mirror row_mask:0xf bank_mask:0xf
    s_nop 1
    v_max_u32_dpp v25, v25, v25 row_mirror row_mask:0xf bank_mask:0xf
    s_nop 1
    v_max_u32_dpp v25, v25, v25 row_bcast:15 row_mask:0xa bank_mask:0xf
    s_nop 1
    v_max_u32_dpp v25, v25, v25 row_bcast:31 row_mask:0xc bank_mask:0xf
    s_nop 0
    v_readlane_b32 s55, v25, 63
    s_nop 1
    v_writelane_b32 v26, s55, 5
    v_cmp_eq_u32 vcc, s55, v18
    s_nop 1
    v_cndmask_b32 v18, v18, v16, vcc
    v_cndmask_b32 v16, v16, v22, vcc
    s_nop 0
    v_max_u32_dpp v25, v18, v18 quad_perm:[1,0,3,2] row_mask:0xf bank_mask:0xf
    s_nop 1
    v_max_u32_dpp v25, v25, v25 quad_perm:[2,3,0,1] row_mask:0xf bank_mask:0xf
    s_nop 1
    v_max_u32_dpp v25, v25, v25 row_half_mirror row_mask:0xf bank_mask:0xf
    s_nop 1
    v_max_u32_dpp v25, v25, v25 row_mirror row_mask:0xf bank_mask:0xf
    s_nop 1
    v_max_u32_dpp v25, v25, v25 row_bcast:15 row_mask:0xa bank_mask:0xf
    s_nop 1
    v_max_u32_dpp v25, v25, v25 row_bcast:31 row_mask:0xc bank_mask:0xf
    s_nop 0
    v_readlane_b32 s56, v25, 63
    s_nop 1
    v_writelane_b32 v26, s56, 6
    v_cmp_eq_u32 vcc, s56, v18
    s_nop 1
    v_cndmask_b32 v18, v18, v16, vcc
    s_nop 1
    v_max_u32_dpp v25, v18, v18 quad_perm:[1,0,3,2] row_mask:0xf bank_mask:0xf
    s_nop 1
    v_max_u32_dpp v25, v25, v25 quad_perm:[2,3,0,1] row_mask:0xf bank_mask:0xf
    s_nop 1
    v_max_u32_dpp v25, v25, v25 row_half_mirror row_mask:0xf bank_mask:0xf
    s_nop 1
    v_max_u32_dpp v25, v25, v25 row_mirror row_mask:0xf bank_mask:0xf
    s_nop 1
    v_max_u32_dpp v25, v25, v25 row_bcast:15 row_mask:0xa bank_mask:0xf
    s_nop 1
    v_max_u32_dpp v25, v25, v25 row_bcast:31 row_mask:0xc bank_mask:0xf
    s_nop 0
    v_readlane_b32 s57, v25, 63
    s_nop 1
    v_writelane_b32 v26, s57, 7
    s_lshl_b32 s40, s68, 5
    v_lshlrev_b32 v27, 2, v1
    v_add_u32 v27, s40, v27
    v_add_u32 v27, 98304, v27
    v_cmp_gt_u32 vcc, 8, v1
    s_nop 0
    s_and_saveexec_b64 s[48:49], vcc
    ds_write_b32 v27, v26 offset:16384
    s_mov_b64 exec, 1
    v_mov_b32 v6, 1
    ds_add_u32 v5, v6
    s_mov_b64 exec, s[48:49]
L_k4l2_poll:
    ds_read_b32 v6, v5
    s_waitcnt lgkmcnt(0)
    v_readfirstlane_b32 s40, v6
    s_nop 0
    s_cmp_lt_u32 s40, 4
    s_cbranch_scc1 L_k4l2_poll
    v_and_b32 v27, 31, v1
    v_lshlrev_b32 v27, 2, v27
    v_add_u32 v27, 98304, v27
    ds_read_b32 v28, v27 offset:16384
    v_mov_b32 v26, 0
    s_waitcnt lgkmcnt(0)
    v_max_u32_dpp v25, v28, v28 quad_perm:[1,0,3,2] row_mask:0xf bank_mask:0xf
    s_nop 1
    v_max_u32_dpp v25, v25, v25 quad_perm:[2,3,0,1] row_mask:0xf bank_mask:0xf
    s_nop 1
    v_max_u32_dpp v25, v25, v25 row_half_mirror row_mask:0xf bank_mask:0xf
    s_nop 1
    v_max_u32_dpp v25, v25, v25 row_mirror row_mask:0xf bank_mask:0xf
    s_nop 1
    v_max_u32_dpp v25, v25, v25 row_bcast:15 row_mask:0xa bank_mask:0xf
    s_nop 1
    v_max_u32_dpp v25, v25, v25 row_bcast:31 row_mask:0xc bank_mask:0xf
    s_nop 0
    v_readlane_b32 s58, v25, 63
    s_nop 1
    v_writelane_b32 v26, s58, 0
    v_cmp_eq_u32 vcc, s58, v28
    s_nop 1
    v_cndmask_b32 v28, v28, 0, vcc
    s_nop 1
    v_max_u32_dpp v25, v28, v28 quad_perm:[1,0,3,2] row_mask:0xf bank_mask:0xf
    s_nop 1
    v_max_u32_dpp v25, v25, v25 quad_perm:[2,3,0,1] row_mask:0xf bank_mask:0xf
    s_nop 1
    v_max_u32_dpp v25, v25, v25 row_half_mirror row_mask:0xf bank_mask:0xf
    s_nop 1
    v_max_u32_dpp v25, v25, v25 row_mirror row_mask:0xf bank_mask:0xf
    s_nop 1
    v_max_u32_dpp v25, v25, v25 row_bcast:15 row_mask:0xa bank_mask:0xf
    s_nop 1
    v_max_u32_dpp v25, v25, v25 row_bcast:31 row_mask:0xc bank_mask:0xf
    s_nop 0
    v_readlane_b32 s59, v25, 63
    s_nop 1
    v_writelane_b32 v26, s59, 1
    v_cmp_eq_u32 vcc, s59, v28
    s_nop 1
    v_cndmask_b32 v28, v28, 0, vcc
    s_nop 1
    v_max_u32_dpp v25, v28, v28 quad_perm:[1,0,3,2] row_mask:0xf bank_mask:0xf
    s_nop 1
    v_max_u32_dpp v25, v25, v25 quad_perm:[2,3,0,1] row_mask:0xf bank_mask:0xf
    s_nop 1
    v_max_u32_dpp v25, v25, v25 row_half_mirror row_mask:0xf bank_mask:0xf
    s_nop 1
    v_max_u32_dpp v25, v25, v25 row_mirror row_mask:0xf bank_mask:0xf
    s_nop 1
    v_max_u32_dpp v25, v25, v25 row_bcast:15 row_mask:0xa bank_mask:0xf
    s_nop 1
    v_max_u32_dpp v25, v25, v25 row_bcast:31 row_mask:0xc bank_mask:0xf
    s_nop 0
    v_readlane_b32 s60, v25, 63
    s_nop 1
    v_writelane_b32 v26, s60, 2
    v_cmp_eq_u32 vcc, s60, v28
    s_nop 1
    v_cndmask_b32 v28, v28, 0, vcc
    s_nop 1
    v_max_u32_dpp v25, v28, v28 quad_perm:[1,0,3,2] row_mask:0xf bank_mask:0xf
    s_nop 1
    v_max_u32_dpp v25, v25, v25 quad_perm:[2,3,0,1] row_mask:0xf bank_mask:0xf
    s_nop 1
    v_max_u32_dpp v25, v25, v25 row_half_mirror row_mask:0xf bank_mask:0xf
    s_nop 1
    v_max_u32_dpp v25, v25, v25 row_mirror row_mask:0xf bank_mask:0xf
    s_nop 1
    v_max_u32_dpp v25, v25, v25 row_bcast:15 row_mask:0xa bank_mask:0xf
    s_nop 1
    v_max_u32_dpp v25, v25, v25 row_bcast:31 row_mask:0xc bank_mask:0xf
    s_nop 0
    v_readlane_b32 s61, v25, 63
    s_nop 1
    v_writelane_b32 v26, s61, 3
    v_cmp_eq_u32 vcc, s61, v28
    s_nop 1
    v_cndmask_b32 v28, v28, 0, vcc
    s_nop 1
    v_max_u32_dpp v25, v28, v28 quad_perm:[1,0,3,2] row_mask:0xf bank_mask:0xf
    s_nop 1
    v_max_u32_dpp v25, v25, v25 quad_perm:[2,3,0,1] row_mask:0xf bank_mask:0xf
    s_nop 1
    v_max_u32_dpp v25, v25, v25 row_half_mirror row_mask:0xf bank_mask:0xf
    s_nop 1
    v_max_u32_dpp v25, v25, v25 row_mirror row_mask:0xf bank_mask:0xf
    s_nop 1
    v_max_u32_dpp v25, v25, v25 row_bcast:15 row_mask:0xa bank_mask:0xf
    s_nop 1
    v_max_u32_dpp v25, v25, v25 row_bcast:31 row_mask:0xc bank_mask:0xf
    s_nop 0
    v_readlane_b32 s62, v25, 63
    s_nop 1
    v_writelane_b32 v26, s62, 4
    v_cmp_eq_u32 vcc, s62, v28
    s_nop 1
    v_cndmask_b32 v28, v28, 0, vcc
    s_nop 1
    v_max_u32_dpp v25, v28, v28 quad_perm:[1,0,3,2] row_mask:0xf bank_mask:0xf
    s_nop 1
    v_max_u32_dpp v25, v25, v25 quad_perm:[2,3,0,1] row_mask:0xf bank_mask:0xf
    s_nop 1
    v_max_u32_dpp v25, v25, v25 row_half_mirror row_mask:0xf bank_mask:0xf
    s_nop 1
    v_max_u32_dpp v25, v25, v25 row_mirror row_mask:0xf bank_mask:0xf
    s_nop 1
    v_max_u32_dpp v25, v25, v25 row_bcast:15 row_mask:0xa bank_mask:0xf
    s_nop 1
    v_max_u32_dpp v25, v25, v25 row_bcast:31 row_mask:0xc bank_mask:0xf
    s_nop 0
    v_readlane_b32 s63, v25, 63
    s_nop 1
    v_writelane_b32 v26, s63, 5
    v_cmp_eq_u32 vcc, s63, v28
    s_nop 1
    v_cndmask_b32 v28, v28, 0, vcc
    s_nop 1
    v_max_u32_dpp v25, v28, v28 quad_perm:[1,0,3,2] row_mask:0xf bank_mask:0xf
    s_nop 1
    v_max_u32_dpp v25, v25, v25 quad_perm:[2,3,0,1] row_mask:0xf bank_mask:0xf
    s_nop 1
    v_max_u32_dpp v25, v25, v25 row_half_mirror row_mask:0xf bank_mask:0xf
    s_nop 1
    v_max_u32_dpp v25, v25, v25 row_mirror row_mask:0xf bank_mask:0xf
    s_nop 1
    v_max_u32_dpp v25, v25, v25 row_bcast:15 row_mask:0xa bank_mask:0xf
    s_nop 1
    v_max_u32_dpp v25, v25, v25 row_bcast:31 row_mask:0xc bank_mask:0xf
    s_nop 0
    v_readlane_b32 s64, v25, 63
    s_nop 1
    v_writelane_b32 v26, s64, 6
    v_cmp_eq_u32 vcc, s64, v28
    s_nop 1
    v_cndmask_b32 v28, v28, 0, vcc
    s_nop 1
    v_max_u32_dpp v25, v28, v28 quad_perm:[1,0,3,2] row_mask:0xf bank_mask:0xf
    s_nop 1
    v_max_u32_dpp v25, v25, v25 quad_perm:[2,3,0,1] row_mask:0xf bank_mask:0xf
    s_nop 1
    v_max_u32_dpp v25, v25, v25 row_half_mirror row_mask:0xf bank_mask:0xf
    s_nop 1
    v_max_u32_dpp v25, v25, v25 row_mirror row_mask:0xf bank_mask:0xf
    s_nop 1
    v_max_u32_dpp v25, v25, v25 row_bcast:15 row_mask:0xa bank_mask:0xf
    s_nop 1
    v_max_u32_dpp v25, v25, v25 row_bcast:31 row_mask:0xc bank_mask:0xf
    s_nop 0
    v_readlane_b32 s65, v25, 63
    s_nop 1
    v_writelane_b32 v26, s65, 7
    v_and_b32 v27, 7, v1
    v_lshlrev_b32 v27, 2, v27
    ds_bpermute_b32 v28, v27, v26
    v_lshrrev_b32 v61, 4, v1
    s_or_b32 s40, s2, s68
    s_cmp_lg_u32 s40, 0
    s_cbranch_scc1 L_k4l2_nokeys
    v_lshlrev_b32 v27, 2, v1
    v_cmp_gt_u32 vcc, 8, v1
    s_nop 0
    s_and_saveexec_b64 s[48:49], vcc
    s_mov_b32 s40, 32768
    buffer_store_dword v26, v27, s[32:35], s40 offen
    s_mov_b64 exec, s[48:49]
L_k4l2_nokeys:
    s_waitcnt lgkmcnt(0)
    v_and_b32 v28, 0x7ff, v28
    v_sub_u32 v28, 2047, v28
    v_lshlrev_b32 v29, 10, v28
    v_lshl_add_u32 v29, v61, 4, v29
    s_lshl_b32 s40, s68, 8
    v_lshlrev_b32 v30, 4, v28
    buffer_load_dwordx2 v[14:15], v30, s[24:27], 0 offen
    buffer_load_dwordx4 v[32:35], v29, s[12:15], s40 offen offset:0
    buffer_load_dwordx4 v[36:39], v29, s[12:15], s40 offen offset:64
    buffer_load_dwordx4 v[40:43], v29, s[12:15], s40 offen offset:128
    buffer_load_dwordx4 v[44:47], v29, s[12:15], s40 offen offset:192
    v_bfe_u32 v62, v1, 2, 2
    v_lshl_add_u32 v62, v61, 3, v62
    v_lshlrev_b32 v62, 6, v62
    v_and_b32 v63, 1, v61
    v_lshl_add_u32 v62, v63, 5, v62
    v_and_b32 v63, 3, v1
    v_lshl_add_u32 v62, v63, 3, v62
    v_add_u32 v62, s77, v62
    v_xor_b32 v63, 32, v62
    s_barrier
    ds_read_b64_tr_b16 v[64:65], v62 offset:0
    ds_read_b64_tr_b16 v[66:67], v62 offset:256
    ds_read_b64_tr_b16 v[80:81], v63 offset:0
    ds_read_b64_tr_b16 v[82:83], v63 offset:256
    ds_read_b64_tr_b16 v[96:97], v62 offset:32768
    ds_read_b64_tr_b16 v[98:99], v62 offset:33024
    ds_read_b64_tr_b16 v[112:113], v63 offset:32768
    ds_read_b64_tr_b16 v[114:115], v63 offset:33024
    ds_read_b64_tr_b16 v[68:69], v62 offset:2048
    ds_read_b64_tr_b16 v[70:71], v62 offset:2304
    ds_read_b64_tr_b16 v[84:85], v63 offset:2048
    ds_read_b64_tr_b16 v[86:87], v63 offset:2304
    s_waitcnt lgkmcnt(10)
    ds_read_b64_tr_b16 v[100:101], v62 offset:34816
    ds_read_b64_tr_b16 v[102:103], v62 offset:35072
    s_waitcnt lgkmcnt(10)
    ds_read_b64_tr_b16 v[116:117], v63 offset:34816
    ds_read_b64_tr_b16 v[118:119], v63 offset:35072
    s_waitcnt lgkmcnt(10)
    ds_read_b64_tr_b16 v[72:73], v62 offset:4096
    ds_read_b64_tr_b16 v[74:75], v62 offset:4352
    s_waitcnt lgkmcnt(10)
    ds_read_b64_tr_b16 v[88:89], v63 offset:4096
    ds_read_b64_tr_b16 v[90:91], v63 offset:4352
    s_waitcnt lgkmcnt(10)
    ds_read_b64_tr_b16 v[104:105], v62 offset:36864
    ds_read_b64_tr_b16 v[106:107], v62 offset:37120
    s_waitcnt lgkmcnt(10)
    ds_read_b64_tr_b16 v[120:121], v63 offset:36864
    ds_read_b64_tr_b16 v[122:123], v63 offset:37120
    s_waitcnt lgkmcnt(10)
    ds_read_b64_tr_b16 v[76:77], v62 offset:6144
    ds_read_b64_tr_b16 v[78:79], v62 offset:6400
    s_waitcnt lgkmcnt(10)
    ds_read_b64_tr_b16 v[92:93], v63 offset:6144
    ds_read_b64_tr_b16 v[94:95], v63 offset:6400
    s_waitcnt lgkmcnt(10)
    ds_read_b64_tr_b16 v[108:109], v62 offset:38912
    ds_read_b64_tr_b16 v[110:111], v62 offset:39168
    s_waitcnt lgkmcnt(10)
    ds_read_b64_tr_b16 v[124:125], v63 offset:38912
    ds_read_b64_tr_b16 v[126:127], v63 offset:39168
    s_waitcnt vmcnt(4)
    v_mul_f32 v12, s73, v14
    v_mul_f32 v13, s73, v15
    v_fma_f32 v13, -v12, v12, v13
    v_max_f32 v13, 0, v13
    v_cvt_pk_bf16_f32 v12, v12, v13
    v_lshlrev_b32 v10, 16, v12
    v_and_b32 v13, s72, v12
    v_add_f32 v13, s74, v13
    v_cvt_pk_bf16_f32 v13, v13, v13
    v_lshlrev_b32 v13, 16, v13
    v_sqrt_f32 v13, v13
    s_nop 0
    v_cvt_pk_bf16_f32 v13, v13, v13
    v_lshlrev_b32 v13, 16, v13
    v_rcp_f32 v11, v13
    s_waitcnt vmcnt(0)
    v_lshlrev_b32 v12, 16, v32
    v_and_b32 v13, s72, v32
    v_sub_f32 v12, v12, v10
    v_sub_f32 v13, v13, v10
    v_cvt_pk_bf16_f32 v12, v12, v13
    v_and_b32 v13, s72, v12
    v_lshlrev_b32 v12, 16, v12
    v_mul_f32 v12, v12, v11
    v_mul_f32 v13, v13, v11
    v_cvt_pk_bf16_f32 v32, v12, v13
    v_lshlrev_b32 v12, 16, v33
    v_and_b32 v13, s72, v33
    v_sub_f32 v12, v12, v10
    v_sub_f32 v13, v13, v10
    v_cvt_pk_bf16_f32 v12, v12, v13
    v_and_b32 v13, s72, v12
    v_lshlrev_b32 v12, 16, v12
    v_mul_f32 v12, v12, v11
    v_mul_f32 v13, v13, v11
    v_cvt_pk_bf16_f32 v33, v12, v13
    v_lshlrev_b32 v12, 16, v34
    v_and_b32 v13, s72, v34
    v_sub_f32 v12, v12, v10
    v_sub_f32 v13, v13, v10
    v_cvt_pk_bf16_f32 v12, v12, v13
    v_and_b32 v13, s72, v12
    v_lshlrev_b32 v12, 16, v12
    v_mul_f32 v12, v12, v11
    v_mul_f32 v13, v13, v11
    v_cvt_pk_bf16_f32 v34, v12, v13
    v_lshlrev_b32 v12, 16, v35
    v_and_b32 v13, s72, v35
    v_sub_f32 v12, v12, v10
    v_sub_f32 v13, v13, v10
    v_cvt_pk_bf16_f32 v12, v12, v13
    v_and_b32 v13, s72, v12
    v_lshlrev_b32 v12, 16, v12
    v_mul_f32 v12, v12, v11
    v_mul_f32 v13, v13, v11
    v_cvt_pk_bf16_f32 v35, v12, v13
    v_lshlrev_b32 v12, 16, v36
    v_and_b32 v13, s72, v36
    v_sub_f32 v12, v12, v10
    v_sub_f32 v13, v13, v10
    v_cvt_pk_bf16_f32 v12, v12, v13
    v_and_b32 v13, s72, v12
    v_lshlrev_b32 v12, 16, v12
    v_mul_f32 v12, v12, v11
    v_mul_f32 v13, v13, v11
    v_cvt_pk_bf16_f32 v36, v12, v13
    v_lshlrev_b32 v12, 16, v37
    v_and_b32 v13, s72, v37
    v_sub_f32 v12, v12, v10
    v_sub_f32 v13, v13, v10
    v_cvt_pk_bf16_f32 v12, v12, v13
    v_and_b32 v13, s72, v12
    v_lshlrev_b32 v12, 16, v12
    v_mul_f32 v12, v12, v11
    v_mul_f32 v13, v13, v11
    v_cvt_pk_bf16_f32 v37, v12, v13
    v_lshlrev_b32 v12, 16, v38
    v_and_b32 v13, s72, v38
    v_sub_f32 v12, v12, v10
    v_sub_f32 v13, v13, v10
    v_cvt_pk_bf16_f32 v12, v12, v13
    v_and_b32 v13, s72, v12
    v_lshlrev_b32 v12, 16, v12
    v_mul_f32 v12, v12, v11
    v_mul_f32 v13, v13, v11
    v_cvt_pk_bf16_f32 v38, v12, v13
    v_lshlrev_b32 v12, 16, v39
    v_and_b32 v13, s72, v39
    v_sub_f32 v12, v12, v10
    v_sub_f32 v13, v13, v10
    v_cvt_pk_bf16_f32 v12, v12, v13
    v_and_b32 v13, s72, v12
    v_lshlrev_b32 v12, 16, v12
    v_mul_f32 v12, v12, v11
    v_mul_f32 v13, v13, v11
    v_cvt_pk_bf16_f32 v39, v12, v13
    v_lshlrev_b32 v12, 16, v40
    v_and_b32 v13, s72, v40
    v_sub_f32 v12, v12, v10
    v_sub_f32 v13, v13, v10
    v_cvt_pk_bf16_f32 v12, v12, v13
    v_and_b32 v13, s72, v12
    v_lshlrev_b32 v12, 16, v12
    v_mul_f32 v12, v12, v11
    v_mul_f32 v13, v13, v11
    v_cvt_pk_bf16_f32 v40, v12, v13
    v_lshlrev_b32 v12, 16, v41
    v_and_b32 v13, s72, v41
    v_sub_f32 v12, v12, v10
    v_sub_f32 v13, v13, v10
    v_cvt_pk_bf16_f32 v12, v12, v13
    v_and_b32 v13, s72, v12
    v_lshlrev_b32 v12, 16, v12
    v_mul_f32 v12, v12, v11
    v_mul_f32 v13, v13, v11
    v_cvt_pk_bf16_f32 v41, v12, v13
    v_lshlrev_b32 v12, 16, v42
    v_and_b32 v13, s72, v42
    v_sub_f32 v12, v12, v10
    v_sub_f32 v13, v13, v10
    v_cvt_pk_bf16_f32 v12, v12, v13
    v_and_b32 v13, s72, v12
    v_lshlrev_b32 v12, 16, v12
    v_mul_f32 v12, v12, v11
    v_mul_f32 v13, v13, v11
    v_cvt_pk_bf16_f32 v42, v12, v13
    v_lshlrev_b32 v12, 16, v43
    v_and_b32 v13, s72, v43
    v_sub_f32 v12, v12, v10
    v_sub_f32 v13, v13, v10
    v_cvt_pk_bf16_f32 v12, v12, v13
    v_and_b32 v13, s72, v12
    v_lshlrev_b32 v12, 16, v12
    v_mul_f32 v12, v12, v11
    v_mul_f32 v13, v13, v11
    v_cvt_pk_bf16_f32 v43, v12, v13
    v_lshlrev_b32 v12, 16, v44
    v_and_b32 v13, s72, v44
    v_sub_f32 v12, v12, v10
    v_sub_f32 v13, v13, v10
    v_cvt_pk_bf16_f32 v12, v12, v13
    v_and_b32 v13, s72, v12
    v_lshlrev_b32 v12, 16, v12
    v_mul_f32 v12, v12, v11
    v_mul_f32 v13, v13, v11
    v_cvt_pk_bf16_f32 v44, v12, v13
    v_lshlrev_b32 v12, 16, v45
    v_and_b32 v13, s72, v45
    v_sub_f32 v12, v12, v10
    v_sub_f32 v13, v13, v10
    v_cvt_pk_bf16_f32 v12, v12, v13
    v_and_b32 v13, s72, v12
    v_lshlrev_b32 v12, 16, v12
    v_mul_f32 v12, v12, v11
    v_mul_f32 v13, v13, v11
    v_cvt_pk_bf16_f32 v45, v12, v13
    v_lshlrev_b32 v12, 16, v46
    v_and_b32 v13, s72, v46
    v_sub_f32 v12, v12, v10
    v_sub_f32 v13, v13, v10
    v_cvt_pk_bf16_f32 v12, v12, v13
    v_and_b32 v13, s72, v12
    v_lshlrev_b32 v12, 16, v12
    v_mul_f32 v12, v12, v11
    v_mul_f32 v13, v13, v11
    v_cvt_pk_bf16_f32 v46, v12, v13
    v_lshlrev_b32 v12, 16, v47
    v_and_b32 v13, s72, v47
    v_sub_f32 v12, v12, v10
    v_sub_f32 v13, v13, v10
    v_cvt_pk_bf16_f32 v12, v12, v13
    v_and_b32 v13, s72, v12
    v_lshlrev_b32 v12, 16, v12
    v_mul_f32 v12, v12, v11
    v_mul_f32 v13, v13, v11
    v_cvt_pk_bf16_f32 v47, v12, v13
    v_mov_b32 v16, 0
    v_mov_b32 v17, 0
    v_mov_b32 v18, 0
    v_mov_b32 v19, 0
    v_mov_b32 v20, 0
    v_mov_b32 v21, 0
    v_mov_b32 v22, 0
    v_mov_b32 v23, 0
    v_mov_b32 v24, 0
    v_mov_b32 v25, 0
    v_mov_b32 v26, 0
    v_mov_b32 v27, 0
    v_mov_b32 v28, 0
    v_mov_b32 v29, 0
    v_mov_b32 v30, 0
    v_mov_b32 v31, 0
    s_waitcnt lgkmcnt(0)
    v_mfma_f32_16x16x32_bf16 v[16:19], v[64:67], v[32:35], v[16:19]
    v_mfma_f32_16x16x32_bf16 v[20:23], v[80:83], v[32:35], v[20:23]
    v_mfma_f32_16x16x32_bf16 v[24:27], v[96:99], v[32:35], v[24:27]
    v_mfma_f32_16x16x32_bf16 v[28:31], v[112:115], v[32:35], v[28:31]
    v_mfma_f32_16x16x32_bf16 v[16:19], v[68:71], v[36:39], v[16:19]
    v_mfma_f32_16x16x32_bf16 v[20:23], v[84:87], v[36:39], v[20:23]
    v_mfma_f32_16x16x32_bf16 v[24:27], v[100:103], v[36:39], v[24:27]
    v_mfma_f32_16x16x32_bf16 v[28:31], v[116:119], v[36:39], v[28:31]
    v_mfma_f32_16x16x32_bf16 v[16:19], v[72:75], v[40:43], v[16:19]
    v_mfma_f32_16x16x32_bf16 v[20:23], v[88:91], v[40:43], v[20:23]
    v_mfma_f32_16x16x32_bf16 v[24:27], v[104:107], v[40:43], v[24:27]
    v_mfma_f32_16x16x32_bf16 v[28:31], v[120:123], v[40:43], v[28:31]
    v_mfma_f32_16x16x32_bf16 v[16:19], v[76:79], v[44:47], v[16:19]
    v_mfma_f32_16x16x32_bf16 v[20:23], v[92:95], v[44:47], v[20:23]
    v_mfma_f32_16x16x32_bf16 v[24:27], v[108:111], v[44:47], v[24:27]
    v_mfma_f32_16x16x32_bf16 v[28:31], v[124:127], v[44:47], v[28:31]
    v_bfe_u32 v60, v1, 2, 2
    v_lshl_add_u32 v36, v61, 3, v60
    v_lshlrev_b32 v36, 10, v36
    v_and_b32 v37, 3, v1
    v_lshl_add_u32 v36, v37, 3, v36
    v_add_u32 v36, 65536, v36
    v_and_b32 v37, 1, v61
    v_lshl_or_b32 v60, v37, 2, v60
    s_lshl_b32 s40, s68, 8
    v_add_u32 v36, s40, v36
    v_xor_b32 v37, 0, v60
    v_lshl_add_u32 v40, v37, 5, v36
    v_xor_b32 v37, 1, v60
    v_lshl_add_u32 v41, v37, 5, v36
    v_xor_b32 v37, 2, v60
    v_lshl_add_u32 v42, v37, 5, v36
    v_xor_b32 v37, 3, v60
    v_lshl_add_u32 v43, v37, 5, v36
    v_xor_b32 v37, 4, v60
    v_lshl_add_u32 v44, v37, 5, v36
    v_xor_b32 v37, 5, v60
    v_lshl_add_u32 v45, v37, 5, v36
    v_xor_b32 v37, 6, v60
    v_lshl_add_u32 v46, v37, 5, v36
    v_xor_b32 v37, 7, v60
    v_lshl_add_u32 v47, v37, 5, v36
    ds_read_b64_tr_b16 v[96:97], v40
    ds_read_b64_tr_b16 v[98:99], v40 offset:4096
    ds_read_b64_tr_b16 v[100:101], v41
    ds_read_b64_tr_b16 v[102:103], v41 offset:4096
    ds_read_b64_tr_b16 v[104:105], v42
    ds_read_b64_tr_b16 v[106:107], v42 offset:4096
    ds_read_b64_tr_b16 v[108:109], v43
    ds_read_b64_tr_b16 v[110:111], v43 offset:4096
    ds_read_b64_tr_b16 v[112:113], v44
    ds_read_b64_tr_b16 v[114:115], v44 offset:4096
    ds_read_b64_tr_b16 v[116:117], v45
    ds_read_b64_tr_b16 v[118:119], v45 offset:4096
    ds_read_b64_tr_b16 v[120:121], v46
    ds_read_b64_tr_b16 v[122:123], v46 offset:4096
    s_waitcnt lgkmcnt(8)
    ds_read_b64_tr_b16 v[124:125], v47
    ds_read_b64_tr_b16 v[126:127], v47 offset:4096
    s_lshl_b32 s40, s68, 12
    v_lshlrev_b32 v56, 4, v1
    v_add_u32 v56, 98304, v56
    v_add_u32 v57, s40, v56
    ds_write_b128 v57, v[16:19] offset:0
    ds_write_b128 v57, v[20:23] offset:1024
    ds_write_b128 v57, v[24:27] offset:2048
    ds_write_b128 v57, v[28:31] offset:3072
    s_waitcnt lgkmcnt(0)
    s_barrier
    s_cmp_ge_u32 s68, 2
    s_cbranch_scc1 L_k4l2_skiph
    s_lshl_b32 s40, s68, 10
    v_add_u32 v57, s40, v56
    ds_read_b128 v[64:67], v57 offset:0
    ds_read_b128 v[68:71], v57 offset:2048
    ds_read_b128 v[72:75], v57 offset:4096
    ds_read_b128 v[76:79], v57 offset:6144
    ds_read_b128 v[80:83], v57 offset:8192
    ds_read_b128 v[84:87], v57 offset:10240
    ds_read_b128 v[88:91], v57 offset:12288
    ds_read_b128 v[92:95], v57 offset:14336
    s_waitcnt lgkmcnt(0)
    v_add_f32 v64, v64, v72
    v_add_f32 v80, v80, v88
    v_add_f32 v65, v65, v73
    v_add_f32 v81, v81, v89
    v_add_f32 v66, v66, v74
    v_add_f32 v82, v82, v90
    v_add_f32 v67, v67, v75
    v_add_f32 v83, v83, v91
    v_add_f32 v68, v68, v76
    v_add_f32 v84, v84, v92
    v_add_f32 v69, v69, v77
    v_add_f32 v85, v85, v93
    v_add_f32 v70, v70, v78
    v_add_f32 v86, v86, v94
    v_add_f32 v71, v71, v79
    v_add_f32 v87, v87, v95
    v_add_f32 v64, v64, v80
    v_add_f32 v65, v65, v81
    v_add_f32 v66, v66, v82
    v_add_f32 v67, v67, v83
    v_add_f32 v68, v68, v84
    v_add_f32 v69, v69, v85
    v_add_f32 v70, v70, v86
    v_add_f32 v71, v71, v87
    v_cvt_pk_bf16_f32 v72, v64, v65
    v_lshlrev_b32 v64, 16, v72
    v_and_b32 v65, s72, v72
    v_cvt_pk_bf16_f32 v72, v66, v67
    v_lshlrev_b32 v66, 16, v72
    v_and_b32 v67, s72, v72
    v_cvt_pk_bf16_f32 v72, v68, v69
    v_lshlrev_b32 v68, 16, v72
    v_and_b32 v69, s72, v72
    v_cvt_pk_bf16_f32 v72, v70, v71
    v_lshlrev_b32 v70, 16, v72
    v_and_b32 v71, s72, v72
    s_mov_b32 s40, 0xbfb8aa3b
    v_mul_f32 v72, s40, v64
    v_mul_f32 v73, s40, v65
    v_mul_f32 v74, s40, v66
    v_mul_f32 v75, s40, v67
    v_exp_f32 v72, v72
    v_exp_f32 v73, v73
    v_exp_f32 v74, v74
    v_exp_f32 v75, v75
    v_add_f32 v72, 1.0, v72
    v_add_f32 v73, 1.0, v73
    v_add_f32 v74, 1.0, v74
    v_add_f32 v75, 1.0, v75
    v_rcp_f32 v72, v72
    v_rcp_f32 v73, v73
    v_rcp_f32 v74, v74
    v_rcp_f32 v75, v75
    v_mul_f32 v64, v64, v72
    v_mul_f32 v65, v65, v73
    v_mul_f32 v66, v66, v74
    v_mul_f32 v67, v67, v75
    v_cvt_pk_bf16_f32 v72, v64, v65
    v_lshlrev_b32 v64, 16, v72
    v_and_b32 v65, s72, v72
    v_cvt_pk_bf16_f32 v72, v66, v67
    v_lshlrev_b32 v66, 16, v72
    v_and_b32 v67, s72, v72
    v_mul_f32 v64, v64, v68
    v_mul_f32 v65, v65, v69
    v_mul_f32 v66, v66, v70
    v_mul_f32 v67, v67, v71
    v_cvt_pk_bf16_f32 v76, v64, v65
    v_cvt_pk_bf16_f32 v77, v66, v67
    v_and_b32 v58, 15, v1
    v_lshlrev_b32 v58, 6, v58
    v_lshl_add_u32 v58, v61, 3, v58
    s_lshl_b32 s40, s68, 5
    v_add_u32 v58, s40, v58
    v_add_u32 v58, 98304, v58
    ds_write_b64 v58, v[76:77] offset:16512
L_k4l2_skiph:
    s_waitcnt lgkmcnt(0)
    s_barrier
    v_and_b32 v58, 15, v1
    v_lshlrev_b32 v59, 6, v58
    v_lshl_add_u32 v59, v61, 4, v59
    v_add_u32 v59, 98304, v59
    ds_read_b128 v[32:35], v59 offset:16512
    s_add_u32 s36, s4, 9437184
    s_addc_u32 s37, s5, 0
    s_and_b32 s37, s37, 0xffff
    s_mov_b32 s38, 917504
    s_mov_b32 s39, 0x00020000
    v_lshlrev_b32 v38, 11, v58
    v_lshl_add_u32 v38, v61, 4, v38
    s_lshl_b32 s40, s69, 14
    s_lshl_b32 s41, s68, 9
    s_add_u32 s40, s40, s41
    v_add_u32 v38, s40, v38
    s_waitcnt lgkmcnt(0)
    v_mfma_f32_16x16x32_bf16 v[64:67], v[96:99], v[32:35], 0
    v_mfma_f32_16x16x32_bf16 v[68:71], v[100:103], v[32:35], 0
    v_mfma_f32_16x16x32_bf16 v[72:75], v[104:107], v[32:35], 0
    v_mfma_f32_16x16x32_bf16 v[76:79], v[108:111], v[32:35], 0
    v_mfma_f32_16x16x32_bf16 v[80:83], v[112:115], v[32:35], 0
    v_mfma_f32_16x16x32_bf16 v[84:87], v[116:119], v[32:35], 0
    v_mfma_f32_16x16x32_bf16 v[88:91], v[120:123], v[32:35], 0
    v_mfma_f32_16x16x32_bf16 v[92:95], v[124:127], v[32:35], 0
    v_cmp_gt_u32 vcc, 8, v58
    s_nop 0
    s_and_saveexec_b64 s[48:49], vcc
    buffer_store_dwordx4 v[64:67], v38, s[36:39], 0 offen offset:0
    buffer_store_dwordx4 v[68:71], v38, s[36:39], 0 offen offset:64
    buffer_store_dwordx4 v[72:75], v38, s[36:39], 0 offen offset:128
    buffer_store_dwordx4 v[76:79], v38, s[36:39], 0 offen offset:192
    buffer_store_dwordx4 v[80:83], v38, s[36:39], 0 offen offset:256
    buffer_store_dwordx4 v[84:87], v38, s[36:39], 0 offen offset:320
    buffer_store_dwordx4 v[88:91], v38, s[36:39], 0 offen offset:384
    buffer_store_dwordx4 v[92:95], v38, s[36:39], 0 offen offset:448
    s_mov_b64 exec, s[48:49]
    s_branch L_k4l2_done
L_k4l2_ln:
    s_mov_b32 s36, s70
    s_and_b32 s37, s71, 0xffff
    s_mov_b32 s38, 2097152
    s_mov_b32 s39, 0x00020000
    s_sub_u32 s40, s2, 56
    s_lshl_b32 s40, s40, 4
    v_lshrrev_b32 v2, 5, v0
    v_add_u32 v2, s40, v2
    v_lshlrev_b32 v3, 4, v2
    buffer_load_dwordx2 v[14:15], v3, s[24:27], 0 offen
    v_and_b32 v4, 31, v0
    v_lshlrev_b32 v3, 10, v2
    v_lshl_add_u32 v3, v4, 4, v3
    buffer_load_dwordx4 v[32:35], v3, s[12:15], 0 offen offset:0
    buffer_load_dwordx4 v[36:39], v3, s[12:15], 0 offen offset:512
    s_waitcnt vmcnt(2)
    v_mul_f32 v12, s73, v14
    v_mul_f32 v13, s73, v15
    v_fma_f32 v13, -v12, v12, v13
    v_max_f32 v13, 0, v13
    v_cvt_pk_bf16_f32 v12, v12, v13
    v_lshlrev_b32 v10, 16, v12
    v_and_b32 v13, s72, v12
    v_add_f32 v13, s74, v13
    v_cvt_pk_bf16_f32 v13, v13, v13
    v_lshlrev_b32 v13, 16, v13
    v_sqrt_f32 v13, v13
    s_nop 0
    v_cvt_pk_bf16_f32 v13, v13, v13
    v_lshlrev_b32 v13, 16, v13
    v_rcp_f32 v11, v13
    s_waitcnt vmcnt(1)
    v_lshlrev_b32 v12, 16, v32
    v_and_b32 v13, s72, v32
    v_sub_f32 v12, v12, v10
    v_sub_f32 v13, v13, v10
    v_cvt_pk_bf16_f32 v12, v12, v13
    v_and_b32 v13, s72, v12
    v_lshlrev_b32 v12, 16, v12
    v_mul_f32 v12, v12, v11
    v_mul_f32 v13, v13, v11
    v_cvt_pk_bf16_f32 v16, v12, v13
    v_lshlrev_b32 v12, 16, v32
    v_and_b32 v13, s72, v32
    v_lshlrev_b32 v17, 16, v16
    v_and_b32 v18, s72, v16
    v_add_f32 v12, v12, v17
    v_add_f32 v13, v13, v18
    v_cvt_pk_bf16_f32 v48, v12, v13
    v_lshlrev_b32 v12, 16, v33
    v_and_b32 v13, s72, v33
    v_sub_f32 v12, v12, v10
    v_sub_f32 v13, v13, v10
    v_cvt_pk_bf16_f32 v12, v12, v13
    v_and_b32 v13, s72, v12
    v_lshlrev_b32 v12, 16, v12
    v_mul_f32 v12, v12, v11
    v_mul_f32 v13, v13, v11
    v_cvt_pk_bf16_f32 v16, v12, v13
    v_lshlrev_b32 v12, 16, v33
    v_and_b32 v13, s72, v33
    v_lshlrev_b32 v17, 16, v16
    v_and_b32 v18, s72, v16
    v_add_f32 v12, v12, v17
    v_add_f32 v13, v13, v18
    v_cvt_pk_bf16_f32 v49, v12, v13
    v_lshlrev_b32 v12, 16, v34
    v_and_b32 v13, s72, v34
    v_sub_f32 v12, v12, v10
    v_sub_f32 v13, v13, v10
    v_cvt_pk_bf16_f32 v12, v12, v13
    v_and_b32 v13, s72, v12
    v_lshlrev_b32 v12, 16, v12
    v_mul_f32 v12, v12, v11
    v_mul_f32 v13, v13, v11
    v_cvt_pk_bf16_f32 v16, v12, v13
    v_lshlrev_b32 v12, 16, v34
    v_and_b32 v13, s72, v34
    v_lshlrev_b32 v17, 16, v16
    v_and_b32 v18, s72, v16
    v_add_f32 v12, v12, v17
    v_add_f32 v13, v13, v18
    v_cvt_pk_bf16_f32 v50, v12, v13
    v_lshlrev_b32 v12, 16, v35
    v_and_b32 v13, s72, v35
    v_sub_f32 v12, v12, v10
    v_sub_f32 v13, v13, v10
    v_cvt_pk_bf16_f32 v12, v12, v13
    v_and_b32 v13, s72, v12
    v_lshlrev_b32 v12, 16, v12
    v_mul_f32 v12, v12, v11
    v_mul_f32 v13, v13, v11
    v_cvt_pk_bf16_f32 v16, v12, v13
    v_lshlrev_b32 v12, 16, v35
    v_and_b32 v13, s72, v35
    v_lshlrev_b32 v17, 16, v16
    v_and_b32 v18, s72, v16
    v_add_f32 v12, v12, v17
    v_add_f32 v13, v13, v18
    v_cvt_pk_bf16_f32 v51, v12, v13
    buffer_store_dwordx4 v[48:51], v3, s[36:39], 0 offen offset:0
    s_waitcnt vmcnt(1)
    v_lshlrev_b32 v12, 16, v36
    v_and_b32 v13, s72, v36
    v_sub_f32 v12, v12, v10
    v_sub_f32 v13, v13, v10
    v_cvt_pk_bf16_f32 v12, v12, v13
    v_and_b32 v13, s72, v12
    v_lshlrev_b32 v12, 16, v12
    v_mul_f32 v12, v12, v11
    v_mul_f32 v13, v13, v11
    v_cvt_pk_bf16_f32 v16, v12, v13
    v_lshlrev_b32 v12, 16, v36
    v_and_b32 v13, s72, v36
    v_lshlrev_b32 v17, 16, v16
    v_and_b32 v18, s72, v16
    v_add_f32 v12, v12, v17
    v_add_f32 v13, v13, v18
    v_cvt_pk_bf16_f32 v52, v12, v13
    v_lshlrev_b32 v12, 16, v37
    v_and_b32 v13, s72, v37
    v_sub_f32 v12, v12, v10
    v_sub_f32 v13, v13, v10
    v_cvt_pk_bf16_f32 v12, v12, v13
    v_and_b32 v13, s72, v12
    v_lshlrev_b32 v12, 16, v12
    v_mul_f32 v12, v12, v11
    v_mul_f32 v13, v13, v11
    v_cvt_pk_bf16_f32 v16, v12, v13
    v_lshlrev_b32 v12, 16, v37
    v_and_b32 v13, s72, v37
    v_lshlrev_b32 v17, 16, v16
    v_and_b32 v18, s72, v16
    v_add_f32 v12, v12, v17
    v_add_f32 v13, v13, v18
    v_cvt_pk_bf16_f32 v53, v12, v13
    v_lshlrev_b32 v12, 16, v38
    v_and_b32 v13, s72, v38
    v_sub_f32 v12, v12, v10
    v_sub_f32 v13, v13, v10
    v_cvt_pk_bf16_f32 v12, v12, v13
    v_and_b32 v13, s72, v12
    v_lshlrev_b32 v12, 16, v12
    v_mul_f32 v12, v12, v11
    v_mul_f32 v13, v13, v11
    v_cvt_pk_bf16_f32 v16, v12, v13
    v_lshlrev_b32 v12, 16, v38
    v_and_b32 v13, s72, v38
    v_lshlrev_b32 v17, 16, v16
    v_and_b32 v18, s72, v16
    v_add_f32 v12, v12, v17
    v_add_f32 v13, v13, v18
    v_cvt_pk_bf16_f32 v54, v12, v13
    v_lshlrev_b32 v12, 16, v39
    v_and_b32 v13, s72, v39
    v_sub_f32 v12, v12, v10
    v_sub_f32 v13, v13, v10
    v_cvt_pk_bf16_f32 v12, v12, v13
    v_and_b32 v13, s72, v12
    v_lshlrev_b32 v12, 16, v12
    v_mul_f32 v12, v12, v11
    v_mul_f32 v13, v13, v11
    v_cvt_pk_bf16_f32 v16, v12, v13
    v_lshlrev_b32 v12, 16, v39
    v_and_b32 v13, s72, v39
    v_lshlrev_b32 v17, 16, v16
    v_and_b32 v18, s72, v16
    v_add_f32 v12, v12, v17
    v_add_f32 v13, v13, v18
    v_cvt_pk_bf16_f32 v55, v12, v13
    buffer_store_dwordx4 v[52:55], v3, s[36:39], 0 offen offset:512
L_k4l2_done:
    s_endpgm
.globl k5l2_kernel
.p2align 8
.type k5l2_kernel,@function
k5l2_kernel:
    s_cmp_ge_u32 s2, 32
    s_cbranch_scc1 L_k5l2_done
    s_load_dwordx2 s[4:5], s[0:1], 80
    s_load_dwordx2 s[70:71], s[0:1], 64
    s_mov_b32 s72, 0xffff0000
    s_mov_b32 s73, 0x3b000000
    s_mov_b32 s74, 0x3727c5ac
    s_lshr_b32 s68, s2, 2
    s_and_b32 s69, s2, 3
    v_and_b32 v1, 31, v0
    v_lshrrev_b32 v2, 5, v0
    v_mul_u32_u24 v3, 114688, v2
    v_lshl_add_u32 v3, v1, 4, v3
    s_lshl_b32 s40, s68, 11
    s_lshl_b32 s41, s69, 9
    s_add_u32 s40, s40, s41
    v_add_u32 v3, s40, v3
    s_waitcnt lgkmcnt(0)
    s_add_u32 s36, s4, 9437184
    s_addc_u32 s37, s5, 0
    s_and_b32 s37, s37, 0xffff
    s_mov_b32 s38, 917504
    s_mov_b32 s39, 0x00020000
    s_add_u32 s32, s4, 8454144
    s_addc_u32 s33, s5, 0
    s_and_b32 s33, s33, 0xffff
    s_mov_b32 s34, 65536
    s_mov_b32 s35, 0x00020000
    s_lshl_b32 s41, s68, 2
    s_add_u32 s41, s41, 32768
    v_mov_b32 v4, 0
    buffer_load_dword v26, v4, s[32:35], s41 offen
    s_mov_b32 s40, 0
    buffer_load_dwordx4 v[32:35], v3, s[36:39], s40 offen
    s_mov_b32 s40, 16384
    buffer_load_dwordx4 v[36:39], v3, s[36:39], s40 offen
    s_mov_b32 s40, 32768
    buffer_load_dwordx4 v[40:43], v3, s[36:39], s40 offen
    s_mov_b32 s40, 49152
    buffer_load_dwordx4 v[44:47], v3, s[36:39], s40 offen
    s_mov_b32 s40, 65536
    buffer_load_dwordx4 v[48:51], v3, s[36:39], s40 offen
    s_mov_b32 s40, 81920
    buffer_load_dwordx4 v[52:55], v3, s[36:39], s40 offen
    s_mov_b32 s40, 98304
    buffer_load_dwordx4 v[56:59], v3, s[36:39], s40 offen
    s_add_u32 s12, s4, 6291456
    s_addc_u32 s13, s5, 0
    s_and_b32 s13, s13, 0xffff
    s_mov_b32 s14, 2097152
    s_mov_b32 s15, 0x00020000
    s_add_u32 s24, s4, 8421376
    s_addc_u32 s25, s5, 0
    s_and_b32 s25, s25, 0xffff
    s_mov_b32 s26, 32768
    s_mov_b32 s27, 0x00020000
    s_mov_b32 s44, s70
    s_and_b32 s45, s71, 0xffff
    s_mov_b32 s46, 2097152
    s_mov_b32 s47, 0x00020000
    s_waitcnt vmcnt(7)
    v_and_b32 v28, 0x7ff, v26
    v_sub_u32 v28, 2047, v28
    v_lshlrev_b32 v30, 4, v28
    buffer_load_dwordx2 v[14:15], v30, s[24:27], 0 offen
    v_lshlrev_b32 v31, 10, v28
    v_lshl_add_u32 v31, v1, 3, v31
    s_lshl_b32 s41, s69, 8
    v_add_u32 v31, s41, v31
    buffer_load_dwordx2 v[16:17], v31, s[12:15], 0 offen
    s_waitcnt vmcnt(2)
    v_add_f32 v32, v32, v36
    v_add_f32 v33, v33, v37
    v_add_f32 v34, v34, v38
    v_add_f32 v35, v35, v39
    v_add_f32 v32, v32, v40
    v_add_f32 v33, v33, v41
    v_add_f32 v34, v34, v42
    v_add_f32 v35, v35, v43
    v_add_f32 v32, v32, v44
    v_add_f32 v33, v33, v45
    v_add_f32 v34, v34, v46
    v_add_f32 v35, v35, v47
    v_add_f32 v32, v32, v48
    v_add_f32 v33, v33, v49
    v_add_f32 v34, v34, v50
    v_add_f32 v35, v35, v51
    v_add_f32 v32, v32, v52
    v_add_f32 v33, v33, v53
    v_add_f32 v34, v34, v54
    v_add_f32 v35, v35, v55
    v_add_f32 v32, v32, v56
    v_add_f32 v33, v33, v57
    v_add_f32 v34, v34, v58
    v_add_f32 v35, v35, v59
    v_lshlrev_b32 v5, 4, v0
    ds_write_b128 v5, v[32:35]
    s_waitcnt lgkmcnt(0)
    s_barrier
    v_cmp_gt_u32 vcc, 32, v0
    s_nop 0
    s_and_saveexec_b64 s[48:49], vcc
    s_cbranch_execz L_k5l2_done
    ds_read_b128 v[32:35], v5 offset:0
    ds_read_b128 v[36:39], v5 offset:512
    ds_read_b128 v[40:43], v5 offset:1024
    ds_read_b128 v[44:47], v5 offset:1536
    ds_read_b128 v[48:51], v5 offset:2048
    ds_read_b128 v[52:55], v5 offset:2560
    ds_read_b128 v[56:59], v5 offset:3072
    ds_read_b128 v[60:63], v5 offset:3584
    s_waitcnt lgkmcnt(0)
    v_add_f32 v32, v32, v36
    v_add_f32 v33, v33, v37
    v_add_f32 v34, v34, v38
    v_add_f32 v35, v35, v39
    v_add_f32 v32, v32, v40
    v_add_f32 v33, v33, v41
    v_add_f32 v34, v34, v42
    v_add_f32 v35, v35, v43
    v_add_f32 v32, v32, v44
    v_add_f32 v33, v33, v45
    v_add_f32 v34, v34, v46
    v_add_f32 v35, v35, v47
    v_add_f32 v32, v32, v48
    v_add_f32 v33, v33, v49
    v_add_f32 v34, v34, v50
    v_add_f32 v35, v35, v51
    v_add_f32 v32, v32, v52
    v_add_f32 v33, v33, v53
    v_add_f32 v34, v34, v54
    v_add_f32 v35, v35, v55
    v_add_f32 v32, v32, v56
    v_add_f32 v33, v33, v57
    v_add_f32 v34, v34, v58
    v_add_f32 v35, v35, v59
    v_add_f32 v32, v32, v60
    v_add_f32 v33, v33, v61
    v_add_f32 v34, v34, v62
    v_add_f32 v35, v35, v63
    v_cvt_pk_bf16_f32 v40, v32, v33
    v_lshlrev_b32 v32, 16, v40
    v_and_b32 v33, s72, v40
    v_cvt_pk_bf16_f32 v40, v34, v35
    v_lshlrev_b32 v34, 16, v40
    v_and_b32 v35, s72, v40
    v_and_b32 v20, s72, v26
    v_ashrrev_i32 v21, 31, v20
    v_not_b32 v21, v21
    v_or_b32 v21, 0x80000000, v21
    v_xor_b32 v20, v20, v21
    v_and_b32 v20, s72, v20
    s_mov_b32 s40, 0xbfb8aa3b
    v_mul_f32 v20, s40, v20
    v_exp_f32 v20, v20
    s_nop 0
    v_add_f32 v20, 1.0, v20
    v_rcp_f32 v20, v20
    s_nop 0
    v_cvt_pk_bf16_f32 v20, v20, v20
    v_lshlrev_b32 v20, 16, v20
    v_mul_f32 v32, v32, v20
    v_mul_f32 v33, v33, v20
    v_mul_f32 v34, v34, v20
    v_mul_f32 v35, v35, v20
    v_cvt_pk_bf16_f32 v44, v32, v33
    v_cvt_pk_bf16_f32 v45, v34, v35
    s_waitcnt vmcnt(0)
    v_mul_f32 v12, s73, v14
    v_mul_f32 v13, s73, v15
    v_fma_f32 v13, -v12, v12, v13
    v_max_f32 v13, 0, v13
    v_cvt_pk_bf16_f32 v12, v12, v13
    v_lshlrev_b32 v10, 16, v12
    v_and_b32 v13, s72, v12
    v_add_f32 v13, s74, v13
    v_cvt_pk_bf16_f32 v13, v13, v13
    v_lshlrev_b32 v13, 16, v13
    v_sqrt_f32 v13, v13
    s_nop 0
    v_cvt_pk_bf16_f32 v13, v13, v13
    v_lshlrev_b32 v13, 16, v13
    v_rcp_f32 v11, v13
    v_lshlrev_b32 v12, 16, v16
    v_and_b32 v13, s72, v16
    v_sub_f32 v12, v12, v10
    v_sub_f32 v13, v13, v10
    v_cvt_pk_bf16_f32 v12, v12, v13
    v_and_b32 v13, s72, v12
    v_lshlrev_b32 v12, 16, v12
    v_mul_f32 v12, v12, v11
    v_mul_f32 v13, v13, v11
    v_cvt_pk_bf16_f32 v18, v12, v13
    v_lshlrev_b32 v12, 16, v18
    v_and_b32 v13, s72, v18
    v_lshlrev_b32 v19, 16, v44
    v_and_b32 v22, s72, v44
    v_add_f32 v12, v12, v19
    v_add_f32 v13, v13, v22
    v_cvt_pk_bf16_f32 v18, v12, v13
    v_lshlrev_b32 v12, 16, v16
    v_and_b32 v13, s72, v16
    v_lshlrev_b32 v19, 16, v18
    v_and_b32 v22, s72, v18
    v_add_f32 v12, v12, v19
    v_add_f32 v13, v13, v22
    v_cvt_pk_bf16_f32 v46, v12, v13
    v_lshlrev_b32 v12, 16, v17
    v_and_b32 v13, s72, v17
    v_sub_f32 v12, v12, v10
    v_sub_f32 v13, v13, v10
    v_cvt_pk_bf16_f32 v12, v12, v13
    v_and_b32 v13, s72, v12
    v_lshlrev_b32 v12, 16, v12
    v_mul_f32 v12, v12, v11
    v_mul_f32 v13, v13, v11
    v_cvt_pk_bf16_f32 v18, v12, v13
    v_lshlrev_b32 v12, 16, v18
    v_and_b32 v13, s72, v18
    v_lshlrev_b32 v19, 16, v45
    v_and_b32 v22, s72, v45
    v_add_f32 v12, v12, v19
    v_add_f32 v13, v13, v22
    v_cvt_pk_bf16_f32 v18, v12, v13
    v_lshlrev_b32 v12, 16, v17
    v_and_b32 v13, s72, v17
    v_lshlrev_b32 v19, 16, v18
    v_and_b32 v22, s72, v18
    v_add_f32 v12, v12, v19
    v_add_f32 v13, v13, v22
    v_cvt_pk_bf16_f32 v47, v12, v13
    buffer_store_dwordx2 v[46:47], v31, s[44:47], 0 offen
L_k5l2_done:
    s_endpgm
.section .rodata,"a"
.p2align 6
.amdhsa_kernel k1l1_kernel
  .amdhsa_next_free_vgpr 200
  .amdhsa_next_free_sgpr 100
  .amdhsa_accum_offset 200
  .amdhsa_group_segment_fixed_size 0
  .amdhsa_kernarg_size 88
  .amdhsa_user_sgpr_count 2
  .amdhsa_user_sgpr_kernarg_segment_ptr 1
  .amdhsa_system_sgpr_workgroup_id_x 1
.end_amdhsa_kernel
.p2align 6
.amdhsa_kernel k2l1_kernel
  .amdhsa_next_free_vgpr 128
  .amdhsa_next_free_sgpr 100
  .amdhsa_accum_offset 128
  .amdhsa_group_segment_fixed_size 0
  .amdhsa_kernarg_size 88
  .amdhsa_user_sgpr_count 2
  .amdhsa_user_sgpr_kernarg_segment_ptr 1
  .amdhsa_system_sgpr_workgroup_id_x 1
.end_amdhsa_kernel
.p2align 6
.amdhsa_kernel k4l1_kernel
  .amdhsa_next_free_vgpr 128
  .amdhsa_next_free_sgpr 100
  .amdhsa_accum_offset 128
  .amdhsa_group_segment_fixed_size 0
  .amdhsa_kernarg_size 88
  .amdhsa_user_sgpr_count 2
  .amdhsa_user_sgpr_kernarg_segment_ptr 1
  .amdhsa_system_sgpr_workgroup_id_x 1
.end_amdhsa_kernel
.p2align 6
.amdhsa_kernel k5l1_kernel
  .amdhsa_next_free_vgpr 64
  .amdhsa_next_free_sgpr 100
  .amdhsa_accum_offset 64
  .amdhsa_group_segment_fixed_size 0
  .amdhsa_kernarg_size 88
  .amdhsa_user_sgpr_count 2
  .amdhsa_user_sgpr_kernarg_segment_ptr 1
  .amdhsa_system_sgpr_workgroup_id_x 1
.end_amdhsa_kernel
.p2align 6
.amdhsa_kernel k1l2_kernel
  .amdhsa_next_free_vgpr 200
  .amdhsa_next_free_sgpr 100
  .amdhsa_accum_offset 200
  .amdhsa_group_segment_fixed_size 0
  .amdhsa_kernarg_size 88
  .amdhsa_user_sgpr_count 2
  .amdhsa_user_sgpr_kernarg_segment_ptr 1
  .amdhsa_system_sgpr_workgroup_id_x 1
.end_amdhsa_kernel
.p2align 6
.amdhsa_kernel k2l2_kernel
  .amdhsa_next_free_vgpr 128
  .amdhsa_next_free_sgpr 100
  .amdhsa_accum_offset 128
  .amdhsa_group_segment_fixed_size 0
  .amdhsa_kernarg_size 88
  .amdhsa_user_sgpr_count 2
  .amdhsa_user_sgpr_kernarg_segment_ptr 1
  .amdhsa_system_sgpr_workgroup_id_x 1
.end_amdhsa_kernel
.p2align 6
.amdhsa_kernel k4l2_kernel
  .amdhsa_next_free_vgpr 128
  .amdhsa_next_free_sgpr 100
  .amdhsa_accum_offset 128
  .amdhsa_group_segment_fixed_size 0
  .amdhsa_kernarg_size 88
  .amdhsa_user_sgpr_count 2
  .amdhsa_user_sgpr_kernarg_segment_ptr 1
  .amdhsa_system_sgpr_workgroup_id_x 1
.end_amdhsa_kernel
.p2align 6
.amdhsa_kernel k5l2_kernel
  .amdhsa_next_free_vgpr 64
  .amdhsa_next_free_sgpr 100
  .amdhsa_accum_offset 64
  .amdhsa_group_segment_fixed_size 0
  .amdhsa_kernarg_size 88
  .amdhsa_user_sgpr_count 2
  .amdhsa_user_sgpr_kernarg_segment_ptr 1
  .amdhsa_system_sgpr_workgroup_id_x 1
.end_amdhsa_kernel
```
